```python
import torch

def _softmax(x, axis=-1):
    return torch.softmax(x, dim=axis)
def _gelu(x):
    return torch.nn.functional.gelu(x, approximate="tanh")
def _silu(x):
    return torch.nn.functional.silu(x)
def _sigmoid(x):
    return torch.sigmoid(x)
def _layernorm(x, axis=-1, eps=1e-5):
    m = x.mean(dim=axis, keepdim=True)
    v = x.var(dim=axis, keepdim=True, unbiased=False)
    return (x - m) / torch.sqrt(v + eps)
def _scatter_add(tgt, idx, src, axis=0):
    return tgt.clone().index_add_(axis, idx, src)
def _segment_sum(src, seg, n):
    out = torch.zeros((n,) + src.shape[1:], dtype=src.dtype)
    return out.index_add_(0, seg, src)
def _pad(x, pw):
    flat = tuple(v for pair in reversed(pw) for v in pair)
    return torch.nn.functional.pad(x, flat)

kernel_name = 'interleave_layers__spectral_gfnet__grouped_kv_mqa__prompt'

def setup_inputs():

    _w = (lambda a: (lambda t: t.to(torch.bfloat16) if t.is_floating_point() else t)(torch.as_tensor(a)))
    def _A_setup():
        B, S, D = 1, 2048, 512
        Df = D // 2 + 1
        return {
            "x": _w((lambda *s: torch.randn(*s, dtype=torch.bfloat16) * 0.05)(B, S, D)),
            "w_r": _w((lambda *s: torch.randn(*s, dtype=torch.bfloat16) * 0.8)(S, Df) * 0.02),
            "w_i": _w((lambda *s: torch.randn(*s, dtype=torch.bfloat16) * 0.8)(S, Df) * 0.02),
        }
    _A_in = _A_setup()

    def _B_setup():
        B, S, D, H = 1, 2048, 512, 32
        Dh = D // H
        return {
            "x": _w((lambda *s: torch.randn(*s, dtype=torch.bfloat16) * 0.05)(B, S, D)),
            "wq": _w((lambda *s: torch.randn(*s, dtype=torch.bfloat16) * 0.05)(D, H * Dh)),
            "wk": _w((lambda *s: torch.randn(*s, dtype=torch.bfloat16) * 0.05)(D, Dh)),
            "wv": _w((lambda *s: torch.randn(*s, dtype=torch.bfloat16) * 0.05)(D, Dh)),
            "wo": _w((lambda *s: torch.randn(*s, dtype=torch.bfloat16) * 0.05)(H * Dh, D)),
        }
    _B_in = _B_setup()

    return {
        "A_x": _A_in["x"],
        "A_w_r": _A_in["w_r"],
        "A_w_i": _A_in["w_i"],
        "B_x": _B_in["x"],
        "B_wq": _B_in["wq"],
        "B_wk": _B_in["wk"],
        "B_wv": _B_in["wv"],
        "B_wo": _B_in["wo"],
    }

def reference(A_x, A_w_r, A_w_i, B_x, B_wq, B_wk, B_wv, B_wo):
    def _A_ref(x, w_r, w_i):
        B, S, D = x.shape
        X = (lambda x, axes=(-2,-1): torch.fft.rfft2(x.float(), dim=axes))(x, axes=(-2, -1))
        W = w_r + 1j * w_i
        X = X * W
        y = (lambda x, s, axes=(-2,-1): torch.fft.irfft2(x, s=s, dim=axes).to(torch.bfloat16))(X, (S, D), axes=(-2, -1))
        return y

    def _B_ref(x, wq, wk, wv, wo):
        B, S, D = x.shape
        H = 32
        Dh = D // H
        q = (lambda x, *d: x.permute(*d))((x @ wq).reshape(B, S, H, Dh), 0, 2, 1, 3)
        k = x @ wk
        v = x @ wv
        scores = torch.einsum("bhqd,bkd->bhqk", q, k) * (Dh ** -0.5)
        p = _softmax(scores, axis=-1)
        o = torch.einsum("bhqk,bkd->bhqd", p, v)
        return (lambda x, *d: x.permute(*d))(o, 0, 2, 1, 3).reshape(B, S, H * Dh) @ wo

    x = A_x
    x = x + _A_ref(_layernorm(x, axis=-1), A_w_r, A_w_i)
    x = x + _B_ref(_layernorm(x, axis=-1), B_wq, B_wk, B_wv, B_wo)
    x = x + _A_ref(_layernorm(x, axis=-1), A_w_r, A_w_i)
    x = x + _B_ref(_layernorm(x, axis=-1), B_wq, B_wk, B_wv, B_wo)
    return x
```

```asm
; @launch kernel=k1_kernel grid=(256,1,1) block=(512,1,1) lds=16640
; @launch kernel=km_kernel grid=(256,1,1) block=(512,1,1) lds=163840
.amdgcn_target "amdgcn-amd-amdhsa--gfx950"
.text
.globl k1_kernel
.p2align 8
.type k1_kernel,@function
k1_kernel:
    s_load_dwordx4 s[4:7], s[0:1], 0
    s_load_dwordx2 s[8:9], s[0:1], 16
    s_load_dwordx8 s[12:19], s[0:1], 32
    s_load_dwordx2 s[24:25], s[0:1], 80
    s_cmp_ge_u32 s2, 256
    s_cbranch_scc1 k1_exit
    v_lshrrev_b32 v5, 6, v0
    v_and_b32 v1, 63, v0
    v_readfirstlane_b32 s36, v5
    v_and_b32 v2, 15, v0
    v_bfe_u32 v3, v0, 4, 2
    v_lshlrev_b32 v4, 4, v1
    s_and_b32 s37, s2, 7
    s_lshr_b32 s38, s2, 3
    s_mov_b32 s26, 67108864
    s_mov_b32 s27, 0x00020000
    s_lshl_b32 s39, s37, 2
    s_and_b32 s42, s38, 3
    s_add_u32 s39, s39, s42
    s_lshl_b32 s49, s42, 3
    s_add_u32 s49, s49, s37
    s_lshl_b32 s48, s37, 4
    s_add_u32 s48, s48, s38
    s_sub_u32 s48, s48, 8
    s_cmp_ge_u32 s36, 4
    s_cbranch_scc1 k1_f
    s_cmp_ge_u32 s2, 194
    s_cbranch_scc1 k1_f2
    s_setprio 3
    v_lshl_add_u32 v5, v2, 2, s36
    v_cvt_f32_u32 v9, v5
    v_cvt_f32_u32 v6, v3
    v_cmp_eq_u32 vcc, 0, v5
    v_mul_f32 v9, 0x3c000000, v9
    v_mul_f32 v6, 4.0, v6
    v_mov_b32 v7, 0x3e000000
    v_mul_f32 v10, v6, v9
    v_mul_f32 v8, 0x3e800000, v9
    v_cndmask_b32 v9, v9, 0.5, vcc
    v_cndmask_b32 v10, v10, v7, vcc
    s_not_b64 s[60:61], vcc
    v_mul_f32 v11, 0x42000000, v9
    v_mul_f32 v13, 0x41500000, v9
    s_mov_b32 s23, 0x00020000
    s_mul_i32 s56, s36, 4160
    s_add_u32 s57, s56, 1040
    s_add_u32 s58, s56, 2080
    s_add_u32 s59, s56, 3120
    v_mov_b32 v12, v4
    s_mov_b32 s40, 2
    s_mov_b32 s22, 0x200000
    s_sub_u32 s43, s38, 8
    s_cmp_lt_u32 s43, 16
    s_cbranch_scc0 k1_nx
    s_lshl_b32 s52, s42, 19
    s_lshr_b32 s44, s48, 2
    s_lshl_b32 s44, s44, 10
    s_add_u32 s52, s52, s44
    s_lshl_b32 s44, s36, 17
    s_add_u32 s52, s52, s44
    s_add_u32 s53, s52, 0x8000
    s_add_u32 s54, s52, 0x10000
    s_add_u32 s55, s52, 0x18000
    s_branch k1_go
k1_nx:
    s_mov_b32 s22, 0x80000
    s_lshr_b32 s40, s38, 2
    s_cmp_lg_u32 s40, 1
    s_cbranch_scc1 k1_nw
    s_lshl_b32 s52, s49, 14
    s_lshl_b32 s44, s36, 12
    s_add_u32 s52, s52, s44
    s_add_u32 s53, s52, 1024
    s_add_u32 s54, s52, 2048
    s_add_u32 s55, s52, 3072
    s_branch k1_go
k1_nw:
    s_lshl_b32 s43, s39, 5
    s_mov_b32 s41, 10
    s_cmp_eq_u32 s40, 0
    s_cbranch_scc1 k1_nkv
    s_mov_b32 s40, 0
    s_add_u32 s39, s37, 32
    s_mov_b32 s41, 5
    s_mov_b32 s43, 0
    s_mov_b32 s22, 0x4000
k1_nkv:
    s_lshl_b32 s44, s36, 7
    s_lshl_b32 s45, s36, 10
    s_xor_b32 s47, s42, 0
    s_add_u32 s52, s44, s47
    s_lshl_b32 s52, s52, s41
    s_add_u32 s52, s52, s43
    s_lshl_b32 s47, s47, 12
    s_add_u32 s56, s47, s45
    s_xor_b32 s47, s42, 1
    s_add_u32 s53, s44, s47
    s_lshl_b32 s53, s53, s41
    s_add_u32 s53, s53, s43
    s_lshl_b32 s47, s47, 12
    s_add_u32 s57, s47, s45
    s_xor_b32 s47, s42, 2
    s_add_u32 s54, s44, s47
    s_lshl_b32 s54, s54, s41
    s_add_u32 s54, s54, s43
    s_lshl_b32 s47, s47, 12
    s_add_u32 s58, s47, s45
    s_xor_b32 s47, s42, 3
    s_add_u32 s55, s44, s47
    s_lshl_b32 s55, s55, s41
    s_add_u32 s55, s55, s43
    s_lshl_b32 s47, s47, 12
    s_add_u32 s59, s47, s45
    v_and_b32 v5, 62, v1
    s_add_u32 s41, s41, 1
    v_lshlrev_b32 v5, s41, v5
    v_and_or_b32 v12, v4, 16, v5
k1_go:
    s_mov_b32 m0, s56
    v_add_f32 v76, v10, v9
    v_cos_f32 v52, v10
    v_sin_f32 v60, v10
    v_cos_f32 v53, v76
    v_sin_f32 v61, v76
    v_add_f32 v10, v76, v9
    v_cos_f32 v68, v11
    v_sin_f32 v69, v11
    v_fmac_f32 v11, 0x42000000, v9
    v_cvt_pk_bf16_f32 v20, v52, v53
    v_cvt_pk_bf16_f32 v36, -v60, -v61
    s_waitcnt lgkmcnt(0)
    s_cmp_eq_u32 s39, 33
    s_cselect_b64 s[20:21], s[16:17], s[14:15]
    s_cmp_lt_u32 s39, 32
    s_cselect_b64 s[20:21], s[12:13], s[20:21]
    s_cmp_eq_u32 s40, 1
    s_cselect_b64 s[20:21], s[18:19], s[20:21]
    s_cmp_eq_u32 s40, 2
    s_cselect_b64 s[20:21], s[4:5], s[20:21]
    buffer_load_dwordx4 v12, s[20:23], s52 offen lds
    s_mov_b32 m0, s57
    s_nop 0
    buffer_load_dwordx4 v12, s[20:23], s53 offen lds
    s_mov_b32 m0, s58
    s_nop 0
    buffer_load_dwordx4 v12, s[20:23], s54 offen lds
    s_mov_b32 m0, s59
    s_nop 0
    buffer_load_dwordx4 v12, s[20:23], s55 offen lds
    s_setprio 1
    v_add_f32 v76, v10, v9
    v_cos_f32 v54, v10
    v_sin_f32 v62, v10
    v_cos_f32 v55, v76
    v_sin_f32 v63, v76
    v_add_f32 v10, v76, v13
    v_cos_f32 v70, v11
    v_sin_f32 v71, v11
    v_fmac_f32 v11, 0x42000000, v9
    v_cvt_pk_bf16_f32 v21, v54, v55
    v_cvt_pk_bf16_f32 v37, -v62, -v63
    v_add_f32 v76, v10, v9
    v_cos_f32 v56, v10
    v_sin_f32 v64, v10
    v_cos_f32 v57, v76
    v_sin_f32 v65, v76
    v_add_f32 v10, v76, v9
    v_cos_f32 v72, v11
    v_sin_f32 v73, v11
    v_cvt_pk_bf16_f32 v22, v56, v57
    v_cvt_pk_bf16_f32 v38, -v64, -v65
    v_add_f32 v76, v10, v9
    v_cos_f32 v58, v10
    v_sin_f32 v66, v10
    v_cos_f32 v59, v76
    v_sin_f32 v67, v76
    v_cvt_pk_bf16_f32 v23, v58, v59
    v_cvt_pk_bf16_f32 v39, -v66, -v67
    v_pk_mul_f32 v[76:77], v[60:61], v[68:69] op_sel:[0,1] op_sel_hi:[1,1]
    v_pk_mul_f32 v[78:79], v[52:53], v[68:69] op_sel:[0,1] op_sel_hi:[1,1]
    v_pk_fma_f32 v[76:77], v[52:53], v[68:69], v[76:77] op_sel_hi:[1,0,1] neg_lo:[0,0,1] neg_hi:[0,0,1]
    v_pk_fma_f32 v[78:79], v[60:61], v[68:69], v[78:79] op_sel_hi:[1,0,1]
    v_cvt_pk_bf16_f32 v24, v76, v77
    v_cvt_pk_bf16_f32 v40, -v78, -v79
    v_pk_mul_f32 v[80:81], v[62:63], v[68:69] op_sel:[0,1] op_sel_hi:[1,1]
    v_pk_mul_f32 v[82:83], v[54:55], v[68:69] op_sel:[0,1] op_sel_hi:[1,1]
    v_pk_fma_f32 v[80:81], v[54:55], v[68:69], v[80:81] op_sel_hi:[1,0,1] neg_lo:[0,0,1] neg_hi:[0,0,1]
    v_pk_fma_f32 v[82:83], v[62:63], v[68:69], v[82:83] op_sel_hi:[1,0,1]
    v_cvt_pk_bf16_f32 v25, v80, v81
    v_cvt_pk_bf16_f32 v41, -v82, -v83
    v_pk_mul_f32 v[76:77], v[64:65], v[68:69] op_sel:[0,1] op_sel_hi:[1,1]
    v_pk_mul_f32 v[78:79], v[56:57], v[68:69] op_sel:[0,1] op_sel_hi:[1,1]
    v_pk_fma_f32 v[76:77], v[56:57], v[68:69], v[76:77] op_sel_hi:[1,0,1] neg_lo:[0,0,1] neg_hi:[0,0,1]
    v_pk_fma_f32 v[78:79], v[64:65], v[68:69], v[78:79] op_sel_hi:[1,0,1]
    v_cvt_pk_bf16_f32 v26, v76, v77
    v_cvt_pk_bf16_f32 v42, -v78, -v79
    v_pk_mul_f32 v[80:81], v[66:67], v[68:69] op_sel:[0,1] op_sel_hi:[1,1]
    v_pk_mul_f32 v[82:83], v[58:59], v[68:69] op_sel:[0,1] op_sel_hi:[1,1]
    v_pk_fma_f32 v[80:81], v[58:59], v[68:69], v[80:81] op_sel_hi:[1,0,1] neg_lo:[0,0,1] neg_hi:[0,0,1]
    v_pk_fma_f32 v[82:83], v[66:67], v[68:69], v[82:83] op_sel_hi:[1,0,1]
    v_cvt_pk_bf16_f32 v27, v80, v81
    v_cvt_pk_bf16_f32 v43, -v82, -v83
    v_pk_mul_f32 v[76:77], v[60:61], v[70:71] op_sel:[0,1] op_sel_hi:[1,1]
    v_pk_mul_f32 v[78:79], v[52:53], v[70:71] op_sel:[0,1] op_sel_hi:[1,1]
    v_pk_fma_f32 v[76:77], v[52:53], v[70:71], v[76:77] op_sel_hi:[1,0,1] neg_lo:[0,0,1] neg_hi:[0,0,1]
    v_pk_fma_f32 v[78:79], v[60:61], v[70:71], v[78:79] op_sel_hi:[1,0,1]
    v_cvt_pk_bf16_f32 v28, v76, v77
    v_cvt_pk_bf16_f32 v44, -v78, -v79
    v_pk_mul_f32 v[80:81], v[62:63], v[70:71] op_sel:[0,1] op_sel_hi:[1,1]
    v_pk_mul_f32 v[82:83], v[54:55], v[70:71] op_sel:[0,1] op_sel_hi:[1,1]
    v_pk_fma_f32 v[80:81], v[54:55], v[70:71], v[80:81] op_sel_hi:[1,0,1] neg_lo:[0,0,1] neg_hi:[0,0,1]
    v_pk_fma_f32 v[82:83], v[62:63], v[70:71], v[82:83] op_sel_hi:[1,0,1]
    v_cvt_pk_bf16_f32 v29, v80, v81
    v_cvt_pk_bf16_f32 v45, -v82, -v83
    v_pk_mul_f32 v[76:77], v[64:65], v[70:71] op_sel:[0,1] op_sel_hi:[1,1]
    v_pk_mul_f32 v[78:79], v[56:57], v[70:71] op_sel:[0,1] op_sel_hi:[1,1]
    v_pk_fma_f32 v[76:77], v[56:57], v[70:71], v[76:77] op_sel_hi:[1,0,1] neg_lo:[0,0,1] neg_hi:[0,0,1]
    v_pk_fma_f32 v[78:79], v[64:65], v[70:71], v[78:79] op_sel_hi:[1,0,1]
    v_cvt_pk_bf16_f32 v30, v76, v77
    v_cvt_pk_bf16_f32 v46, -v78, -v79
    v_pk_mul_f32 v[80:81], v[66:67], v[70:71] op_sel:[0,1] op_sel_hi:[1,1]
    v_pk_mul_f32 v[82:83], v[58:59], v[70:71] op_sel:[0,1] op_sel_hi:[1,1]
    v_pk_fma_f32 v[80:81], v[58:59], v[70:71], v[80:81] op_sel_hi:[1,0,1] neg_lo:[0,0,1] neg_hi:[0,0,1]
    v_pk_fma_f32 v[82:83], v[66:67], v[70:71], v[82:83] op_sel_hi:[1,0,1]
    v_cvt_pk_bf16_f32 v31, v80, v81
    v_cvt_pk_bf16_f32 v47, -v82, -v83
    v_pk_mul_f32 v[76:77], v[60:61], v[72:73] op_sel:[0,1] op_sel_hi:[1,1]
    v_pk_mul_f32 v[78:79], v[52:53], v[72:73] op_sel:[0,1] op_sel_hi:[1,1]
    v_pk_fma_f32 v[76:77], v[52:53], v[72:73], v[76:77] op_sel_hi:[1,0,1] neg_lo:[0,0,1] neg_hi:[0,0,1]
    v_pk_fma_f32 v[78:79], v[60:61], v[72:73], v[78:79] op_sel_hi:[1,0,1]
    v_cvt_pk_bf16_f32 v32, v76, v77
    v_cvt_pk_bf16_f32 v48, -v78, -v79
    v_pk_mul_f32 v[80:81], v[62:63], v[72:73] op_sel:[0,1] op_sel_hi:[1,1]
    v_pk_mul_f32 v[82:83], v[54:55], v[72:73] op_sel:[0,1] op_sel_hi:[1,1]
    v_pk_fma_f32 v[80:81], v[54:55], v[72:73], v[80:81] op_sel_hi:[1,0,1] neg_lo:[0,0,1] neg_hi:[0,0,1]
    v_pk_fma_f32 v[82:83], v[62:63], v[72:73], v[82:83] op_sel_hi:[1,0,1]
    v_cvt_pk_bf16_f32 v33, v80, v81
    v_cvt_pk_bf16_f32 v49, -v82, -v83
    v_pk_mul_f32 v[76:77], v[64:65], v[72:73] op_sel:[0,1] op_sel_hi:[1,1]
    v_pk_mul_f32 v[78:79], v[56:57], v[72:73] op_sel:[0,1] op_sel_hi:[1,1]
    v_pk_fma_f32 v[76:77], v[56:57], v[72:73], v[76:77] op_sel_hi:[1,0,1] neg_lo:[0,0,1] neg_hi:[0,0,1]
    v_pk_fma_f32 v[78:79], v[64:65], v[72:73], v[78:79] op_sel_hi:[1,0,1]
    v_cvt_pk_bf16_f32 v34, v76, v77
    v_cvt_pk_bf16_f32 v50, -v78, -v79
    v_pk_mul_f32 v[80:81], v[66:67], v[72:73] op_sel:[0,1] op_sel_hi:[1,1]
    v_pk_mul_f32 v[82:83], v[58:59], v[72:73] op_sel:[0,1] op_sel_hi:[1,1]
    v_pk_fma_f32 v[80:81], v[58:59], v[72:73], v[80:81] op_sel_hi:[1,0,1] neg_lo:[0,0,1] neg_hi:[0,0,1]
    v_pk_fma_f32 v[82:83], v[66:67], v[72:73], v[82:83] op_sel_hi:[1,0,1]
    v_cvt_pk_bf16_f32 v35, v80, v81
    v_cvt_pk_bf16_f32 v51, -v82, -v83
    s_mov_b32 s62, 2.0
    s_mov_b32 s63, 2.0
    s_mov_b32 s45, 0x3fb509e7
    s_cmp_lg_u32 s36, 0
    s_cbranch_scc1 k1_nofix
    s_mov_b32 s43, 0x3f353f35
    s_mov_b64 exec, vcc
    v_mov_b32 v36, s43
    v_mov_b32 v37, s43
    v_mov_b32 v38, s43
    v_mov_b32 v39, s43
    v_mov_b32 v40, s43
    v_mov_b32 v41, s43
    v_mov_b32 v42, s43
    v_mov_b32 v43, s43
    v_mov_b32 v44, s43
    v_mov_b32 v45, s43
    v_mov_b32 v46, s43
    v_mov_b32 v47, s43
    v_mov_b32 v48, s43
    v_mov_b32 v49, s43
    v_mov_b32 v50, s43
    v_mov_b32 v51, s43
    s_mov_b64 exec, -1
k1_nofix:
    s_cmp_eq_u32 s40, 0
    s_cbranch_scc1 k1_mW
    v_add_f32 v5, v8, v8
    v_cos_f32 v92, v8
    v_sin_f32 v93, v8
    v_add_f32 v6, v5, v8
    v_cos_f32 v94, v5
    v_sin_f32 v96, v5
    v_cos_f32 v95, v6
    v_sin_f32 v97, v6
    v_and_b32 v5, 3, v2
    v_and_b32 v10, 60, v1
    v_lshlrev_b32 v10, 1, v10
    v_mul_u32_u24 v5, 4160, v5
    v_add_u32 v10, v10, v5
    v_and_b32 v12, 0x30, v0
    v_lshl_add_u32 v12, v2, 6, v12
    s_lshl_b32 s46, s48, 14
    s_lshl_b32 s43, s36, 10
    s_add_u32 s46, s46, s43
    s_add_u32 s46, s46, 0
    s_waitcnt vmcnt(0)
    s_barrier
    ds_read_b64_tr_b16 v[116:117], v10 offset:0
    ds_read_b64_tr_b16 v[118:119], v10 offset:128
    ds_read_b64_tr_b16 v[120:121], v10 offset:256
    ds_read_b64_tr_b16 v[122:123], v10 offset:384
    ds_read_b64_tr_b16 v[124:125], v10 offset:512
    ds_read_b64_tr_b16 v[126:127], v10 offset:640
    ds_read_b64_tr_b16 v[128:129], v10 offset:768
    ds_read_b64_tr_b16 v[130:131], v10 offset:896
    ds_read_b64_tr_b16 v[132:133], v10 offset:1040
    ds_read_b64_tr_b16 v[134:135], v10 offset:1168
    ds_read_b64_tr_b16 v[136:137], v10 offset:1296
    ds_read_b64_tr_b16 v[138:139], v10 offset:1424
    ds_read_b64_tr_b16 v[140:141], v10 offset:1552
    ds_read_b64_tr_b16 v[142:143], v10 offset:1680
    s_waitcnt lgkmcnt(12)
    v_mfma_f32_16x16x32_bf16 v[52:55], v[116:119], v[20:23], 0
    v_mfma_f32_16x16x32_bf16 v[56:59], v[116:119], v[36:39], 0
    ds_read_b64_tr_b16 v[144:145], v10 offset:1808
    ds_read_b64_tr_b16 v[146:147], v10 offset:1936
    s_waitcnt lgkmcnt(12)
    v_mfma_f32_16x16x32_bf16 v[52:55], v[120:123], v[24:27], v[52:55]
    v_mfma_f32_16x16x32_bf16 v[56:59], v[120:123], v[40:43], v[56:59]
    ds_read_b64_tr_b16 v[148:149], v10 offset:2080
    ds_read_b64_tr_b16 v[150:151], v10 offset:2208
    s_waitcnt lgkmcnt(12)
    v_mfma_f32_16x16x32_bf16 v[52:55], v[124:127], v[28:31], v[52:55]
    v_mfma_f32_16x16x32_bf16 v[56:59], v[124:127], v[44:47], v[56:59]
    ds_read_b64_tr_b16 v[152:153], v10 offset:2336
    ds_read_b64_tr_b16 v[154:155], v10 offset:2464
    s_waitcnt lgkmcnt(12)
    v_mfma_f32_16x16x32_bf16 v[52:55], v[128:131], v[32:35], v[52:55]
    v_mfma_f32_16x16x32_bf16 v[56:59], v[128:131], v[48:51], v[56:59]
    ds_read_b64_tr_b16 v[156:157], v10 offset:2592
    ds_read_b64_tr_b16 v[158:159], v10 offset:2720
    s_waitcnt lgkmcnt(12)
    v_mfma_f32_16x16x32_bf16 v[60:63], v[132:135], v[20:23], 0
    v_mfma_f32_16x16x32_bf16 v[64:67], v[132:135], v[36:39], 0
    ds_read_b64_tr_b16 v[160:161], v10 offset:2848
    ds_read_b64_tr_b16 v[162:163], v10 offset:2976
    s_waitcnt lgkmcnt(12)
    v_mfma_f32_16x16x32_bf16 v[60:63], v[136:139], v[24:27], v[60:63]
    s_mov_b64 exec, s[60:61]
    v_mul_f32 v16, v57, v93
    v_mul_f32 v17, v53, v93
    v_mfma_f32_16x16x32_bf16 v[64:67], v[136:139], v[40:43], v[64:67]
    v_fma_f32 v53, v53, v92, v16
    v_fma_f32 v57, v57, v92, -v17
    s_mov_b64 exec, -1
    ds_read_b64_tr_b16 v[164:165], v10 offset:3120
    ds_read_b64_tr_b16 v[166:167], v10 offset:3248
    s_waitcnt lgkmcnt(12)
    v_mfma_f32_16x16x32_bf16 v[60:63], v[140:143], v[28:31], v[60:63]
    s_mov_b64 exec, s[60:61]
    v_pk_fma_f32 v[84:85], v[58:59], v[96:97], v[52:53]
    v_pk_fma_f32 v[18:19], v[54:55], v[96:97], v[56:57] neg_lo:[0,1,0] neg_hi:[0,1,0]
    v_mfma_f32_16x16x32_bf16 v[64:67], v[140:143], v[44:47], v[64:67]
    v_pk_fma_f32 v[84:85], v[54:55], v[94:95], v[84:85]
    v_pk_fma_f32 v[18:19], v[58:59], v[94:95], v[18:19]
    v_pk_fma_f32 v[52:53], v[52:53], s[62:63], v[84:85] neg_lo:[0,0,1] neg_hi:[0,0,1]
    s_mov_b64 exec, -1
    ds_read_b64_tr_b16 v[168:169], v10 offset:3376
    ds_read_b64_tr_b16 v[170:171], v10 offset:3504
    s_waitcnt lgkmcnt(12)
    v_mfma_f32_16x16x32_bf16 v[60:63], v[144:147], v[32:35], v[60:63]
    s_mov_b64 exec, s[60:61]
    v_pk_fma_f32 v[56:57], v[56:57], s[62:63], v[18:19] neg_lo:[0,0,1] neg_hi:[0,0,1]
    v_pk_add_f32 v[54:55], v[84:85], v[84:85] op_sel:[0,1] op_sel_hi:[0,1] neg_hi:[0,1]
    v_mfma_f32_16x16x32_bf16 v[64:67], v[144:147], v[48:51], v[64:67]
    v_pk_add_f32 v[58:59], v[18:19], v[18:19] op_sel:[0,1] op_sel_hi:[0,1] neg_hi:[1,0]
    v_pk_add_f32 v[84:85], v[52:53], v[56:57] op_sel:[0,1] op_sel_hi:[0,1] neg_hi:[0,1]
    v_pk_add_f32 v[56:57], v[56:57], v[52:53] op_sel:[0,1] op_sel_hi:[0,1] neg_lo:[0,1] neg_hi:[1,1]
    s_mov_b64 exec, -1
    ds_read_b64_tr_b16 v[172:173], v10 offset:3632
    ds_read_b64_tr_b16 v[174:175], v10 offset:3760
    s_waitcnt lgkmcnt(12)
    v_mfma_f32_16x16x32_bf16 v[68:71], v[148:151], v[20:23], 0
    v_mfma_f32_16x16x32_bf16 v[72:75], v[148:151], v[36:39], 0
    ds_read_b64_tr_b16 v[176:177], v10 offset:3888
    ds_read_b64_tr_b16 v[178:179], v10 offset:4016
    s_waitcnt lgkmcnt(12)
    v_mfma_f32_16x16x32_bf16 v[68:71], v[152:155], v[24:27], v[68:71]
    s_mov_b64 exec, s[60:61]
    v_mul_f32 v16, v65, v93
    v_mul_f32 v17, v61, v93
    v_mfma_f32_16x16x32_bf16 v[72:75], v[152:155], v[40:43], v[72:75]
    v_fma_f32 v61, v61, v92, v16
    v_fma_f32 v65, v65, v92, -v17
    s_waitcnt lgkmcnt(10)
    v_mfma_f32_16x16x32_bf16 v[68:71], v[156:159], v[28:31], v[68:71]
    v_pk_fma_f32 v[86:87], v[66:67], v[96:97], v[60:61]
    v_pk_fma_f32 v[18:19], v[62:63], v[96:97], v[64:65] neg_lo:[0,1,0] neg_hi:[0,1,0]
    v_mfma_f32_16x16x32_bf16 v[72:75], v[156:159], v[44:47], v[72:75]
    v_pk_fma_f32 v[86:87], v[62:63], v[94:95], v[86:87]
    v_pk_fma_f32 v[18:19], v[66:67], v[94:95], v[18:19]
    v_pk_fma_f32 v[60:61], v[60:61], s[62:63], v[86:87] neg_lo:[0,0,1] neg_hi:[0,0,1]
    s_waitcnt lgkmcnt(8)
    v_mfma_f32_16x16x32_bf16 v[68:71], v[160:163], v[32:35], v[68:71]
    v_pk_fma_f32 v[64:65], v[64:65], s[62:63], v[18:19] neg_lo:[0,0,1] neg_hi:[0,0,1]
    v_pk_add_f32 v[62:63], v[86:87], v[86:87] op_sel:[0,1] op_sel_hi:[0,1] neg_hi:[0,1]
    v_mfma_f32_16x16x32_bf16 v[72:75], v[160:163], v[48:51], v[72:75]
    v_pk_add_f32 v[66:67], v[18:19], v[18:19] op_sel:[0,1] op_sel_hi:[0,1] neg_hi:[1,0]
    v_pk_add_f32 v[86:87], v[60:61], v[64:65] op_sel:[0,1] op_sel_hi:[0,1] neg_hi:[0,1]
    v_pk_add_f32 v[64:65], v[64:65], v[60:61] op_sel:[0,1] op_sel_hi:[0,1] neg_lo:[0,1] neg_hi:[1,1]
    s_waitcnt lgkmcnt(6)
    v_mfma_f32_16x16x32_bf16 v[76:79], v[164:167], v[20:23], 0
    v_mfma_f32_16x16x32_bf16 v[80:83], v[164:167], v[36:39], 0
    s_waitcnt lgkmcnt(4)
    v_mfma_f32_16x16x32_bf16 v[76:79], v[168:171], v[24:27], v[76:79]
    v_mul_f32 v16, v73, v93
    v_mul_f32 v17, v69, v93
    v_mfma_f32_16x16x32_bf16 v[80:83], v[168:171], v[40:43], v[80:83]
    v_fma_f32 v69, v69, v92, v16
    v_fma_f32 v73, v73, v92, -v17
    s_waitcnt lgkmcnt(2)
    v_mfma_f32_16x16x32_bf16 v[76:79], v[172:175], v[28:31], v[76:79]
    v_pk_fma_f32 v[88:89], v[74:75], v[96:97], v[68:69]
    v_pk_fma_f32 v[18:19], v[70:71], v[96:97], v[72:73] neg_lo:[0,1,0] neg_hi:[0,1,0]
    v_mfma_f32_16x16x32_bf16 v[80:83], v[172:175], v[44:47], v[80:83]
    v_pk_fma_f32 v[88:89], v[70:71], v[94:95], v[88:89]
    v_pk_fma_f32 v[18:19], v[74:75], v[94:95], v[18:19]
    v_pk_fma_f32 v[68:69], v[68:69], s[62:63], v[88:89] neg_lo:[0,0,1] neg_hi:[0,0,1]
    s_waitcnt lgkmcnt(0)
    v_mfma_f32_16x16x32_bf16 v[76:79], v[176:179], v[32:35], v[76:79]
    v_pk_fma_f32 v[72:73], v[72:73], s[62:63], v[18:19] neg_lo:[0,0,1] neg_hi:[0,0,1]
    v_pk_add_f32 v[70:71], v[88:89], v[88:89] op_sel:[0,1] op_sel_hi:[0,1] neg_hi:[0,1]
    v_mfma_f32_16x16x32_bf16 v[80:83], v[176:179], v[48:51], v[80:83]
    v_pk_add_f32 v[74:75], v[18:19], v[18:19] op_sel:[0,1] op_sel_hi:[0,1] neg_hi:[1,0]
    v_pk_add_f32 v[88:89], v[68:69], v[72:73] op_sel:[0,1] op_sel_hi:[0,1] neg_hi:[0,1]
    v_pk_add_f32 v[72:73], v[72:73], v[68:69] op_sel:[0,1] op_sel_hi:[0,1] neg_lo:[0,1] neg_hi:[1,1]
    s_cmp_lg_u32 s36, 0
    s_cbranch_scc1 k1_nsp
    s_mov_b64 exec, vcc
    v_pk_add_f32 v[18:19], v[56:57], v[58:59]
    v_pk_add_f32 v[56:57], v[56:57], v[58:59] neg_lo:[0,1] neg_hi:[0,1]
    v_pk_add_f32 v[16:17], v[52:53], v[54:55] op_sel:[1,1] op_sel_hi:[1,1] neg_lo:[0,1]
    v_mul_f32 v84, s45, v56
    v_mul_f32 v56, s45, -v57
    v_fma_f32 v85, s45, v52, v16
    v_fma_f32 v57, s45, -v54, -v17
    v_fma_f32 v55, s45, v52, -v16
    v_fma_f32 v59, s45, v54, -v17
    v_sub_f32 v54, v18, v19
    v_add_f32 v58, v18, v19
    v_pk_add_f32 v[18:19], v[64:65], v[66:67]
    v_pk_add_f32 v[64:65], v[64:65], v[66:67] neg_lo:[0,1] neg_hi:[0,1]
    v_pk_add_f32 v[16:17], v[60:61], v[62:63] op_sel:[1,1] op_sel_hi:[1,1] neg_lo:[0,1]
    v_mul_f32 v86, s45, v64
    v_mul_f32 v64, s45, -v65
    v_fma_f32 v87, s45, v60, v16
    v_fma_f32 v65, s45, -v62, -v17
    v_fma_f32 v63, s45, v60, -v16
    v_fma_f32 v67, s45, v62, -v17
    v_sub_f32 v62, v18, v19
    v_add_f32 v66, v18, v19
    v_pk_add_f32 v[18:19], v[72:73], v[74:75]
    v_pk_add_f32 v[72:73], v[72:73], v[74:75] neg_lo:[0,1] neg_hi:[0,1]
    v_pk_add_f32 v[16:17], v[68:69], v[70:71] op_sel:[1,1] op_sel_hi:[1,1] neg_lo:[0,1]
    v_mul_f32 v88, s45, v72
    v_mul_f32 v72, s45, -v73
    v_fma_f32 v89, s45, v68, v16
    v_fma_f32 v73, s45, -v70, -v17
    v_fma_f32 v71, s45, v68, -v16
    v_fma_f32 v75, s45, v70, -v17
    v_sub_f32 v70, v18, v19
    v_add_f32 v74, v18, v19
    v_pk_add_f32 v[18:19], v[80:81], v[82:83]
    v_pk_add_f32 v[80:81], v[80:81], v[82:83] neg_lo:[0,1] neg_hi:[0,1]
    v_pk_add_f32 v[16:17], v[76:77], v[78:79] op_sel:[1,1] op_sel_hi:[1,1] neg_lo:[0,1]
    v_mul_f32 v90, s45, v80
    v_mul_f32 v80, s45, -v81
    v_fma_f32 v91, s45, v76, v16
    v_fma_f32 v81, s45, -v78, -v17
    v_fma_f32 v79, s45, v76, -v16
    v_fma_f32 v83, s45, v78, -v17
    v_sub_f32 v78, v18, v19
    v_add_f32 v82, v18, v19
    s_mov_b64 exec, s[60:61]
k1_nsp:
    s_nop 4
    v_mul_f32 v16, v81, v93
    v_mul_f32 v17, v77, v93
    v_fma_f32 v77, v77, v92, v16
    v_fma_f32 v81, v81, v92, -v17
    v_pk_fma_f32 v[90:91], v[82:83], v[96:97], v[76:77]
    v_pk_fma_f32 v[18:19], v[78:79], v[96:97], v[80:81] neg_lo:[0,1,0] neg_hi:[0,1,0]
    v_pk_fma_f32 v[90:91], v[78:79], v[94:95], v[90:91]
    v_pk_fma_f32 v[18:19], v[82:83], v[94:95], v[18:19]
    v_pk_fma_f32 v[76:77], v[76:77], s[62:63], v[90:91] neg_lo:[0,0,1] neg_hi:[0,0,1]
    v_pk_fma_f32 v[80:81], v[80:81], s[62:63], v[18:19] neg_lo:[0,0,1] neg_hi:[0,0,1]
    v_pk_add_f32 v[78:79], v[90:91], v[90:91] op_sel:[0,1] op_sel_hi:[0,1] neg_hi:[0,1]
    v_pk_add_f32 v[82:83], v[18:19], v[18:19] op_sel:[0,1] op_sel_hi:[0,1] neg_hi:[1,0]
    v_pk_add_f32 v[90:91], v[76:77], v[80:81] op_sel:[0,1] op_sel_hi:[0,1] neg_hi:[0,1]
    v_pk_add_f32 v[80:81], v[80:81], v[76:77] op_sel:[0,1] op_sel_hi:[0,1] neg_lo:[0,1] neg_hi:[1,1]
    s_mov_b64 exec, -1
    s_cmp_eq_u32 s40, 1
    s_cbranch_scc1 k1_eO
    v_cvt_pk_bf16_f32 v116, v54, v58
    v_cvt_pk_bf16_f32 v117, v62, v66
    v_cvt_pk_bf16_f32 v118, v70, v74
    v_cvt_pk_bf16_f32 v119, v78, v82
    buffer_store_dwordx4 v[116:119], v12, s[24:27], s46 offen
    s_add_u32 s46, s46, 4096
    v_cvt_pk_bf16_f32 v120, v55, v59
    v_cvt_pk_bf16_f32 v121, v63, v67
    v_cvt_pk_bf16_f32 v122, v71, v75
    v_cvt_pk_bf16_f32 v123, v79, v83
    buffer_store_dwordx4 v[120:123], v12, s[24:27], s46 offen
    s_add_u32 s46, s46, 4096
    v_cvt_pk_bf16_f32 v124, v85, v57
    v_cvt_pk_bf16_f32 v125, v87, v65
    v_cvt_pk_bf16_f32 v126, v89, v73
    v_cvt_pk_bf16_f32 v127, v91, v81
    buffer_store_dwordx4 v[124:127], v12, s[24:27], s46 offen
    s_add_u32 s46, s46, 4096
    v_cvt_pk_bf16_f32 v128, v84, v56
    v_cvt_pk_bf16_f32 v129, v86, v64
    v_cvt_pk_bf16_f32 v130, v88, v72
    v_cvt_pk_bf16_f32 v131, v90, v80
    buffer_store_dwordx4 v[128:131], v12, s[24:27], s46 offen
    s_endpgm
k1_eO:
    v_and_b32 v7, 32, v0
    v_lshlrev_b32 v7, 3, v7
    v_and_b32 v6, 1, v3
    v_lshl_add_u32 v7, v6, 3, v7
    v_lshl_add_u32 v7, v2, 4, v7
    s_lshl_b32 s43, s36, 6
    s_add_u32 s43, s43, s49
    s_lshl_b32 s43, s43, 9
    s_add_u32 s43, s43, 5767168
    v_cvt_pk_bf16_f32 v116, v54, v62
    v_cvt_pk_bf16_f32 v117, v70, v78
    buffer_store_dwordx2 v[116:117], v7, s[24:27], s43 offen
    s_add_u32 s43, s43, 16384
    v_cvt_pk_bf16_f32 v118, v58, v66
    v_cvt_pk_bf16_f32 v119, v74, v82
    buffer_store_dwordx2 v[118:119], v7, s[24:27], s43 offen
    s_add_u32 s43, s43, 114688
    v_cvt_pk_bf16_f32 v120, v55, v63
    v_cvt_pk_bf16_f32 v121, v71, v79
    buffer_store_dwordx2 v[120:121], v7, s[24:27], s43 offen
    s_add_u32 s43, s43, 16384
    v_cvt_pk_bf16_f32 v122, v59, v67
    v_cvt_pk_bf16_f32 v123, v75, v83
    buffer_store_dwordx2 v[122:123], v7, s[24:27], s43 offen
    s_add_u32 s43, s43, 114688
    v_cvt_pk_bf16_f32 v124, v85, v87
    v_cvt_pk_bf16_f32 v125, v89, v91
    buffer_store_dwordx2 v[124:125], v7, s[24:27], s43 offen
    s_add_u32 s43, s43, 16384
    v_cvt_pk_bf16_f32 v126, v57, v65
    v_cvt_pk_bf16_f32 v127, v73, v81
    buffer_store_dwordx2 v[126:127], v7, s[24:27], s43 offen
    s_add_u32 s43, s43, 114688
    v_cvt_pk_bf16_f32 v128, v84, v86
    v_cvt_pk_bf16_f32 v129, v88, v90
    buffer_store_dwordx2 v[128:129], v7, s[24:27], s43 offen
    s_add_u32 s43, s43, 16384
    v_cvt_pk_bf16_f32 v130, v56, v64
    v_cvt_pk_bf16_f32 v131, v72, v80
    buffer_store_dwordx2 v[130:131], v7, s[24:27], s43 offen
    s_endpgm
k1_mW:
    v_lshl_add_u32 v5, v3, 4, s36
    v_cvt_f32_u32 v5, v5
    v_lshlrev_b32 v10, 3, v1
    v_mul_f32 v5, 0x3b000000, v5
    s_lshl_b32 s46, s39, 4
    s_add_u32 s46, s46, s36
    s_lshl_b32 s46, s46, 10
    s_add_u32 s46, s46, 4718592
    v_add_f32 v6, v5, v5
    v_cos_f32 v92, v5
    v_sin_f32 v96, v5
    v_add_f32 v7, v6, v5
    v_cos_f32 v100, v6
    v_sin_f32 v104, v6
    v_cos_f32 v108, v7
    v_sin_f32 v112, v7
    v_add_f32 v5, 0x3c000000, v5
    v_add_f32 v6, v5, v5
    v_cos_f32 v93, v5
    v_sin_f32 v97, v5
    v_add_f32 v7, v6, v5
    v_cos_f32 v101, v6
    v_sin_f32 v105, v6
    v_cos_f32 v109, v7
    v_sin_f32 v113, v7
    v_add_f32 v5, 0x3c000000, v5
    v_add_f32 v6, v5, v5
    v_cos_f32 v94, v5
    v_sin_f32 v98, v5
    v_add_f32 v7, v6, v5
    v_cos_f32 v102, v6
    v_sin_f32 v106, v6
    v_cos_f32 v110, v7
    v_sin_f32 v114, v7
    v_add_f32 v5, 0x3c000000, v5
    v_add_f32 v6, v5, v5
    v_cos_f32 v95, v5
    v_sin_f32 v99, v5
    v_add_f32 v7, v6, v5
    v_cos_f32 v103, v6
    v_sin_f32 v107, v6
    v_cos_f32 v111, v7
    v_sin_f32 v115, v7
    s_waitcnt vmcnt(0)
    s_barrier
    ds_read_b64_tr_b16 v[116:117], v10 offset:4096
    ds_read_b64_tr_b16 v[118:119], v10 offset:4608
    ds_read_b64_tr_b16 v[120:121], v10 offset:5120
    ds_read_b64_tr_b16 v[122:123], v10 offset:5632
    ds_read_b64_tr_b16 v[124:125], v10 offset:6144
    ds_read_b64_tr_b16 v[126:127], v10 offset:6656
    ds_read_b64_tr_b16 v[128:129], v10 offset:7168
    ds_read_b64_tr_b16 v[130:131], v10 offset:7680
    ds_read_b64_tr_b16 v[132:133], v10 offset:12288
    ds_read_b64_tr_b16 v[134:135], v10 offset:12800
    ds_read_b64_tr_b16 v[136:137], v10 offset:13312
    ds_read_b64_tr_b16 v[138:139], v10 offset:13824
    ds_read_b64_tr_b16 v[140:141], v10 offset:14336
    ds_read_b64_tr_b16 v[142:143], v10 offset:14848
    s_waitcnt lgkmcnt(12)
    v_mfma_f32_16x16x32_bf16 v[60:63], v[20:23], v[116:119], 0
    v_mfma_f32_16x16x32_bf16 v[64:67], v[36:39], v[116:119], 0
    ds_read_b64_tr_b16 v[144:145], v10 offset:15360
    ds_read_b64_tr_b16 v[146:147], v10 offset:15872
    s_waitcnt lgkmcnt(12)
    v_mfma_f32_16x16x32_bf16 v[60:63], v[24:27], v[120:123], v[60:63]
    v_mfma_f32_16x16x32_bf16 v[64:67], v[40:43], v[120:123], v[64:67]
    ds_read_b64_tr_b16 v[148:149], v10 offset:0
    ds_read_b64_tr_b16 v[150:151], v10 offset:512
    s_waitcnt lgkmcnt(12)
    v_mfma_f32_16x16x32_bf16 v[60:63], v[28:31], v[124:127], v[60:63]
    v_mfma_f32_16x16x32_bf16 v[64:67], v[44:47], v[124:127], v[64:67]
    ds_read_b64_tr_b16 v[152:153], v10 offset:1024
    ds_read_b64_tr_b16 v[154:155], v10 offset:1536
    s_waitcnt lgkmcnt(12)
    v_mfma_f32_16x16x32_bf16 v[60:63], v[32:35], v[128:131], v[60:63]
    v_mfma_f32_16x16x32_bf16 v[64:67], v[48:51], v[128:131], v[64:67]
    ds_read_b64_tr_b16 v[156:157], v10 offset:2048
    ds_read_b64_tr_b16 v[158:159], v10 offset:2560
    s_waitcnt lgkmcnt(12)
    v_mfma_f32_16x16x32_bf16 v[76:79], v[20:23], v[132:135], 0
    v_mfma_f32_16x16x32_bf16 v[80:83], v[36:39], v[132:135], 0
    ds_read_b64_tr_b16 v[160:161], v10 offset:3072
    ds_read_b64_tr_b16 v[162:163], v10 offset:3584
    s_waitcnt lgkmcnt(12)
    v_mfma_f32_16x16x32_bf16 v[76:79], v[24:27], v[136:139], v[76:79]
    v_mov_b32 v85, v60
    v_mov_b32 v89, v64
    v_mfma_f32_16x16x32_bf16 v[80:83], v[40:43], v[136:139], v[80:83]
    v_pk_mul_f32 v[16:17], v[64:65], v[96:97]
    v_pk_mul_f32 v[18:19], v[60:61], v[96:97]
    ds_read_b64_tr_b16 v[164:165], v10 offset:8192
    ds_read_b64_tr_b16 v[166:167], v10 offset:8704
    s_waitcnt lgkmcnt(12)
    v_mfma_f32_16x16x32_bf16 v[76:79], v[28:31], v[140:143], v[76:79]
    v_pk_fma_f32 v[60:61], v[60:61], v[92:93], v[16:17]
    v_pk_fma_f32 v[64:65], v[64:65], v[92:93], v[18:19] neg_lo:[0,0,1] neg_hi:[0,0,1]
    v_mfma_f32_16x16x32_bf16 v[80:83], v[44:47], v[140:143], v[80:83]
    v_pk_mul_f32 v[16:17], v[66:67], v[98:99]
    v_pk_mul_f32 v[18:19], v[62:63], v[98:99]
    ds_read_b64_tr_b16 v[168:169], v10 offset:9216
    ds_read_b64_tr_b16 v[170:171], v10 offset:9728
    s_waitcnt lgkmcnt(12)
    v_mfma_f32_16x16x32_bf16 v[76:79], v[32:35], v[144:147], v[76:79]
    v_pk_fma_f32 v[62:63], v[62:63], v[94:95], v[16:17]
    v_mfma_f32_16x16x32_bf16 v[80:83], v[48:51], v[144:147], v[80:83]
    v_pk_fma_f32 v[66:67], v[66:67], v[94:95], v[18:19] neg_lo:[0,0,1] neg_hi:[0,0,1]
    ds_read_b64_tr_b16 v[172:173], v10 offset:10240
    ds_read_b64_tr_b16 v[174:175], v10 offset:10752
    s_waitcnt lgkmcnt(12)
    v_mfma_f32_16x16x32_bf16 v[52:55], v[20:23], v[148:151], 0
    v_mfma_f32_16x16x32_bf16 v[56:59], v[36:39], v[148:151], 0
    ds_read_b64_tr_b16 v[176:177], v10 offset:11264
    ds_read_b64_tr_b16 v[178:179], v10 offset:11776
    s_waitcnt lgkmcnt(12)
    v_mfma_f32_16x16x32_bf16 v[52:55], v[24:27], v[152:155], v[52:55]
    v_mov_b32 v87, v76
    v_mov_b32 v91, v80
    v_mfma_f32_16x16x32_bf16 v[56:59], v[40:43], v[152:155], v[56:59]
    v_pk_fma_f32 v[16:17], v[80:81], v[112:113], v[60:61]
    v_pk_fma_f32 v[18:19], v[76:77], v[112:113], v[64:65] neg_lo:[0,1,0] neg_hi:[0,1,0]
    s_waitcnt lgkmcnt(10)
    v_mfma_f32_16x16x32_bf16 v[52:55], v[28:31], v[156:159], v[52:55]
    v_pk_fma_f32 v[76:77], v[76:77], v[108:109], v[16:17]
    v_pk_fma_f32 v[80:81], v[80:81], v[108:109], v[18:19]
    v_mfma_f32_16x16x32_bf16 v[56:59], v[44:47], v[156:159], v[56:59]
    v_pk_fma_f32 v[60:61], v[60:61], s[62:63], v[76:77] neg_lo:[0,0,1] neg_hi:[0,0,1]
    v_pk_fma_f32 v[64:65], v[64:65], s[62:63], v[80:81] neg_lo:[0,0,1] neg_hi:[0,0,1]
    v_pk_fma_f32 v[16:17], v[82:83], v[114:115], v[62:63]
    s_waitcnt lgkmcnt(8)
    v_mfma_f32_16x16x32_bf16 v[52:55], v[32:35], v[160:163], v[52:55]
    v_pk_fma_f32 v[18:19], v[78:79], v[114:115], v[66:67] neg_lo:[0,1,0] neg_hi:[0,1,0]
    v_pk_fma_f32 v[78:79], v[78:79], v[110:111], v[16:17]
    v_mfma_f32_16x16x32_bf16 v[56:59], v[48:51], v[160:163], v[56:59]
    v_pk_fma_f32 v[82:83], v[82:83], v[110:111], v[18:19]
    v_pk_fma_f32 v[62:63], v[62:63], s[62:63], v[78:79] neg_lo:[0,0,1] neg_hi:[0,0,1]
    v_pk_fma_f32 v[66:67], v[66:67], s[62:63], v[82:83] neg_lo:[0,0,1] neg_hi:[0,0,1]
    s_waitcnt lgkmcnt(6)
    v_mfma_f32_16x16x32_bf16 v[68:71], v[20:23], v[164:167], 0
    v_mfma_f32_16x16x32_bf16 v[72:75], v[36:39], v[164:167], 0
    s_waitcnt lgkmcnt(4)
    v_mfma_f32_16x16x32_bf16 v[68:71], v[24:27], v[168:171], v[68:71]
    v_mov_b32 v84, v52
    v_mfma_f32_16x16x32_bf16 v[72:75], v[40:43], v[168:171], v[72:75]
    v_mov_b32 v88, v56
    s_waitcnt lgkmcnt(2)
    v_mfma_f32_16x16x32_bf16 v[68:71], v[28:31], v[172:175], v[68:71]
    v_mfma_f32_16x16x32_bf16 v[72:75], v[44:47], v[172:175], v[72:75]
    s_waitcnt lgkmcnt(0)
    v_mfma_f32_16x16x32_bf16 v[68:71], v[32:35], v[176:179], v[68:71]
    v_mfma_f32_16x16x32_bf16 v[72:75], v[48:51], v[176:179], v[72:75]
    s_nop 6
    v_mov_b32 v86, v68
    v_mov_b32 v90, v72
    v_pk_fma_f32 v[16:17], v[72:73], v[104:105], v[52:53]
    v_pk_fma_f32 v[18:19], v[68:69], v[104:105], v[56:57] neg_lo:[0,1,0] neg_hi:[0,1,0]
    v_pk_fma_f32 v[68:69], v[68:69], v[100:101], v[16:17]
    v_pk_fma_f32 v[72:73], v[72:73], v[100:101], v[18:19]
    v_pk_fma_f32 v[52:53], v[52:53], s[62:63], v[68:69] neg_lo:[0,0,1] neg_hi:[0,0,1]
    v_pk_fma_f32 v[56:57], v[56:57], s[62:63], v[72:73] neg_lo:[0,0,1] neg_hi:[0,0,1]
    v_pk_fma_f32 v[16:17], v[74:75], v[106:107], v[54:55]
    v_pk_fma_f32 v[18:19], v[70:71], v[106:107], v[58:59] neg_lo:[0,1,0] neg_hi:[0,1,0]
    v_pk_fma_f32 v[70:71], v[70:71], v[102:103], v[16:17]
    v_pk_fma_f32 v[74:75], v[74:75], v[102:103], v[18:19]
    v_pk_fma_f32 v[54:55], v[54:55], s[62:63], v[70:71] neg_lo:[0,0,1] neg_hi:[0,0,1]
    v_pk_fma_f32 v[58:59], v[58:59], s[62:63], v[74:75] neg_lo:[0,0,1] neg_hi:[0,0,1]
    s_cmp_lg_u32 s36, 0
    s_cbranch_scc1 k1_nsw
    v_pk_add_f32 v[18:19], v[88:89], v[90:91]
    v_pk_add_f32 v[88:89], v[88:89], v[90:91] neg_lo:[0,1] neg_hi:[0,1]
    v_pk_add_f32 v[16:17], v[84:85], v[86:87] op_sel:[1,1] op_sel_hi:[1,1] neg_lo:[0,1]
    v_mul_f32 v5, s45, v88
    v_mul_f32 v88, s45, -v89
    v_fma_f32 v6, s45, v84, v16
    v_fma_f32 v89, s45, -v86, -v17
    v_fma_f32 v87, s45, v84, -v16
    v_fma_f32 v91, s45, v86, -v17
    v_sub_f32 v86, v18, v19
    v_add_f32 v90, v18, v19
    v_cvt_pk_bf16_f32 v86, v86, 0
    v_cvt_pk_bf16_f32 v87, v87, v91
    v_cvt_pk_bf16_f32 v85, v6, v89
    v_cvt_pk_bf16_f32 v84, v5, v88
k1_nsw:
    v_add_u32 v7, s36, v3
    v_cmp_eq_u32 vcc, 0, v7
    v_pk_add_f32 v[132:133], v[68:69], v[76:77]
    v_pk_add_f32 v[134:135], v[70:71], v[78:79]
    v_pk_add_f32 v[136:137], v[72:73], v[80:81]
    v_pk_add_f32 v[138:139], v[74:75], v[82:83]
    v_cvt_pk_bf16_f32 v116, v132, v136
    v_cvt_pk_bf16_f32 v117, v133, v137
    v_cvt_pk_bf16_f32 v118, v134, v138
    v_cvt_pk_bf16_f32 v119, v135, v139
    v_cndmask_b32 v116, v116, v86, vcc
    buffer_store_dwordx4 v[116:119], v4, s[24:27], s46 offen sc0 sc1
    s_add_u32 s46, s46, 4096
    v_pk_add_f32 v[140:141], v[68:69], v[76:77] neg_lo:[0,1] neg_hi:[0,1]
    v_pk_add_f32 v[142:143], v[70:71], v[78:79] neg_lo:[0,1] neg_hi:[0,1]
    v_pk_add_f32 v[144:145], v[80:81], v[72:73] neg_lo:[0,1] neg_hi:[0,1]
    v_pk_add_f32 v[146:147], v[82:83], v[74:75] neg_lo:[0,1] neg_hi:[0,1]
    v_cvt_pk_bf16_f32 v120, v140, v144
    v_cvt_pk_bf16_f32 v121, v141, v145
    v_cvt_pk_bf16_f32 v122, v142, v146
    v_cvt_pk_bf16_f32 v123, v143, v147
    v_cndmask_b32 v120, v120, v87, vcc
    buffer_store_dwordx4 v[120:123], v4, s[24:27], s46 offen sc0 sc1
    s_add_u32 s46, s46, 4096
    v_pk_add_f32 v[132:133], v[52:53], v[64:65] neg_lo:[0,1] neg_hi:[0,1]
    v_pk_add_f32 v[134:135], v[54:55], v[66:67] neg_lo:[0,1] neg_hi:[0,1]
    v_pk_add_f32 v[136:137], v[56:57], v[60:61] neg_lo:[1,1] neg_hi:[1,1]
    v_pk_add_f32 v[138:139], v[58:59], v[62:63] neg_lo:[1,1] neg_hi:[1,1]
    v_cvt_pk_bf16_f32 v124, v132, v136
    v_cvt_pk_bf16_f32 v125, v133, v137
    v_cvt_pk_bf16_f32 v126, v134, v138
    v_cvt_pk_bf16_f32 v127, v135, v139
    v_cndmask_b32 v124, v124, v85, vcc
    buffer_store_dwordx4 v[124:127], v4, s[24:27], s46 offen sc0 sc1
    s_add_u32 s46, s46, 4096
    v_pk_add_f32 v[140:141], v[52:53], v[64:65]
    v_pk_add_f32 v[142:143], v[54:55], v[66:67]
    v_pk_add_f32 v[144:145], v[56:57], v[60:61] neg_lo:[0,1] neg_hi:[0,1]
    v_pk_add_f32 v[146:147], v[58:59], v[62:63] neg_lo:[0,1] neg_hi:[0,1]
    v_cvt_pk_bf16_f32 v128, v140, v144
    v_cvt_pk_bf16_f32 v129, v141, v145
    v_cvt_pk_bf16_f32 v130, v142, v146
    v_cvt_pk_bf16_f32 v131, v143, v147
    v_cndmask_b32 v128, v128, v84, vcc
    buffer_store_dwordx4 v[128:131], v4, s[24:27], s46 offen sc0 sc1
    s_endpgm
k1_f2:
    s_cmp_lt_u32 s38, 28
    s_cbranch_scc1 k1_exit
    s_sub_u32 s45, s38, 28
    s_branch k1_f3
k1_f:
    s_cmp_lt_u32 s36, 6
    s_cbranch_scc1 k1_ncl
    s_lshl_b32 s43, s2, 1
    s_add_u32 s43, s43, s36
    s_lshl_b32 s43, s43, 12
    v_mov_b64 v[116:117], -1
    v_mov_b64 v[118:119], -1
    s_add_u32 s43, s43, 18849792
    s_lshr_b32 s44, s2, 7
    s_mul_i32 s44, s44, 16777216
    s_and_b32 s45, s2, 127
    s_lshl_b32 s46, s45, 10
    s_add_u32 s46, s46, s44
    s_add_u32 s46, s46, 21037056
    v_mov_b32 v5, v4
    s_waitcnt lgkmcnt(0)
    buffer_store_dwordx4 v[116:119], v4, s[24:27], s43 offen offset:0
    buffer_store_dwordx4 v[116:119], v4, s[24:27], s43 offen offset:1024
    buffer_store_dwordx4 v[116:119], v4, s[24:27], s43 offen offset:2048
    buffer_store_dwordx4 v[116:119], v4, s[24:27], s43 offen offset:3072
    s_cmp_eq_u32 s36, 6
    s_cbranch_scc1 k1_cl6
    s_and_b32 s45, s2, 1
    s_lshl_b32 s45, s45, 9
    s_sub_u32 s46, s46, s45
    s_add_u32 s46, s46, 132096
    s_lshl_b32 s45, s2, 7
    s_add_u32 s45, s45, 20971520
    v_add_u32 v5, s45, v4
    s_mov_b32 s45, 0x3f803f80
    v_writelane_b32 v5, s46, 8
    s_mov_b32 s46, 0
    v_writelane_b32 v116, s45, 8
    v_writelane_b32 v117, s45, 8
    v_writelane_b32 v118, s45, 8
    v_writelane_b32 v119, s45, 8
    s_mov_b64 exec, 0x1ff
k1_cl6:
    buffer_store_dwordx4 v[116:119], v5, s[24:27], s46 offen
    s_mov_b64 exec, -1
k1_ncl:
    s_cmp_lt_u32 s38, 4
    s_cbranch_scc1 k1_exit
    s_mov_b32 s45, s38
k1_f3:
    s_and_b32 s36, s36, 3
    s_cmp_lt_u32 s36, 2
    s_cbranch_scc1 k1_g
    v_mov_b32 v13, 0
    v_mov_b64 v[92:93], 0
    v_mov_b64 v[94:95], 0
    s_getpc_b64 s[54:55]
k1_pc:
    s_sub_u32 s54, s54, k1_pc-k1_kernel
    s_subb_u32 s55, s55, 0
    s_lshl_b32 s43, s45, 1
    s_add_u32 s43, s43, s36
    s_sub_u32 s43, s43, 2
    s_lshl_b32 s43, s43, 10
    v_add_u32 v6, s43, v4
    v_min_u32 v6, HOT_END-k1_kernel-8, v6
    global_load_dwordx2 v[16:17], v6, s[54:55]
    s_mov_b32 s47, 0
    s_waitcnt lgkmcnt(0)
    s_mov_b64 s[28:29], s[6:7]
    s_mov_b64 s[30:31], s[26:27]
    s_mov_b64 s[32:33], s[8:9]
    s_mov_b64 s[34:35], s[26:27]
    s_branch k1_g2
k1_g:
    s_lshl_b32 s43, s39, 1
    s_add_u32 s43, s43, s36
    s_and_b32 s44, s45, 0x18
    s_lshl_b32 s47, s44, 1
    s_and_b32 s44, s43, 15
    s_add_u32 s47, s47, s44
    s_lshr_b32 s44, s43, 4
    s_lshl_b32 s44, s44, 8
    s_add_u32 s47, s47, s44
    s_and_b32 s44, s45, 4
    s_lshl_b32 s44, s44, 8
    s_add_u32 s47, s47, s44
    s_mul_i32 s47, s47, 514
    s_and_b32 s46, s45, 0x1c
    s_lshl_b32 s46, s46, 8
    s_lshl_b32 s43, s43, 4
    s_add_u32 s46, s46, s43
    s_add_u32 s46, s46, 2097152
    v_lshlrev_b32 v13, 3, v1
    s_waitcnt lgkmcnt(0)
    s_mov_b32 s28, s6
    s_mov_b32 s29, s7
    s_mov_b32 s30, 1052672
    s_mov_b32 s31, 0x00020000
    s_mov_b32 s32, s8
    s_mov_b32 s33, s9
    s_mov_b32 s34, 1052672
    s_mov_b32 s35, 0x00020000
    buffer_load_dwordx2 v[20:21], v13, s[28:31], s47 offen offset:2
    buffer_load_dwordx2 v[22:23], v13, s[32:35], s47 offen offset:2
    s_add_u32 s47, s47, 32896
    v_and_b32 v5, 1, v3
    v_sub_u32 v6, 0, v5
    v_lshl_or_b32 v7, v2, 2, 1
    v_xor_b32 v7, v6, v7
    v_mul_u32_u24 v10, 65, v5
    v_add_u32 v7, v10, v7
    v_or_b32 v6, 1, v6
    v_lshrrev_b32 v8, 1, v3
    v_xor_b32 v5, v5, v8
    v_lshl_or_b32 v8, v5, 1, v8
    v_lshlrev_b32 v8, 19, v8
    v_and_b32 v5, 3, v7
    v_lshl_add_u32 v92, v5, 17, v8
    v_lshrrev_b32 v5, 2, v7
    v_lshl_add_u32 v92, v5, 13, v92
    v_add_u32 v7, v7, v6
    v_and_b32 v5, 3, v7
    v_lshl_add_u32 v93, v5, 17, v8
    v_lshrrev_b32 v5, 2, v7
    v_lshl_add_u32 v93, v5, 13, v93
    v_add_u32 v7, v7, v6
    v_and_b32 v5, 3, v7
    v_lshl_add_u32 v94, v5, 17, v8
    v_lshrrev_b32 v5, 2, v7
    v_lshl_add_u32 v94, v5, 13, v94
    v_add_u32 v7, v7, v6
    v_and_b32 v5, 3, v7
    v_lshl_add_u32 v95, v5, 17, v8
    v_lshrrev_b32 v5, 2, v7
    v_lshl_add_u32 v95, v5, 13, v95
    s_mov_b32 s43, 1048576
    v_writelane_b32 v95, s43, 15
    s_mov_b32 s43, 1572864
    v_writelane_b32 v95, s43, 31
    s_mov_b32 s43, 524288
    v_writelane_b32 v95, s43, 47
    s_mov_b32 s43, 0
    v_writelane_b32 v95, s43, 63
    s_mov_b32 s52, 0x05040100
    s_mov_b32 s53, 0x07060302
k1_g2:
    s_cmp_ge_u32 s38, 24
    s_cbranch_scc1 k1_fw
    s_cmp_lt_u32 s38, 8
    s_cbranch_scc1 k1_fo
    s_mul_i32 s43, s36, 4160
    v_mul_u32_u24 v10, 1040, v3
    v_lshl_add_u32 v10, v2, 4, v10
    v_add_u32 v10, s43, v10
    v_lshlrev_b32 v12, 2, v3
    s_and_b32 s43, s48, 0xfc
    s_lshl_b32 s43, s43, 6
    s_and_b32 s44, s48, 1
    s_lshl_b32 s44, s44, 7
    s_add_u32 s43, s43, s44
    s_and_b32 s44, s48, 2
    s_lshl_b32 s44, s44, 5
    s_add_u32 s43, s43, s44
    s_lshl_b32 s44, s36, 4
    s_add_u32 s43, s43, s44
    s_add_u32 s43, s43, 4194304
    v_mov_b32 v5, 0
    v_mov_b32 v6, 0
    v_mov_b32 v7, 0
    v_mov_b32 v8, 0
    s_mov_b32 s44, 0x3f803f80
    v_cmp_eq_u32 vcc, 0, v2
    s_barrier
    ds_read_b128 v[116:119], v10 offset:0
    ds_read_b128 v[120:123], v10 offset:256
    ds_read_b128 v[124:127], v10 offset:512
    ds_read_b128 v[128:131], v10 offset:768
    s_cmp_ge_u32 s36, 2
    s_cbranch_scc1 k1_lta
    buffer_load_dwordx2 v[24:25], v13, s[28:31], s47 offen offset:2
    buffer_load_dwordx2 v[26:27], v13, s[32:35], s47 offen offset:2
    s_add_u32 s47, s47, 32896
    buffer_load_dwordx2 v[28:29], v13, s[28:31], s47 offen offset:2
    buffer_load_dwordx2 v[30:31], v13, s[32:35], s47 offen offset:2
    s_add_u32 s47, s47, 32896
    buffer_load_dwordx2 v[32:33], v13, s[28:31], s47 offen offset:2
    buffer_load_dwordx2 v[34:35], v13, s[32:35], s47 offen offset:2
k1_lta:
    s_waitcnt lgkmcnt(3)
    v_dot2c_f32_bf16 v5, v116, v116
    v_dot2c_f32_bf16 v6, s44, v116
    v_dot2c_f32_bf16 v7, v117, v117
    v_dot2c_f32_bf16 v8, s44, v117
    v_dot2c_f32_bf16 v5, v118, v118
    v_dot2c_f32_bf16 v6, s44, v118
    v_dot2c_f32_bf16 v7, v119, v119
    v_dot2c_f32_bf16 v8, s44, v119
    s_waitcnt lgkmcnt(2)
    v_dot2c_f32_bf16 v5, v120, v120
    v_dot2c_f32_bf16 v6, s44, v120
    v_dot2c_f32_bf16 v7, v121, v121
    v_dot2c_f32_bf16 v8, s44, v121
    v_dot2c_f32_bf16 v5, v122, v122
    v_dot2c_f32_bf16 v6, s44, v122
    v_dot2c_f32_bf16 v7, v123, v123
    v_dot2c_f32_bf16 v8, s44, v123
    s_waitcnt lgkmcnt(1)
    v_dot2c_f32_bf16 v5, v124, v124
    v_dot2c_f32_bf16 v6, s44, v124
    v_dot2c_f32_bf16 v7, v125, v125
    v_dot2c_f32_bf16 v8, s44, v125
    v_dot2c_f32_bf16 v5, v126, v126
    v_dot2c_f32_bf16 v6, s44, v126
    v_dot2c_f32_bf16 v7, v127, v127
    v_dot2c_f32_bf16 v8, s44, v127
    s_waitcnt lgkmcnt(0)
    v_dot2c_f32_bf16 v5, v128, v128
    v_dot2c_f32_bf16 v6, s44, v128
    v_dot2c_f32_bf16 v7, v129, v129
    v_dot2c_f32_bf16 v8, s44, v129
    v_dot2c_f32_bf16 v5, v130, v130
    v_dot2c_f32_bf16 v6, s44, v130
    v_dot2c_f32_bf16 v7, v131, v131
    v_dot2c_f32_bf16 v8, s44, v131
    s_nop 1
    v_add_f32 v5, v5, v7
    v_add_f32 v6, v6, v8
    s_nop 0
    v_add_f32_dpp v5, v5, v5 quad_perm:[1,0,3,2] row_mask:0xf bank_mask:0xf
    v_add_f32_dpp v6, v6, v6 quad_perm:[1,0,3,2] row_mask:0xf bank_mask:0xf
    s_nop 0
    v_add_f32_dpp v5, v5, v5 quad_perm:[2,3,0,1] row_mask:0xf bank_mask:0xf
    v_add_f32_dpp v6, v6, v6 quad_perm:[2,3,0,1] row_mask:0xf bank_mask:0xf
    s_nop 0
    v_add_f32_dpp v5, v5, v5 row_half_mirror row_mask:0xf bank_mask:0xf
    v_add_f32_dpp v6, v6, v6 row_half_mirror row_mask:0xf bank_mask:0xf
    s_nop 0
    v_add_f32_dpp v5, v5, v5 row_mirror row_mask:0xf bank_mask:0xf
    v_add_f32_dpp v6, v6, v6 row_mirror row_mask:0xf bank_mask:0xf
    v_mul_f32 v6, 0x3b000000, v6
    v_mov_b32 v7, 0x3727c5ac
    v_fma_f32 v7, -v6, v6, v7
    v_fmac_f32 v7, 0x3b000000, v5
    v_rsq_f32 v7, v7
    s_mov_b64 exec, vcc
    v_mul_f32 v7, 0x3a000000, v7
    buffer_store_dword v7, v12, s[24:27], s43 offen
    s_mov_b64 exec, -1
    s_waitcnt vmcnt(1)
    s_branch k1_fs
k1_fo:
    v_lshrrev_b32 v8, 2, v2
    v_mul_u32_u24 v5, 1040, v8
    v_and_b32 v6, 3, v2
    v_lshl_add_u32 v5, v6, 3, v5
    v_lshl_add_u32 v5, v3, 5, v5
    s_lshl_b32 s43, s36, 8
    v_add_u32 v10, s43, v5
    v_lshlrev_b32 v7, 14, v6
    v_lshl_add_u32 v7, v3, 6, v7
    v_lshl_add_u32 v7, v8, 4, v7
    s_add_u32 s43, s43, s49
    s_lshl_b32 s43, s43, 9
    s_add_u32 s43, s43, 6291456
    s_barrier
    ds_read_b64_tr_b16 v[116:117], v10 offset:0
    ds_read_b64_tr_b16 v[118:119], v10 offset:4160
    ds_read_b64_tr_b16 v[120:121], v10 offset:8320
    ds_read_b64_tr_b16 v[122:123], v10 offset:12480
    ds_read_b64_tr_b16 v[124:125], v10 offset:128
    ds_read_b64_tr_b16 v[126:127], v10 offset:4288
    ds_read_b64_tr_b16 v[128:129], v10 offset:8448
    ds_read_b64_tr_b16 v[130:131], v10 offset:12608
    s_cmp_ge_u32 s36, 2
    s_cbranch_scc1 k1_ltb
    buffer_load_dwordx2 v[24:25], v13, s[28:31], s47 offen offset:2
    buffer_load_dwordx2 v[26:27], v13, s[32:35], s47 offen offset:2
    s_add_u32 s47, s47, 32896
    buffer_load_dwordx2 v[28:29], v13, s[28:31], s47 offen offset:2
    buffer_load_dwordx2 v[30:31], v13, s[32:35], s47 offen offset:2
    s_add_u32 s47, s47, 32896
    buffer_load_dwordx2 v[32:33], v13, s[28:31], s47 offen offset:2
    buffer_load_dwordx2 v[34:35], v13, s[32:35], s47 offen offset:2
k1_ltb:
    s_waitcnt lgkmcnt(6)
    buffer_store_dwordx4 v[116:119], v7, s[24:27], s43 offen offset:0
    s_waitcnt lgkmcnt(4)
    buffer_store_dwordx4 v[120:123], v7, s[24:27], s43 offen offset:256
    s_add_u32 s43, s43, 65536
    s_waitcnt lgkmcnt(2)
    buffer_store_dwordx4 v[124:127], v7, s[24:27], s43 offen offset:0
    s_waitcnt lgkmcnt(0)
    buffer_store_dwordx4 v[128:131], v7, s[24:27], s43 offen offset:256
    s_waitcnt vmcnt(4)
    s_branch k1_fs
k1_fw:
    s_waitcnt vmcnt(0)
    s_cmp_ge_u32 s36, 2
    s_cbranch_scc1 k1_ltc
    buffer_load_dwordx2 v[24:25], v13, s[28:31], s47 offen offset:2
    buffer_load_dwordx2 v[26:27], v13, s[32:35], s47 offen offset:2
    s_add_u32 s47, s47, 32896
    buffer_load_dwordx2 v[28:29], v13, s[28:31], s47 offen offset:2
    buffer_load_dwordx2 v[30:31], v13, s[32:35], s47 offen offset:2
    s_add_u32 s47, s47, 32896
    buffer_load_dwordx2 v[32:33], v13, s[28:31], s47 offen offset:2
    buffer_load_dwordx2 v[34:35], v13, s[32:35], s47 offen offset:2
k1_ltc:
    s_barrier
    s_waitcnt vmcnt(0)
k1_fs:
    s_cmp_ge_u32 s36, 2
    s_cbranch_scc1 k1_exit
    v_perm_b32 v36, v22, v20, s52
    v_perm_b32 v37, v26, v24, s52
    v_perm_b32 v38, v30, v28, s52
    v_perm_b32 v39, v34, v32, s52
    buffer_store_dwordx4 v[36:39], v92, s[24:27], s46 offen
    v_perm_b32 v40, v22, v20, s53
    v_perm_b32 v41, v26, v24, s53
    v_perm_b32 v42, v30, v28, s53
    v_perm_b32 v43, v34, v32, s53
    buffer_store_dwordx4 v[40:43], v93, s[24:27], s46 offen
    v_perm_b32 v44, v23, v21, s52
    v_perm_b32 v45, v27, v25, s52
    v_perm_b32 v46, v31, v29, s52
    v_perm_b32 v47, v35, v33, s52
    buffer_store_dwordx4 v[44:47], v94, s[24:27], s46 offen
    v_perm_b32 v48, v23, v21, s53
    v_perm_b32 v49, v27, v25, s53
    v_perm_b32 v50, v31, v29, s53
    v_perm_b32 v51, v35, v33, s53
    buffer_store_dwordx4 v[48:51], v95, s[24:27], s46 offen
k1_exit:
    s_endpgm
.globl km_kernel
.p2align 8
.type km_kernel,@function
km_kernel:
    s_load_dwordx2 s[8:9], s[0:1], 80
    s_load_dwordx2 s[12:13], s[0:1], 64
    s_cmp_ge_u32 s2, 256
    s_cbranch_scc1 k4_exit
    v_lshrrev_b32 v1, 6, v0
    s_mov_b32 s17, 0
    v_readfirstlane_b32 s16, v1
    s_mov_b32 s6, 0
    s_mov_b32 s10, 67108864
    s_mov_b32 s11, 0x00020000
    s_mov_b32 s14, 0x200000
    s_mov_b32 s15, 0x00020000
p2_start:
    s_cmp_ge_u32 s16, 4
    s_cbranch_scc1 p2_help
    s_setprio 3
    s_and_b32 s18, s2, 7
    s_lshl_b32 s18, s18, 5
    s_lshr_b32 s19, s2, 3
    s_add_u32 s18, s18, s19
    v_and_b32 v7, 8, v0
    v_lshrrev_b32 v7, 1, v7
    s_lshl_b32 s19, s16, 1
    v_xor_b32 v13, s19, v7
    v_and_b32 v16, 7, v0
    v_bfe_u32 v8, v0, 5, 1
    v_lshl_add_u32 v7, v16, 3, v13
    v_add_u32 v7, v7, v8
    v_and_b32 v8, 16, v0
    v_lshl_or_b32 v4, v7, 13, v8
    v_lshl_or_b32 v5, v7, 7, v8
    s_lshr_b32 s20, s16, 1
    s_lshl_b32 s22, s20, 20
    s_lshl_b32 s21, s18, 5
    s_add_u32 s22, s22, s21
    s_add_u32 s22, s22, s6
    s_add_u32 s23, s22, 0x80000
    s_lshl_b32 s24, s20, 14
    s_add_u32 s24, s24, 20971520
    s_add_u32 s25, s24, 8192
    v_and_b32 v1, 63, v0
    v_lshlrev_b32 v6, 4, v1
    s_lshl_b32 s21, s18, 13
    s_lshl_b32 s19, s16, 11
    s_add_u32 s21, s21, s19
    s_add_u32 s21, s21, 2097152
    s_cmp_eq_u32 s17, 1
    s_cbranch_scc1 p2_late
    v_and_b32 v8, 0x30, v0
    v_and_b32 v4, 62, v7
    v_lshl_or_b32 v4, v4, 13, v8
    s_lshl_b32 s19, s18, 5
    s_add_u32 s22, s22, s19
    s_add_u32 s23, s22, 0x80000
    s_waitcnt lgkmcnt(0)
    buffer_load_dwordx4 v[20:23], v4, s[8:11], s22 offen sc1
    buffer_load_dwordx4 v[24:27], v4, s[8:11], s23 offen sc1
    v_and_b32 v5, 0x30, v0
    v_lshl_or_b32 v5, v16, 8, v5
    v_and_b32 v8, 4, v13
    v_lshl_or_b32 v5, v8, 4, v5
    s_lshl_b32 s24, s20, 12
    s_and_b32 s25, s16, 1
    s_lshl_b32 s25, s25, 7
    s_add_u32 s24, s24, s25
    s_add_u32 s24, s24, 4194304
    s_add_u32 s25, s24, 2048
    buffer_load_dwordx4 v[28:31], v5, s[8:11], s24 offen sc1
    buffer_load_dwordx4 v[32:35], v5, s[8:11], s25 offen sc1
p2_late:
    buffer_load_dwordx4 v[36:39], v6, s[8:11], s21 offen
    buffer_load_dwordx4 v[40:43], v6, s[8:11], s21 offen offset:1024
    v_and_b32 v2, 15, v0
    v_bfe_u32 v3, v0, 4, 2
    s_mov_b32 s26, 0x80008000
    s_lshl_b32 s19, s16, 4
    v_add_u32 v7, s19, v2
    v_cvt_f32_u32 v9, v7
    v_cvt_f32_u32 v8, v3
    v_mul_f32 v9, 0x3c800000, v9
    v_mul_f32 v8, 4.0, v8
    v_mul_f32 v10, v8, v9
    v_and_b32 v11, 1, v2
    v_mul_u32_u24 v11, 0x8000, v11
    v_lshl_or_b32 v11, v11, 16, v11
    v_xor_b32 v12, s26, v11
    v_mul_f32 v14, 0x41500000, v9
    v_cos_f32 v212, v10
    v_sin_f32 v213, v10
    v_mul_f32 v7, 0x3d000000, v10
    v_add_f32 v10, v10, v9
    v_cvt_pk_bf16_f32 v44, v212, v213
    v_cvt_pk_bf16_f32 v60, -v213, v212
    v_cos_f32 v108, v7
    v_sin_f32 v116, v7
    v_xor_b32 v52, v11, v44
    v_xor_b32 v68, v11, v60
    v_cos_f32 v214, v10
    v_sin_f32 v215, v10
    v_mul_f32 v7, 0x3d000000, v10
    v_add_f32 v10, v10, v9
    v_cvt_pk_bf16_f32 v45, v214, v215
    v_cvt_pk_bf16_f32 v61, -v215, v214
    v_cos_f32 v109, v7
    v_sin_f32 v117, v7
    v_xor_b32 v53, v11, v45
    v_xor_b32 v69, v11, v61
    v_cos_f32 v212, v10
    v_sin_f32 v213, v10
    v_mul_f32 v7, 0x3d000000, v10
    v_add_f32 v10, v10, v9
    v_cvt_pk_bf16_f32 v46, v212, v213
    v_cvt_pk_bf16_f32 v62, -v213, v212
    v_cos_f32 v110, v7
    v_sin_f32 v118, v7
    v_xor_b32 v54, v11, v46
    v_xor_b32 v70, v11, v62
    v_cos_f32 v214, v10
    v_sin_f32 v215, v10
    v_mul_f32 v7, 0x3d000000, v10
    v_add_f32 v10, v10, v14
    v_cvt_pk_bf16_f32 v47, v214, v215
    v_cvt_pk_bf16_f32 v63, -v215, v214
    v_cos_f32 v111, v7
    v_sin_f32 v119, v7
    v_xor_b32 v55, v11, v47
    v_xor_b32 v71, v11, v63
    v_cos_f32 v212, v10
    v_sin_f32 v213, v10
    v_mul_f32 v7, 0x3d000000, v10
    v_add_f32 v10, v10, v9
    v_cvt_pk_bf16_f32 v48, v212, v213
    v_cvt_pk_bf16_f32 v64, -v213, v212
    v_cos_f32 v112, v7
    v_sin_f32 v120, v7
    v_xor_b32 v56, v11, v48
    v_xor_b32 v72, v11, v64
    v_cos_f32 v214, v10
    v_sin_f32 v215, v10
    v_mul_f32 v7, 0x3d000000, v10
    v_add_f32 v10, v10, v9
    v_cvt_pk_bf16_f32 v49, v214, v215
    v_cvt_pk_bf16_f32 v65, -v215, v214
    v_cos_f32 v113, v7
    v_sin_f32 v121, v7
    v_xor_b32 v57, v11, v49
    v_xor_b32 v73, v11, v65
    v_cos_f32 v212, v10
    v_sin_f32 v213, v10
    v_mul_f32 v7, 0x3d000000, v10
    v_add_f32 v10, v10, v9
    v_cvt_pk_bf16_f32 v50, v212, v213
    v_cvt_pk_bf16_f32 v66, -v213, v212
    v_cos_f32 v114, v7
    v_sin_f32 v122, v7
    v_xor_b32 v58, v11, v50
    v_xor_b32 v74, v11, v66
    v_cos_f32 v214, v10
    v_sin_f32 v215, v10
    v_mul_f32 v7, 0x3d000000, v10
    v_add_f32 v10, v10, v14
    v_cvt_pk_bf16_f32 v51, v214, v215
    v_cvt_pk_bf16_f32 v67, -v215, v214
    v_cos_f32 v115, v7
    v_sin_f32 v123, v7
    v_xor_b32 v59, v11, v51
    v_xor_b32 v75, v11, v67
    v_cvt_f32_u32 v9, v2
    v_mul_f32 v9, 0x3d000000, v9
    v_mul_f32 v10, v8, v9
    v_cos_f32 v212, v10
    v_sin_f32 v213, v10
    v_add_f32 v10, v10, v9
    v_cvt_pk_bf16_f32 v76, v212, v213
    v_cvt_pk_bf16_f32 v92, -v213, v212
    v_xor_b32 v80, v11, v76
    v_mov_b32 v84, v76
    v_xor_b32 v88, v11, v76
    v_xor_b32 v96, v11, v92
    v_mov_b32 v100, v92
    v_xor_b32 v104, v11, v92
    v_cos_f32 v214, v10
    v_sin_f32 v215, v10
    v_add_f32 v10, v10, v9
    v_cvt_pk_bf16_f32 v77, v214, v215
    v_cvt_pk_bf16_f32 v93, -v215, v214
    v_xor_b32 v81, v11, v77
    v_xor_b32 v85, s26, v77
    v_xor_b32 v89, v12, v77
    v_xor_b32 v97, v11, v93
    v_xor_b32 v101, s26, v93
    v_xor_b32 v105, v12, v93
    v_cos_f32 v212, v10
    v_sin_f32 v213, v10
    v_add_f32 v10, v10, v9
    v_cvt_pk_bf16_f32 v78, v212, v213
    v_cvt_pk_bf16_f32 v94, -v213, v212
    v_xor_b32 v82, v11, v78
    v_mov_b32 v86, v78
    v_xor_b32 v90, v11, v78
    v_xor_b32 v98, v11, v94
    v_mov_b32 v102, v94
    v_xor_b32 v106, v11, v94
    v_cos_f32 v214, v10
    v_sin_f32 v215, v10
    s_nop 0
    v_cvt_pk_bf16_f32 v79, v214, v215
    v_cvt_pk_bf16_f32 v95, -v215, v214
    v_xor_b32 v83, v11, v79
    v_xor_b32 v87, s26, v79
    v_xor_b32 v91, v12, v79
    v_xor_b32 v99, v11, v95
    v_xor_b32 v103, s26, v95
    v_xor_b32 v107, v12, v95
    s_lshl_b32 s19, s20, 12
    v_lshl_add_u32 v13, v13, 9, s19
    v_lshl_add_u32 v13, v3, 8, v13
    v_lshl_add_u32 v13, v16, 4, v13
    v_bfe_i32 v15, v0, 3, 1
    s_and_b32 s19, s16, 1
    s_lshl_b32 s19, s19, 1
    s_or_b32 s19, s19, s20
    s_and_b32 s21, s18, 1
    s_xor_b32 s19, s19, s21
    s_lshr_b32 s21, s18, 1
    s_and_b32 s21, s21, 2
    s_xor_b32 s19, s19, s21
    s_lshl_b32 s19, s19, 6
    v_and_b32 v7, 64, v15
    v_xor_b32 v7, s19, v7
    v_mul_u32_u24 v14, 288, v16
    v_lshl_or_b32 v16, v16, 16, v7
    v_lshl_or_b32 v16, v3, 4, v16
    v_and_b32 v15, s26, v15
    s_lshl_b32 s28, s20, 20
    s_lshl_b32 s21, s18, 8
    s_add_u32 s28, s28, s21
    s_add_u32 s28, s28, s6
    s_add_u32 s28, s28, 18874368
    s_add_u32 s29, s28, 0x80000
    s_mul_i32 s21, s20, 4608
    v_lshl_add_u32 v14, v3, 4, v14
    v_add_u32 v14, s21, v14
    s_mov_b32 s19, 0xffff0000
    s_mov_b32 s27, 16384
    s_cmp_eq_u32 s17, 0
    s_cbranch_scc1 p2_chk
p2_poll:
    buffer_load_dwordx4 v[20:23], v4, s[8:11], s22 offen sc1
    buffer_load_dwordx4 v[24:27], v4, s[8:11], s23 offen sc1
p2_pollr:
    buffer_load_dwordx4 v[28:31], v5, s[8:11], s24 offen sc1
    buffer_load_dwordx4 v[32:35], v5, s[8:11], s25 offen sc1
p2_chk:
    s_sub_u32 s27, s27, 1
    s_waitcnt vmcnt(0)
    v_max3_u32 v7, v20, v21, v22
    v_max3_u32 v8, v28, v29, v30
    v_max3_u32 v7, v7, v23, v24
    v_max3_u32 v8, v8, v31, v32
    v_max3_u32 v7, v7, v25, v26
    v_max3_u32 v8, v8, v33, v34
    v_max_u32 v7, v7, v27
    v_max_u32 v8, v8, v35
    v_cmp_eq_u32 vcc, -1, v7
    s_cbranch_scc1 p2_go
    s_cbranch_vccnz p2_poll
    v_cmp_eq_u32 vcc, -1, v8
    s_cbranch_vccnz p2_pollr
p2_go:
    v_lshlrev_b32 v124, 16, v20
    v_and_b32 v132, s19, v20
    v_lshlrev_b32 v125, 16, v21
    v_and_b32 v133, s19, v21
    v_lshlrev_b32 v126, 16, v22
    v_and_b32 v134, s19, v22
    v_lshlrev_b32 v127, 16, v23
    v_and_b32 v135, s19, v23
    v_lshlrev_b32 v128, 16, v24
    v_and_b32 v136, s19, v24
    v_lshlrev_b32 v129, 16, v25
    v_and_b32 v137, s19, v25
    v_lshlrev_b32 v130, 16, v26
    v_and_b32 v138, s19, v26
    v_lshlrev_b32 v131, 16, v27
    v_and_b32 v139, s19, v27
    v_pk_mul_f32 v[172:173], v[124:125], v[28:29]
    v_pk_mul_f32 v[180:181], v[132:133], v[28:29]
    v_pk_mul_f32 v[174:175], v[126:127], v[30:31]
    v_pk_mul_f32 v[182:183], v[134:135], v[30:31]
    v_pk_mul_f32 v[176:177], v[128:129], v[32:33]
    v_pk_mul_f32 v[184:185], v[136:137], v[32:33]
    v_pk_mul_f32 v[178:179], v[130:131], v[34:35]
    v_pk_mul_f32 v[186:187], v[138:139], v[34:35]
    s_cmp_lg_u32 s2, 0
    s_cbranch_scc1 k2_nz
    v_mov_b32 v180, 0
    v_mov_b32 v181, 0
    v_mov_b32 v182, 0
    v_mov_b32 v183, 0
    v_mov_b32 v184, 0
    v_mov_b32 v185, 0
    v_mov_b32 v186, 0
    v_mov_b32 v187, 0
k2_nz:
    v_cvt_pk_bf16_f32 v188, v172, v180
    v_cvt_pk_bf16_f32 v189, v173, v181
    v_cvt_pk_bf16_f32 v190, v174, v182
    v_cvt_pk_bf16_f32 v191, v175, v183
    ds_write_b128 v13, v[188:191]
    v_cvt_pk_bf16_f32 v192, v176, v184
    v_cvt_pk_bf16_f32 v193, v177, v185
    v_cvt_pk_bf16_f32 v194, v178, v186
    v_cvt_pk_bf16_f32 v195, v179, v187
    ds_write_b128 v13, v[192:195] offset:128
    s_waitcnt lgkmcnt(0)
    s_barrier
    ds_read_b128 v[140:143], v6 offset:0
    ds_read_b128 v[144:147], v6 offset:4096
    ds_read_b128 v[148:151], v6 offset:1024
    ds_read_b128 v[152:155], v6 offset:5120
    ds_read_b128 v[156:159], v6 offset:2048
    ds_read_b128 v[160:163], v6 offset:6144
    ds_read_b128 v[164:167], v6 offset:3072
    ds_read_b128 v[168:171], v6 offset:7168
    v_xor_b32 v132, 0x80000000, v132
    v_xor_b32 v133, 0x80000000, v133
    v_xor_b32 v134, 0x80000000, v134
    v_xor_b32 v135, 0x80000000, v135
    v_xor_b32 v136, 0x80000000, v136
    v_xor_b32 v137, 0x80000000, v137
    v_xor_b32 v138, 0x80000000, v138
    v_xor_b32 v139, 0x80000000, v139
    v_mul_u32_u24 v13, 1152, v3
    v_lshl_add_u32 v13, v2, 2, v13
    s_lshl_b32 s20, s16, 6
    v_add_u32 v13, s20, v13
    s_waitcnt lgkmcnt(6)
    v_mfma_f32_16x16x32_bf16 v[172:175], v[140:143], v[44:47], 0
    v_mfma_f32_16x16x32_bf16 v[180:183], v[140:143], v[60:63], 0
    v_mfma_f32_16x16x32_bf16 v[176:179], v[144:147], v[44:47], 0
    v_mfma_f32_16x16x32_bf16 v[184:187], v[144:147], v[60:63], 0
    s_waitcnt lgkmcnt(4)
    v_mfma_f32_16x16x32_bf16 v[172:175], v[148:151], v[48:51], v[172:175]
    v_mfma_f32_16x16x32_bf16 v[180:183], v[148:151], v[64:67], v[180:183]
    v_mfma_f32_16x16x32_bf16 v[176:179], v[152:155], v[48:51], v[176:179]
    v_mfma_f32_16x16x32_bf16 v[184:187], v[152:155], v[64:67], v[184:187]
    s_waitcnt lgkmcnt(2)
    v_mfma_f32_16x16x32_bf16 v[172:175], v[156:159], v[52:55], v[172:175]
    v_mfma_f32_16x16x32_bf16 v[180:183], v[156:159], v[68:71], v[180:183]
    v_mfma_f32_16x16x32_bf16 v[176:179], v[160:163], v[52:55], v[176:179]
    v_mfma_f32_16x16x32_bf16 v[184:187], v[160:163], v[68:71], v[184:187]
    s_waitcnt lgkmcnt(0)
    v_mfma_f32_16x16x32_bf16 v[172:175], v[164:167], v[56:59], v[172:175]
    v_mfma_f32_16x16x32_bf16 v[180:183], v[164:167], v[72:75], v[180:183]
    v_mfma_f32_16x16x32_bf16 v[176:179], v[168:171], v[56:59], v[176:179]
    v_mfma_f32_16x16x32_bf16 v[184:187], v[168:171], v[72:75], v[184:187]
    v_lshlrev_b32 v196, 16, v36
    v_and_b32 v204, s19, v36
    v_lshlrev_b32 v197, 16, v37
    v_and_b32 v205, s19, v37
    v_lshlrev_b32 v198, 16, v38
    v_and_b32 v206, s19, v38
    v_lshlrev_b32 v199, 16, v39
    v_and_b32 v207, s19, v39
    v_lshlrev_b32 v200, 16, v40
    v_and_b32 v208, s19, v40
    v_lshlrev_b32 v201, 16, v41
    v_and_b32 v209, s19, v41
    v_lshlrev_b32 v202, 16, v42
    v_and_b32 v210, s19, v42
    v_lshlrev_b32 v203, 16, v43
    v_and_b32 v211, s19, v43
    v_pk_mul_f32 v[212:213], v[180:181], v[116:117]
    v_pk_mul_f32 v[214:215], v[172:173], v[116:117] neg_lo:[0,1] neg_hi:[0,1]
    v_pk_fma_f32 v[212:213], v[172:173], v[108:109], v[212:213]
    v_pk_fma_f32 v[214:215], v[180:181], v[108:109], v[214:215]
    v_cvt_pk_bf16_f32 v188, v212, v214
    v_cvt_pk_bf16_f32 v189, v213, v215
    v_pk_mul_f32 v[216:217], v[182:183], v[118:119]
    v_pk_mul_f32 v[218:219], v[174:175], v[118:119] neg_lo:[0,1] neg_hi:[0,1]
    v_pk_fma_f32 v[216:217], v[174:175], v[110:111], v[216:217]
    v_pk_fma_f32 v[218:219], v[182:183], v[110:111], v[218:219]
    v_cvt_pk_bf16_f32 v190, v216, v218
    v_cvt_pk_bf16_f32 v191, v217, v219
    v_pk_mul_f32 v[212:213], v[184:185], v[120:121]
    v_pk_mul_f32 v[214:215], v[176:177], v[120:121] neg_lo:[0,1] neg_hi:[0,1]
    v_pk_fma_f32 v[212:213], v[176:177], v[112:113], v[212:213]
    v_pk_fma_f32 v[214:215], v[184:185], v[112:113], v[214:215]
    v_cvt_pk_bf16_f32 v192, v212, v214
    v_cvt_pk_bf16_f32 v193, v213, v215
    v_pk_mul_f32 v[216:217], v[186:187], v[122:123]
    v_pk_mul_f32 v[218:219], v[178:179], v[122:123] neg_lo:[0,1] neg_hi:[0,1]
    v_pk_fma_f32 v[216:217], v[178:179], v[114:115], v[216:217]
    v_pk_fma_f32 v[218:219], v[186:187], v[114:115], v[218:219]
    v_cvt_pk_bf16_f32 v194, v216, v218
    v_cvt_pk_bf16_f32 v195, v217, v219
    v_mfma_f32_16x16x32_bf16 v[172:175], v[76:79], v[188:191], 0
    v_mfma_f32_16x16x32_bf16 v[180:183], v[92:95], v[188:191], 0
    v_mfma_f32_16x16x32_bf16 v[176:179], v[84:87], v[188:191], 0
    v_mfma_f32_16x16x32_bf16 v[184:187], v[100:103], v[188:191], 0
    v_mfma_f32_16x16x32_bf16 v[172:175], v[80:83], v[192:195], v[172:175]
    v_mfma_f32_16x16x32_bf16 v[180:183], v[96:99], v[192:195], v[180:183]
    v_mfma_f32_16x16x32_bf16 v[176:179], v[88:91], v[192:195], v[176:179]
    v_mfma_f32_16x16x32_bf16 v[184:187], v[104:107], v[192:195], v[184:187]
    s_nop 5
    v_pk_mul_f32 v[212:213], v[180:181], v[204:205] neg_lo:[0,1] neg_hi:[0,1]
    v_pk_mul_f32 v[214:215], v[172:173], v[204:205]
    v_pk_fma_f32 v[212:213], v[172:173], v[196:197], v[212:213]
    v_pk_fma_f32 v[214:215], v[180:181], v[196:197], v[214:215]
    v_cvt_pk_bf16_f32 v188, v212, -v214
    v_cvt_pk_bf16_f32 v189, v213, -v215
    v_pk_mul_f32 v[216:217], v[182:183], v[206:207] neg_lo:[0,1] neg_hi:[0,1]
    v_pk_mul_f32 v[218:219], v[174:175], v[206:207]
    v_pk_fma_f32 v[216:217], v[174:175], v[198:199], v[216:217]
    v_pk_fma_f32 v[218:219], v[182:183], v[198:199], v[218:219]
    v_cvt_pk_bf16_f32 v190, v216, -v218
    v_cvt_pk_bf16_f32 v191, v217, -v219
    v_pk_mul_f32 v[212:213], v[184:185], v[208:209] neg_lo:[0,1] neg_hi:[0,1]
    v_pk_mul_f32 v[214:215], v[176:177], v[208:209]
    v_pk_fma_f32 v[212:213], v[176:177], v[200:201], v[212:213]
    v_pk_fma_f32 v[214:215], v[184:185], v[200:201], v[214:215]
    v_cvt_pk_bf16_f32 v192, v212, -v214
    v_cvt_pk_bf16_f32 v193, v213, -v215
    v_pk_mul_f32 v[216:217], v[186:187], v[210:211] neg_lo:[0,1] neg_hi:[0,1]
    v_pk_mul_f32 v[218:219], v[178:179], v[210:211]
    v_pk_fma_f32 v[216:217], v[178:179], v[202:203], v[216:217]
    v_pk_fma_f32 v[218:219], v[186:187], v[202:203], v[218:219]
    v_cvt_pk_bf16_f32 v194, v216, -v218
    v_cvt_pk_bf16_f32 v195, v217, -v219
    v_mfma_f32_16x16x32_bf16 v[172:175], v[76:79], v[188:191], 0
    v_mfma_f32_16x16x32_bf16 v[180:183], v[92:95], v[188:191], 0
    v_mfma_f32_16x16x32_bf16 v[176:179], v[84:87], v[188:191], 0
    v_mfma_f32_16x16x32_bf16 v[184:187], v[100:103], v[188:191], 0
    v_mfma_f32_16x16x32_bf16 v[172:175], v[80:83], v[192:195], v[172:175]
    v_mfma_f32_16x16x32_bf16 v[180:183], v[96:99], v[192:195], v[180:183]
    v_mfma_f32_16x16x32_bf16 v[176:179], v[88:91], v[192:195], v[176:179]
    v_mfma_f32_16x16x32_bf16 v[184:187], v[104:107], v[192:195], v[184:187]
    s_nop 5
    v_pk_mul_f32 v[212:213], v[180:181], v[116:117]
    v_pk_mul_f32 v[214:215], v[172:173], v[116:117] neg_lo:[0,1] neg_hi:[0,1]
    v_pk_fma_f32 v[212:213], v[172:173], v[108:109], v[212:213]
    v_pk_fma_f32 v[214:215], v[180:181], v[108:109], v[214:215]
    v_cvt_pk_bf16_f32 v188, v212, v214
    ds_write_b32 v13, v188 offset:8192
    v_cvt_pk_bf16_f32 v189, v213, v215
    ds_write_b32 v13, v189 offset:8480
    v_pk_mul_f32 v[216:217], v[182:183], v[118:119]
    v_pk_mul_f32 v[218:219], v[174:175], v[118:119] neg_lo:[0,1] neg_hi:[0,1]
    v_pk_fma_f32 v[216:217], v[174:175], v[110:111], v[216:217]
    v_pk_fma_f32 v[218:219], v[182:183], v[110:111], v[218:219]
    v_cvt_pk_bf16_f32 v190, v216, v218
    ds_write_b32 v13, v190 offset:8768
    v_cvt_pk_bf16_f32 v191, v217, v219
    ds_write_b32 v13, v191 offset:9056
    v_pk_mul_f32 v[212:213], v[184:185], v[120:121]
    v_pk_mul_f32 v[214:215], v[176:177], v[120:121] neg_lo:[0,1] neg_hi:[0,1]
    v_pk_fma_f32 v[212:213], v[176:177], v[112:113], v[212:213]
    v_pk_fma_f32 v[214:215], v[184:185], v[112:113], v[214:215]
    v_cvt_pk_bf16_f32 v192, v212, v214
    ds_write_b32 v13, v192 offset:12800
    v_cvt_pk_bf16_f32 v193, v213, v215
    ds_write_b32 v13, v193 offset:13088
    v_pk_mul_f32 v[216:217], v[186:187], v[122:123]
    v_pk_mul_f32 v[218:219], v[178:179], v[122:123] neg_lo:[0,1] neg_hi:[0,1]
    v_pk_fma_f32 v[216:217], v[178:179], v[114:115], v[216:217]
    v_pk_fma_f32 v[218:219], v[186:187], v[114:115], v[218:219]
    v_cvt_pk_bf16_f32 v194, v216, v218
    ds_write_b32 v13, v194 offset:13376
    v_cvt_pk_bf16_f32 v195, v217, v219
    ds_write_b32 v13, v195 offset:13664
    s_cmp_lg_u32 s2, 0
    s_cbranch_scc1 k2_nz2
    v_mov_b64 v[60:61], 0
    v_mov_b64 v[62:63], 0
    v_mov_b64 v[64:65], 0
    v_mov_b64 v[66:67], 0
    v_mov_b64 v[68:69], 0
    v_mov_b64 v[70:71], 0
    v_mov_b64 v[72:73], 0
    v_mov_b64 v[74:75], 0
k2_nz2:
    s_waitcnt lgkmcnt(0)
    s_barrier
    ds_read_b128 v[140:143], v14 offset:8192
    ds_read_b128 v[144:147], v14 offset:8256
    ds_read_b128 v[148:151], v14 offset:8320
    ds_read_b128 v[152:155], v14 offset:8384
    ds_read_b128 v[156:159], v14 offset:10496
    ds_read_b128 v[160:163], v14 offset:10560
    ds_read_b128 v[164:167], v14 offset:10624
    ds_read_b128 v[168:171], v14 offset:10688
    s_waitcnt lgkmcnt(7)
    v_xor_b32 v141, v15, v141
    v_xor_b32 v143, v15, v143
    s_waitcnt lgkmcnt(6)
    v_xor_b32 v145, v15, v145
    v_xor_b32 v147, v15, v147
    v_mfma_f32_16x16x32_bf16 v[124:127], v[44:47], v[140:143], v[124:127]
    v_mfma_f32_16x16x32_bf16 v[132:135], v[60:63], v[140:143], v[132:135]
    s_waitcnt lgkmcnt(5)
    v_xor_b32 v149, v15, v149
    v_xor_b32 v151, v15, v151
    v_mfma_f32_16x16x32_bf16 v[124:127], v[48:51], v[144:147], v[124:127]
    v_mfma_f32_16x16x32_bf16 v[132:135], v[64:67], v[144:147], v[132:135]
    s_waitcnt lgkmcnt(4)
    v_xor_b32 v153, v15, v153
    v_xor_b32 v155, v15, v155
    v_mfma_f32_16x16x32_bf16 v[124:127], v[52:55], v[148:151], v[124:127]
    v_mfma_f32_16x16x32_bf16 v[132:135], v[68:71], v[148:151], v[132:135]
    s_waitcnt lgkmcnt(3)
    v_xor_b32 v157, v15, v157
    v_xor_b32 v159, v15, v159
    v_mfma_f32_16x16x32_bf16 v[124:127], v[56:59], v[152:155], v[124:127]
    v_mfma_f32_16x16x32_bf16 v[132:135], v[72:75], v[152:155], v[132:135]
    s_waitcnt lgkmcnt(2)
    v_xor_b32 v161, v15, v161
    v_xor_b32 v163, v15, v163
    v_mfma_f32_16x16x32_bf16 v[128:131], v[44:47], v[156:159], v[128:131]
    v_mfma_f32_16x16x32_bf16 v[136:139], v[60:63], v[156:159], v[136:139]
    s_waitcnt lgkmcnt(1)
    v_xor_b32 v165, v15, v165
    v_xor_b32 v167, v15, v167
    v_mfma_f32_16x16x32_bf16 v[128:131], v[48:51], v[160:163], v[128:131]
    v_mfma_f32_16x16x32_bf16 v[136:139], v[64:67], v[160:163], v[136:139]
    s_waitcnt lgkmcnt(0)
    v_xor_b32 v169, v15, v169
    v_xor_b32 v171, v15, v171
    v_mfma_f32_16x16x32_bf16 v[128:131], v[52:55], v[164:167], v[128:131]
    v_mfma_f32_16x16x32_bf16 v[136:139], v[68:71], v[164:167], v[136:139]
    v_cvt_pk_bf16_f32 v188, v124, v125
    v_cvt_pk_bf16_f32 v189, v126, v127
    v_cvt_pk_bf16_f32 v190, -v132, -v133
    v_cvt_pk_bf16_f32 v191, -v134, -v135
    buffer_store_dwordx4 v[188:191], v16, s[8:11], s28 offen sc1
    v_mfma_f32_16x16x32_bf16 v[128:131], v[56:59], v[168:171], v[128:131]
    v_mfma_f32_16x16x32_bf16 v[136:139], v[72:75], v[168:171], v[136:139]
    s_nop 6
    v_cvt_pk_bf16_f32 v192, v128, v129
    v_cvt_pk_bf16_f32 v193, v130, v131
    v_cvt_pk_bf16_f32 v194, -v136, -v137
    v_cvt_pk_bf16_f32 v195, -v138, -v139
    buffer_store_dwordx4 v[192:195], v16, s[8:11], s29 offen sc1
    s_branch p3_start
p2_help:
    s_setprio 0
p3_start:
    s_setprio 0
    s_and_b32 s18, s2, 31
    s_lshr_b32 s19, s2, 5
    s_lshr_b32 s24, s16, 2
    s_and_b32 s25, s16, 3
    s_and_b32 s4, s19, 1
    s_add_u32 s4, s4, 1
    s_lshr_b32 s23, s19, 1
    s_cmp_eq_u32 s25, s23
    s_cselect_b32 s4, s4, 0
    s_cselect_b32 s20, 4, 1
    s_lshl_b32 s20, s20, 14
    s_mul_i32 s29, s4, s24
    s_sub_u32 s5, s4, s29
    v_and_b32 v194, 63, v0
    s_lshl_b32 s21, s24, 10
    s_add_u32 s21, s21, 81920
    v_lshl_add_u32 v230, v194, 4, s21
    s_mul_i32 s21, s20, s24
    s_sub_u32 s20, s20, s21
    v_add_u32 v228, s21, v230
    v_add_u32 v229, s20, v230
    s_lshl_b32 s21, s24, 14
    v_subrev_u32 v231, s21, v230
    v_add_u32 v230, s21, v230
    v_lshlrev_b32 v197, 4, v194
    s_add_u32 s30, s6, 16777216
    s_lshl_b32 s48, s18, 16
    s_add_u32 s48, s48, s30
    s_add_u32 s48, s48, 2097152
    s_lshl_b32 s52, s16, 13
    s_add_u32 s49, s48, s52
    s_add_u32 s50, s49, 4096
    s_add_u32 s53, s52, 4096
    v_and_b32 v232, 15, v0
    v_lshl_add_u32 v232, v232, 2, s52
    v_lshl_add_u32 v232, v194, 7, v232
    v_and_b32 v192, 15, v0
    v_bfe_u32 v193, v0, 4, 2
    v_bfe_u32 v194, v0, 3, 2
    s_and_b32 s20, s25, 1
    s_lshl_b32 s20, s20, 1
    s_lshr_b32 s21, s25, 1
    s_or_b32 s20, s20, s21
    s_lshl_b32 s21, s24, 6
    s_or_b32 s20, s20, s21
    v_xor_b32 v194, s20, v194
    v_lshlrev_b32 v194, 6, v194
    v_lshl_add_u32 v194, v193, 10, v194
    v_and_b32 v195, 8, v0
    v_lshl_add_u32 v194, v195, 5, v194
    v_and_b32 v196, 3, v0
    v_cmp_eq_u32 s[32:33], 1, v196
    v_cmp_eq_u32 s[34:35], 3, v196
    v_cmp_lt_u32 s[54:55], 1, v196
    v_lshl_add_u32 v194, v196, 4, v194
    v_and_b32 v196, 4, v0
    v_lshl_add_u32 v209, v196, 1, v194
    v_and_b32 v194, 7, v0
    v_lshlrev_b32 v200, 5, v194
    v_lshl_add_u32 v200, v195, 8, v200
    v_lshl_add_u32 v210, v193, 3, v200
    v_lshrrev_b32 v196, 1, v193
    v_lshl_add_u32 v200, v196, 4, v200
    v_and_b32 v194, 16, v0
    v_lshl_add_u32 v200, v194, 16, v200
    s_lshl_b32 s20, s24, 3
    s_add_u32 s20, s20, s19
    s_lshl_b32 s20, s20, 16
    s_and_b32 s21, s18, 24
    s_lshl_b32 s21, s21, 11
    s_add_u32 s20, s20, s21
    s_and_b32 s21, s18, 7
    s_lshl_b32 s21, s21, 8
    s_add_u32 s20, s20, s21
    s_lshl_b32 s21, s25, 12
    s_add_u32 s20, s20, s21
    s_add_u32 s20, s20, 4718592
    v_add_u32 v200, s20, v200
    v_add_u32 v210, s20, v210
    v_mov_b32 v199, v210
    s_mov_b32 s28, 0x3eb8aa3b
    s_cmp_eq_u32 s29, 0
    s_cbranch_scc1 p3_nkv
    s_mov_b32 s28, 1.0
    s_sub_u32 s20, 10, s29
    v_lshlrev_b32 v196, s20, v196
    v_lshl_add_u32 v196, v192, 4, v196
    s_and_b32 s20, s23, 1
    s_add_u32 s21, s29, 7
    s_lshl_b32 s20, s20, s21
    s_and_b32 s21, s19, 5
    s_add_u32 s21, s21, 1
    s_lshr_b32 s21, s21, 1
    s_lshl_b32 s21, s21, 10
    s_add_u32 s20, s20, s21
    s_lshl_b32 s21, s18, 12
    s_add_u32 s20, s20, s21
    s_add_u32 s20, s20, 4259840
    v_lshrrev_b32 v194, 1, v194
    v_add3_u32 v199, s20, v196, v194
p3_nkv:
    v_and_b32 v194, 0x130, v0
    v_cmp_eq_u32 s[36:37], 0, v194
    v_mov_b32 v198, 0xffff
    s_lshl_b32 s21, s25, 7
    s_add_u32 s21, s21, 72192
    v_lshl_add_u32 v211, v192, 2, s21
    v_cndmask_b32 v198, -1, v198, s[36:37]
    v_lshrrev_b32 v194, 2, v192
    v_cmp_eq_u32 s[38:39], v194, v193
    s_mov_b32 s26, 64
    s_mov_b32 s27, 16384
    s_cmp_eq_u32 s17, 0
    s_cbranch_scc1 p3_b3
    ds_read_b128 v[96:99], v229 offset:0
    ds_read_b128 v[100:103], v229 offset:2048
    ds_read_b128 v[104:107], v229 offset:4096
    ds_read_b128 v[108:111], v229 offset:6144
    ds_read_b128 v[112:115], v229 offset:8192
    ds_read_b128 v[116:119], v229 offset:10240
    ds_read_b128 v[120:123], v229 offset:12288
    ds_read_b128 v[124:127], v229 offset:14336
    ds_read_b128 v[64:67], v228 offset:0
    ds_read_b128 v[68:71], v228 offset:2048
    ds_read_b128 v[72:75], v228 offset:4096
    ds_read_b128 v[76:79], v228 offset:6144
    ds_read_b128 v[80:83], v228 offset:8192
    ds_read_b128 v[84:87], v228 offset:10240
    ds_read_b128 v[88:91], v228 offset:12288
    ds_read_b128 v[92:95], v228 offset:14336
    ds_read_b128 v[128:131], v230 offset:32768
    ds_read_b128 v[132:135], v230 offset:34816
    ds_read_b128 v[136:139], v230 offset:36864
    ds_read_b128 v[140:143], v230 offset:38912
    ds_read_b128 v[144:147], v230 offset:40960
    ds_read_b128 v[148:151], v230 offset:43008
    ds_read_b128 v[152:155], v230 offset:45056
    ds_read_b128 v[156:159], v230 offset:47104
    ds_read_b128 v[160:163], v231 offset:49152
    ds_read_b128 v[164:167], v231 offset:51200
    ds_read_b128 v[168:171], v231 offset:53248
    ds_read_b128 v[172:175], v231 offset:55296
    ds_read_b128 v[176:179], v231 offset:57344
    ds_read_b128 v[180:183], v231 offset:59392
    ds_read_b128 v[184:187], v231 offset:61440
    ds_read_b128 v[188:191], v231 offset:63488
    s_cmp_eq_u32 s24, 1
    s_cbranch_scc1 p3_sk
    s_barrier
    s_mov_b32 m0, s52
    s_nop 0
    buffer_load_dwordx4 v197, s[8:11], s49 offen offset:0  lds
    buffer_load_dwordx4 v197, s[8:11], s49 offen offset:1024  lds
    buffer_load_dwordx4 v197, s[8:11], s49 offen offset:2048  lds
    buffer_load_dwordx4 v197, s[8:11], s49 offen offset:3072  lds
    s_mov_b32 m0, s53
    s_nop 0
    buffer_load_dwordx4 v197, s[8:11], s50 offen offset:0  lds
    buffer_load_dwordx4 v197, s[8:11], s50 offen offset:1024  lds
    buffer_load_dwordx4 v197, s[8:11], s50 offen offset:2048  lds
    buffer_load_dwordx4 v197, s[8:11], s50 offen offset:3072  lds
p3_sk:
    s_lshl_b32 s20, s19, 1
    s_add_u32 s20, s20, s24
    s_lshl_b32 s20, s20, 4
    v_add_u32 v194, s20, v192
    v_lshl_add_u32 v195, v193, 4, s24
    v_cvt_f32_u32 v195, v195
    v_mul_f32 v195, 0x3e800000, v195
    v_cvt_f32_u32 v203, v194
    v_xor_b32 v194, 16, v194
    v_mul_f32 v203, 0x3c000000, v203
    v_mul_f32 v204, v195, v203
    v_mul_f32 v208, 0xc0200000, v203
    v_cos_f32 v248, v204
    v_sin_f32 v249, v204
    v_add_f32 v204, v204, v203
    v_cvt_pk_bf16_f32 v212, v248, -v249
    v_cos_f32 v250, v204
    v_sin_f32 v251, v204
    v_add_f32 v204, v204, v203
    v_cvt_pk_bf16_f32 v213, v250, -v251
    v_cos_f32 v252, v204
    v_sin_f32 v253, v204
    v_add_f32 v204, v204, v203
    v_cvt_pk_bf16_f32 v214, v252, -v253
    v_cos_f32 v254, v204
    v_sin_f32 v255, v204
    v_add_f32 v204, v204, v208
    v_cvt_pk_bf16_f32 v215, v254, -v255
    v_cos_f32 v248, v204
    v_sin_f32 v249, v204
    v_add_f32 v204, v204, v203
    v_cvt_pk_bf16_f32 v216, v248, -v249
    v_cos_f32 v250, v204
    v_sin_f32 v251, v204
    v_add_f32 v204, v204, v203
    v_cvt_pk_bf16_f32 v217, v250, -v251
    v_cos_f32 v252, v204
    v_sin_f32 v253, v204
    v_add_f32 v204, v204, v203
    v_cvt_pk_bf16_f32 v218, v252, -v253
    v_cos_f32 v254, v204
    v_sin_f32 v255, v204
    s_nop 0
    v_cvt_pk_bf16_f32 v219, v254, -v255
    v_cvt_f32_u32 v203, v194
    v_xor_b32 v194, 16, v194
    v_mul_f32 v203, 0x3c000000, v203
    v_mul_f32 v204, v195, v203
    v_mul_f32 v208, 0xc0200000, v203
    v_cos_f32 v248, v204
    v_sin_f32 v249, v204
    v_add_f32 v204, v204, v203
    v_cvt_pk_bf16_f32 v220, v248, -v249
    v_cos_f32 v250, v204
    v_sin_f32 v251, v204
    v_add_f32 v204, v204, v203
    v_cvt_pk_bf16_f32 v221, v250, -v251
    v_cos_f32 v252, v204
    v_sin_f32 v253, v204
    v_add_f32 v204, v204, v203
    v_cvt_pk_bf16_f32 v222, v252, -v253
    v_cos_f32 v254, v204
    v_sin_f32 v255, v204
    v_add_f32 v204, v204, v208
    v_cvt_pk_bf16_f32 v223, v254, -v255
    v_cos_f32 v248, v204
    v_sin_f32 v249, v204
    v_add_f32 v204, v204, v203
    v_cvt_pk_bf16_f32 v224, v248, -v249
    v_cos_f32 v250, v204
    v_sin_f32 v251, v204
    v_add_f32 v204, v204, v203
    v_cvt_pk_bf16_f32 v225, v250, -v251
    v_cos_f32 v252, v204
    v_sin_f32 v253, v204
    v_add_f32 v204, v204, v203
    v_cvt_pk_bf16_f32 v226, v252, -v253
    v_cos_f32 v254, v204
    v_sin_f32 v255, v204
    s_nop 0
    v_cvt_pk_bf16_f32 v227, v254, -v255
    v_and_b32 v195, 1, v192
    v_cmp_eq_u32 vcc, 1, v195
    v_mov_b32 v205, 0x03020100
    v_mov_b32 v206, 0x01000302
    v_cndmask_b32 v205, v205, v206, vcc
    v_add_u32 v206, 1, v192
    v_and_b32 v206, 2, v206
    v_lshlrev_b32 v206, 14, v206
    v_and_b32 v194, 2, v192
    v_lshl_or_b32 v206, v194, 30, v206
    v_lshlrev_b32 v207, 4, v195
    s_brev_b32 s20, 1
    v_lshrrev_b32_e64 v207, v207, s20
    v_mul_f32 v201, 0x42400000, v203
    v_mul_f32 v202, 0x42000000, v203
    v_cos_f32 v248, v201
    v_sin_f32 v249, v201
    v_cos_f32 v250, v202
    v_sin_f32 v251, v202
    v_lshlrev_b32 v195, 15, v195
    v_or_b32 v195, 0x3f353f35, v195
    v_cvt_pk_bf16_f32 v201, v248, -v249
    v_cvt_pk_bf16_f32 v202, v250, -v251
    v_cndmask_b32 v212, v212, v195, s[36:37]
    v_cndmask_b32 v220, v220, v195, s[36:37]
p3_b3:
    v_lshlrev_b32 v204, 4, v0
    v_add_u32 v204, 16384, v204
    v_xor_b32 v203, 4096, v204
    s_cmp_eq_u32 s29, 0
    s_cselect_b32 s20, 0x40000000, 0
    v_or_b32 v208, s20, v210
    s_lshl_b32 s20, s24, 6
    v_add_u32 v196, s20, v211
    s_add_u32 s7, s6, 16777216
    v_and_b32 v1, 63, v0
    v_lshlrev_b32 v1, 4, v1
    v_lshlrev_b32 v5, 2, v0
    s_and_b32 s3, s2, 31
    s_lshl_b32 s3, s3, 3
    s_lshr_b32 s58, s2, 5
    s_add_u32 s3, s3, s58
    s_lshl_b32 s58, s58, 11
    s_add_u32 s58, s58, s7
    s_and_b32 s20, s2, 24
    s_lshl_b32 s20, s20, 11
    s_add_u32 s58, s58, s20
    s_and_b32 s20, s2, 7
    s_lshl_b32 s20, s20, 8
    s_add_u32 s58, s58, s20
    s_add_u32 s58, s58, 4718592
    s_add_u32 s62, s58, 262144
    s_lshl_b32 s31, s2, 3
    s_add_u32 s31, s31, s16
    s_lshl_b32 s31, s31, 10
    s_add_u32 s31, s31, 33554432
    v_bfe_u32 v8, v0, 3, 2
    v_lshlrev_b32 v9, 16, v8
    v_and_b32 v8, 7, v0
    v_lshl_add_u32 v9, v8, 5, v9
    v_bfe_u32 v8, v0, 5, 1
    v_lshl_add_u32 v9, v8, 4, v9
    v_and_b32 v13, 15, v0
    v_lshlrev_b32 v10, 8, v8
    v_lshl_add_u32 v10, v13, 4, v10
    v_lshlrev_b32 v15, 26, v13
    v_and_b32 v8, 16, v0
    v_cmp_eq_u32 vcc, 0, v8
    v_or_b32 v15, 131072, v15
    s_lshl_b32 s59, s16, 14
    s_add_u32 s59, s59, s7
    s_add_u32 s59, s59, 4259840
    v_cndmask_b32 v10, v15, v10, vcc
    s_mov_b32 s63, s59
    v_bfe_u32 v14, v0, 4, 2
    v_mul_u32_u24 v2, 3, v1
    s_mul_i32 s22, s16, 6144
    v_add_u32 v2, s22, v2
    v_lshrrev_b32 v15, 1, v0
    v_xor_b32 v15, v15, v0
    v_and_b32 v15, 4, v15
    v_mul_u32_u24 v15, 3, v15
    v_xor_b32 v15, v15, v0
    v_bfe_u32 v8, v15, 3, 5
    s_lshr_b32 s22, s16, 2
    s_mul_i32 s22, s22, 3072
    v_mad_u32_u24 v4, v8, 48, s22
    v_and_b32 v8, 1, v0
    v_mul_u32_u24 v3, 1536, v8
    v_and_b32 v8, 2, v0
    v_lshl_add_u32 v3, v8, 3, v3
    v_and_b32 v8, 8, v0
    v_add3_u32 v3, v3, v8, v4
    v_and_b32 v8, 7, v15
    v_mul_u32_u24 v8, 6144, v8
    v_add_u32 v4, v4, v8
    v_mov_b32 v7, v1
    v_mov_b32 v11, 0
    s_lshl_b32 s22, s17, 19
    s_lshl_b32 s21, s16, 16
    s_add_u32 s22, s22, s21
    s_add_u32 s40, s22, 5767168
    s_cmp_eq_u32 s17, 1
    s_cbranch_scc1 k4_res1
    v_and_b32 v8, 1, v13
    v_bfe_u32 v15, v13, 2, 1
    v_lshl_or_b32 v8, v15, 1, v8
    s_and_b32 s22, s3, 2
    s_bfe_u32 s21, s3, 0x10002
    s_or_b32 s22, s22, s21
    v_xor_b32 v8, s22, v8
    v_lshlrev_b32 v8, 6, v8
    v_and_b32 v6, 31, v0
    v_and_b32 v12, 2, v14
    v_lshl_add_u32 v8, v6, 8, v8
    v_lshl_add_u32 v8, v12, 3, v8
    s_lshr_b32 s22, s3, 3
    s_lshl_b32 s22, s22, 16
    s_and_b32 s21, s3, 1
    s_lshl_b32 s21, s21, 5
    s_add_u32 s22, s22, s21
    s_lshl_b32 s21, s16, 13
    s_add_u32 s22, s22, s21
    s_add_u32 s57, s22, 18874368
    s_add_u32 s56, s57, 8
    v_lshlrev_b32 v6, 5, v6
    v_lshl_or_b32 v6, v12, 3, v6
    s_lshl_b32 s60, s16, 10
    s_lshl_b32 s21, s3, 13
    s_add_u32 s60, s60, s21
    s_add_u32 s60, s60, 16777216
    s_branch k4_go
k4_res1:
    v_lshrrev_b32 v8, 2, v13
    v_lshlrev_b32 v8, 16, v8
    v_lshl_add_u32 v8, v14, 6, v8
    v_and_b32 v15, 3, v13
    v_lshl_add_u32 v8, v15, 3, v8
    s_lshl_b32 s21, s16, 18
    s_add_u32 s22, s58, s21
    s_sub_u32 s57, s22, 4718592
    s_add_u32 s56, s57, 32
    v_lshlrev_b32 v6, 16, v14
    v_lshl_or_b32 v6, v13, 3, v6
    s_and_b32 s60, s3, 7
    s_lshl_b32 s60, s60, 18
    s_lshr_b32 s21, s3, 3
    s_lshl_b32 s21, s21, 10
    s_add_u32 s60, s60, s21
    s_lshl_b32 s21, s16, 7
    s_add_u32 s60, s60, s21
    s_add_u32 s61, s60, 32768
k4_go:
    s_lshl_b32 s20, s17, 30
    v_or_b32 v13, s20, v1
    v_mov_b64 v[48:49], 0
    v_mov_b64 v[50:51], 0
    v_add_u32 v53, 3072, v2
    v_and_b32 v52, 0x3e0, v1
    v_add_u32 v52, v52, v1
    v_mov_b32 v55, 0xdddddddd
    v_bfe_i32 v54, v0, 1, 1
    v_and_b32 v54, 0xaaaaaaaa, v54
    v_or_b32 v54, 0x44444444, v54
    s_cmp_eq_u32 s17, 0
    s_cbranch_scc1 p3_h0
    s_cmp_eq_u32 s24, 0
    s_cbranch_scc1 p3_i8
    s_barrier
    s_barrier
    s_barrier
    s_mov_b32 m0, s52
    s_nop 0
    buffer_load_dwordx4 v197, s[8:11], s49 offen offset:0  lds
    buffer_load_dwordx4 v197, s[8:11], s49 offen offset:1024  lds
    buffer_load_dwordx4 v197, s[8:11], s49 offen offset:2048  lds
    buffer_load_dwordx4 v197, s[8:11], s49 offen offset:3072  lds
    s_mov_b32 m0, s53
    s_nop 0
    buffer_load_dwordx4 v197, s[8:11], s50 offen offset:0  lds
    buffer_load_dwordx4 v197, s[8:11], s50 offen offset:1024  lds
    buffer_load_dwordx4 v197, s[8:11], s50 offen offset:2048  lds
    buffer_load_dwordx4 v197, s[8:11], s50 offen offset:3072  lds
    s_branch p3_i8
p3_h0:
    s_cmp_eq_u32 s24, 0
    s_cbranch_scc1 p3_m0
    s_lshl_b32 s21, s25, 12
    s_and_b32 s22, s19, 1
    s_sub_u32 s22, s22, s19
    s_add_u32 s22, s22, 8
    s_lshl_b32 s22, s22, 14
    s_lshl_b32 s20, s19, 14
    s_add_u32 s20, s20, s21
    s_add_u32 s20, s20, 4718592
    s_add_u32 s21, s21, 81920
    s_mov_b32 m0, s21
    s_lshl_b32 s23, s2, 2
    s_add_u32 s23, s23, s16
    s_lshl_b32 s23, s23, 11
    s_add_u32 s23, s23, 21487616
    s_add_u32 s26, s23, 4290248704
    v_mov_b64 v[16:17], -1
    v_mov_b64 v[18:19], -1
    s_waitcnt lgkmcnt(0)
    buffer_store_dwordx4 v[16:19], v197, s[8:11], s23 offen offset:0 sc1
    buffer_store_dwordx4 v[16:19], v197, s[8:11], s23 offen offset:1024 sc1
    buffer_store_dwordx4 v[16:19], v197, s[8:11], s26 offen offset:0 sc1
    buffer_store_dwordx4 v[16:19], v197, s[8:11], s26 offen offset:1024 sc1
    s_mov_b32 s26, 64
    s_add_u32 s22, s22, 393216
    s_add_u32 m0, s21, 0
    s_add_u32 s23, s20, 0
    buffer_load_dwordx4 v197, s[8:11], s23 offen offset:0 lds
    buffer_load_dwordx4 v197, s[8:11], s23 offen offset:1024 lds
    buffer_load_dwordx4 v197, s[8:11], s23 offen offset:2048 lds
    buffer_load_dwordx4 v197, s[8:11], s23 offen offset:3072 lds
    s_barrier
    s_add_u32 m0, s21, 16384
    s_add_u32 s23, s20, 131072
    buffer_load_dwordx4 v197, s[8:11], s23 offen offset:0 lds
    buffer_load_dwordx4 v197, s[8:11], s23 offen offset:1024 lds
    buffer_load_dwordx4 v197, s[8:11], s23 offen offset:2048 lds
    buffer_load_dwordx4 v197, s[8:11], s23 offen offset:3072 lds
    s_add_u32 m0, s21, 65536
    s_add_u32 s23, s20, s22
    buffer_load_dwordx4 v197, s[8:11], s23 offen offset:0 lds
    buffer_load_dwordx4 v197, s[8:11], s23 offen offset:1024 lds
    buffer_load_dwordx4 v197, s[8:11], s23 offen offset:2048 lds
    buffer_load_dwordx4 v197, s[8:11], s23 offen offset:3072 lds
    s_waitcnt vmcnt(12)
    s_barrier
    s_add_u32 m0, s21, 32768
    s_add_u32 s23, s20, 262144
    buffer_load_dwordx4 v197, s[8:11], s23 offen offset:0 lds
    buffer_load_dwordx4 v197, s[8:11], s23 offen offset:1024 lds
    buffer_load_dwordx4 v197, s[8:11], s23 offen offset:2048 lds
    buffer_load_dwordx4 v197, s[8:11], s23 offen offset:3072 lds
    s_add_u32 m0, s21, 49152
    s_add_u32 s23, s20, 393216
    buffer_load_dwordx4 v197, s[8:11], s23 offen offset:0 lds
    buffer_load_dwordx4 v197, s[8:11], s23 offen offset:1024 lds
    buffer_load_dwordx4 v197, s[8:11], s23 offen offset:2048 lds
    buffer_load_dwordx4 v197, s[8:11], s23 offen offset:3072 lds
p3_tb:
    s_waitcnt vmcnt(8)
p3_m0:
    s_barrier
    ds_read_b128 v[96:99], v229 offset:0
    ds_read_b128 v[100:103], v229 offset:2048
    ds_read_b128 v[104:107], v229 offset:4096
    ds_read_b128 v[108:111], v229 offset:6144
    ds_read_b128 v[112:115], v229 offset:8192
    ds_read_b128 v[116:119], v229 offset:10240
    ds_read_b128 v[120:123], v229 offset:12288
    ds_read_b128 v[124:127], v229 offset:14336
    s_mov_b32 m0, s52
    s_nop 0
    buffer_load_dwordx4 v197, s[8:11], s49 offen offset:0  lds
    buffer_load_dwordx4 v197, s[8:11], s49 offen offset:1024  lds
    buffer_load_dwordx4 v197, s[8:11], s49 offen offset:2048  lds
    buffer_load_dwordx4 v197, s[8:11], s49 offen offset:3072  lds
    s_mov_b32 m0, s53
    s_nop 0
    buffer_load_dwordx4 v197, s[8:11], s50 offen offset:0  lds
    buffer_load_dwordx4 v197, s[8:11], s50 offen offset:1024  lds
    buffer_load_dwordx4 v197, s[8:11], s50 offen offset:2048  lds
    buffer_load_dwordx4 v197, s[8:11], s50 offen offset:3072  lds
    ds_read_b128 v[64:67], v228 offset:0
    ds_read_b128 v[68:71], v228 offset:2048
    ds_read_b128 v[72:75], v228 offset:4096
    ds_read_b128 v[76:79], v228 offset:6144
    ds_read_b128 v[80:83], v228 offset:8192
    ds_read_b128 v[84:87], v228 offset:10240
    ds_read_b128 v[88:91], v228 offset:12288
    ds_read_b128 v[92:95], v228 offset:14336
    s_waitcnt vmcnt(8)
    s_barrier
    ds_read_b128 v[128:131], v230 offset:32768
    ds_read_b128 v[132:135], v230 offset:34816
    ds_read_b128 v[136:139], v230 offset:36864
    ds_read_b128 v[140:143], v230 offset:38912
    ds_read_b128 v[144:147], v230 offset:40960
    ds_read_b128 v[148:151], v230 offset:43008
    ds_read_b128 v[152:155], v230 offset:45056
    ds_read_b128 v[156:159], v230 offset:47104
    ds_read_b128 v[160:163], v231 offset:49152
    ds_read_b128 v[164:167], v231 offset:51200
    ds_read_b128 v[168:171], v231 offset:53248
    ds_read_b128 v[172:175], v231 offset:55296
    ds_read_b128 v[176:179], v231 offset:57344
    ds_read_b128 v[180:183], v231 offset:59392
    ds_read_b128 v[184:187], v231 offset:61440
    ds_read_b128 v[188:191], v231 offset:63488
    s_branch p3_i8
p3_re:
    s_mov_b32 m0, s52
    s_nop 0
    buffer_load_dwordx4 v197, s[8:11], s49 offen offset:0 sc1 lds
    buffer_load_dwordx4 v197, s[8:11], s49 offen offset:1024 sc1 lds
    buffer_load_dwordx4 v197, s[8:11], s49 offen offset:2048 sc1 lds
    buffer_load_dwordx4 v197, s[8:11], s49 offen offset:3072 sc1 lds
    s_mov_b32 m0, s53
    s_nop 0
    buffer_load_dwordx4 v197, s[8:11], s50 offen offset:0 sc1 lds
    buffer_load_dwordx4 v197, s[8:11], s50 offen offset:1024 sc1 lds
    buffer_load_dwordx4 v197, s[8:11], s50 offen offset:2048 sc1 lds
    buffer_load_dwordx4 v197, s[8:11], s50 offen offset:3072 sc1 lds
p3_i8:
    s_sub_u32 s27, s27, 1
    s_waitcnt vmcnt(0)
    ds_read2_b32 v[248:249], v232 offset0:0 offset1:16
    s_waitcnt lgkmcnt(0)
    v_max_u32 v248, v248, v249
    v_cmp_eq_u32 vcc, -1, v248
    s_cbranch_scc1 p3_go
    s_cbranch_vccnz p3_re
p3_go:
    s_barrier
p3_redo:
    s_cmp_eq_u32 s5, 2
    ds_read_b64_tr_b16 v[16:17], v209 offset:0
    ds_read_b64_tr_b16 v[18:19], v209 offset:512
    ds_read_b64_tr_b16 v[20:21], v209 offset:8192
    ds_read_b64_tr_b16 v[22:23], v209 offset:8704
    ds_read_b64_tr_b16 v[24:25], v209 offset:16384
    ds_read_b64_tr_b16 v[26:27], v209 offset:16896
    ds_read_b64_tr_b16 v[28:29], v209 offset:24576
    ds_read_b64_tr_b16 v[30:31], v209 offset:25088
    ds_read_b64_tr_b16 v[32:33], v209 offset:32768
    ds_read_b64_tr_b16 v[34:35], v209 offset:33280
    ds_read_b64_tr_b16 v[36:37], v209 offset:40960
    ds_read_b64_tr_b16 v[38:39], v209 offset:41472
    ds_read_b64_tr_b16 v[40:41], v209 offset:49152
    ds_read_b64_tr_b16 v[42:43], v209 offset:49664
    ds_read_b64_tr_b16 v[44:45], v209 offset:57344
    ds_read_b64_tr_b16 v[46:47], v209 offset:57856
    v_mov_b32 v194, 0x3f27c5ac
    s_cbranch_scc1 p3_v1
    s_waitcnt lgkmcnt(14)
    v_and_b32 v56, v198, v16
    v_mov_b32 v57, v17
    v_mov_b64 v[58:59], v[18:19]
    v_mfma_f32_16x16x32_bf16 v[240:243], v[96:99], v[16:19], 0
    s_nop 0
    v_mfma_f32_16x16x32_bf16 v[244:247], v[56:59], v[16:19], 0
    s_waitcnt lgkmcnt(12)
    v_mfma_f32_16x16x32_bf16 v[244:247], v[20:23], v[20:23], v[244:247]
    v_mfma_f32_16x16x32_bf16 v[240:243], v[100:103], v[20:23], v[240:243]
    s_waitcnt lgkmcnt(10)
    v_mfma_f32_16x16x32_bf16 v[244:247], v[24:27], v[24:27], v[244:247]
    v_mfma_f32_16x16x32_bf16 v[240:243], v[104:107], v[24:27], v[240:243]
    s_waitcnt lgkmcnt(8)
    v_mfma_f32_16x16x32_bf16 v[244:247], v[28:31], v[28:31], v[244:247]
    v_mfma_f32_16x16x32_bf16 v[240:243], v[108:111], v[28:31], v[240:243]
    s_waitcnt lgkmcnt(6)
    v_mfma_f32_16x16x32_bf16 v[244:247], v[32:35], v[32:35], v[244:247]
    v_mfma_f32_16x16x32_bf16 v[240:243], v[112:115], v[32:35], v[240:243]
    s_waitcnt lgkmcnt(4)
    v_mfma_f32_16x16x32_bf16 v[244:247], v[36:39], v[36:39], v[244:247]
    v_mfma_f32_16x16x32_bf16 v[240:243], v[116:119], v[36:39], v[240:243]
    s_waitcnt lgkmcnt(2)
    v_mfma_f32_16x16x32_bf16 v[244:247], v[40:43], v[40:43], v[244:247]
    v_mfma_f32_16x16x32_bf16 v[240:243], v[120:123], v[40:43], v[240:243]
    s_waitcnt lgkmcnt(0)
    v_mfma_f32_16x16x32_bf16 v[244:247], v[44:47], v[44:47], v[244:247]
    v_mfma_f32_16x16x32_bf16 v[240:243], v[124:127], v[44:47], v[240:243]
    s_cmp_eq_u32 s29, 2
p3_w1:
    s_cbranch_scc1 p3_v2
    v_mfma_f32_16x16x32_bf16 v[236:239], v[64:67], v[16:19], 0
    s_nop 3
    v_cndmask_b32 v248, v244, v245, s[32:33]
    v_cndmask_b32 v249, v246, v247, s[34:35]
    ds_write_b128 v203, v[240:243] offset:57344
    v_cndmask_b32 v248, v248, v249, s[54:55]
    s_mov_b64 exec, s[38:39]
    ds_write_b32 v196, v248
    v_cmp_u_f32 vcc, v248, v248
    s_mov_b64 exec, -1
    v_mfma_f32_16x16x32_bf16 v[236:239], v[68:71], v[20:23], v[236:239]
    s_cbranch_vccnz p3_bad
p3_oka:
    v_mfma_f32_16x16x32_bf16 v[236:239], v[72:75], v[24:27], v[236:239]
    s_waitcnt lgkmcnt(0)
    s_barrier
    ds_read2_b32 v[248:249], v211 offset0:0 offset1:16
    ds_read_b128 v[56:59], v204 offset:57344
    v_mfma_f32_16x16x32_bf16 v[236:239], v[76:79], v[28:31], v[236:239]
    v_mfma_f32_16x16x32_bf16 v[236:239], v[80:83], v[32:35], v[236:239]
    v_mfma_f32_16x16x32_bf16 v[236:239], v[84:87], v[36:39], v[236:239]
    v_mfma_f32_16x16x32_bf16 v[236:239], v[88:91], v[40:43], v[236:239]
    v_mfma_f32_16x16x32_bf16 v[236:239], v[92:95], v[44:47], v[236:239]
    s_waitcnt lgkmcnt(1)
    v_add_f32 v248, v248, v249
    v_fma_f32 v248, 0.5, v248, v194
    v_rsq_f32 v248, v248
    s_cmp_eq_u32 s4, 0
    v_mul_f32 v250, s28, v248
    s_waitcnt lgkmcnt(0)
    s_nop 0
    v_pk_add_f32 v[236:237], v[236:237], v[56:57]
    v_pk_add_f32 v[238:239], v[238:239], v[58:59]
    v_pk_mul_f32 v[236:237], v[236:237], v[250:251] op_sel_hi:[1,0]
    v_pk_mul_f32 v[238:239], v[238:239], v[250:251] op_sel_hi:[1,0]
    v_cvt_pk_bf16_f32 v56, v236, v237
    v_cvt_pk_bf16_f32 v57, v238, v239
p3_w2:
    buffer_store_dwordx2 v[56:57], v199, s[8:11], s30 offen sc1
    s_cbranch_scc1 p3_n4
    s_lshl_b32 s20, s24, 10
    s_add_u32 s20, s20, 98304
    v_add_u32 v195, s20, v197
    ds_read_b128 v[56:59], v195 offset:0
    ds_read_b128 v[60:63], v195 offset:2048
    ds_read_b128 v[64:67], v195 offset:4096
    ds_read_b128 v[68:71], v195 offset:6144
    ds_read_b128 v[72:75], v195 offset:8192
    ds_read_b128 v[76:79], v195 offset:10240
    ds_read_b128 v[80:83], v195 offset:12288
    ds_read_b128 v[84:87], v195 offset:14336
p3_n4:
    v_mfma_f32_16x16x32_bf16 v[240:243], v[160:163], v[16:19], 0
    v_mul_f32 v248, 0x3eb8aa3b, v248
    s_mul_i32 s21, s24, 7
    v_mfma_f32_16x16x32_bf16 v[244:247], v[128:131], v[16:19], 0
    s_sub_u32 s21, s19, s21
    s_lshl_b32 s21, s21, 16
    v_mfma_f32_16x16x32_bf16 v[240:243], v[164:167], v[20:23], v[240:243]
    s_add_u32 s21, s21, s30
    s_sub_u32 s21, s21, 4718592
    v_mfma_f32_16x16x32_bf16 v[244:247], v[132:135], v[20:23], v[244:247]
    s_add_u32 s20, s30, 1048576
    s_mov_b32 s32, 0x3b800000
    v_mfma_f32_16x16x32_bf16 v[240:243], v[168:171], v[24:27], v[240:243]
    s_mov_b32 s33, 0x3b800000
    s_lshl_b32 s34, s24, 31
    v_mfma_f32_16x16x32_bf16 v[244:247], v[136:139], v[24:27], v[244:247]
    s_or_b32 s34, s34, s32
    s_mov_b32 s35, s34
    v_mfma_f32_16x16x32_bf16 v[240:243], v[172:175], v[28:31], v[240:243]
    s_cmp_eq_u32 s17, 1
    s_cselect_b64 vcc, -1, 0
    v_mfma_f32_16x16x32_bf16 v[244:247], v[140:143], v[28:31], v[244:247]
    s_cmp_eq_u32 s4, 0
    ds_write_b32 v2, v48 offset:32
    v_mfma_f32_16x16x32_bf16 v[240:243], v[176:179], v[32:35], v[240:243]
    ds_write_b32 v53, v48 offset:32
    ds_write_b32 v5, v48 offset:51200
    v_mfma_f32_16x16x32_bf16 v[244:247], v[144:147], v[32:35], v[244:247]
    v_mfma_f32_16x16x32_bf16 v[240:243], v[180:183], v[36:39], v[240:243]
    v_mfma_f32_16x16x32_bf16 v[244:247], v[148:151], v[36:39], v[244:247]
    v_mfma_f32_16x16x32_bf16 v[240:243], v[184:187], v[40:43], v[240:243]
    v_mfma_f32_16x16x32_bf16 v[244:247], v[152:155], v[40:43], v[244:247]
    v_mfma_f32_16x16x32_bf16 v[240:243], v[188:191], v[44:47], v[240:243]
    v_mfma_f32_16x16x32_bf16 v[244:247], v[156:159], v[44:47], v[244:247]
    s_cbranch_vccnz p3_y3
    s_nop 7
    ds_write_b128 v204, v[240:243] offset:57344
    s_waitcnt lgkmcnt(4)
    s_branch p3_m3
p3_y3:
    v_mfma_f32_16x16x32_bf16 v[232:235], v[220:223], v[16:19], 0
    v_xor_b32 v220, v207, v220
    v_cndmask_b32 v220, v220, v201, s[36:37]
    v_xor_b32 v221, v207, v221
    v_xor_b32 v222, v207, v222
    v_xor_b32 v223, v207, v223
    v_mfma_f32_16x16x32_bf16 v[228:231], v[212:215], v[16:19], 0
    ds_write_b128 v204, v[240:243] offset:57344
    v_xor_b32 v212, v207, v212
    v_cndmask_b32 v212, v212, v201, s[36:37]
    v_xor_b32 v213, v207, v213
    v_xor_b32 v214, v207, v214
    v_xor_b32 v215, v207, v215
    v_mfma_f32_16x16x32_bf16 v[232:235], v[224:227], v[20:23], v[232:235]
    v_xor_b32 v224, v207, v224
    v_xor_b32 v225, v207, v225
    v_xor_b32 v226, v207, v226
    v_xor_b32 v227, v207, v227
    v_mfma_f32_16x16x32_bf16 v[228:231], v[216:219], v[20:23], v[228:231]
    v_xor_b32 v216, v207, v216
    v_xor_b32 v217, v207, v217
    v_xor_b32 v218, v207, v218
    v_xor_b32 v219, v207, v219
    v_mfma_f32_16x16x32_bf16 v[232:235], v[220:223], v[24:27], v[232:235]
    v_perm_b32 v220, v220, v220, v205
    v_xor_b32 v220, v206, v220
    v_perm_b32 v221, v221, v221, v205
    v_xor_b32 v221, v206, v221
    v_perm_b32 v222, v222, v222, v205
    v_xor_b32 v222, v206, v222
    v_perm_b32 v223, v223, v223, v205
    v_xor_b32 v223, v206, v223
    v_mfma_f32_16x16x32_bf16 v[228:231], v[212:215], v[24:27], v[228:231]
    v_perm_b32 v212, v212, v212, v205
    v_xor_b32 v212, v206, v212
    v_perm_b32 v213, v213, v213, v205
    v_xor_b32 v213, v206, v213
    v_perm_b32 v214, v214, v214, v205
    v_xor_b32 v214, v206, v214
    v_perm_b32 v215, v215, v215, v205
    v_xor_b32 v215, v206, v215
    v_mfma_f32_16x16x32_bf16 v[232:235], v[224:227], v[28:31], v[232:235]
    buffer_load_dwordx4 v[88:91], v9, s[8:11], s58 offen sc1
    v_perm_b32 v224, v224, v224, v205
    v_xor_b32 v224, v206, v224
    v_perm_b32 v225, v225, v225, v205
    v_xor_b32 v225, v206, v225
    v_perm_b32 v226, v226, v226, v205
    v_xor_b32 v226, v206, v226
    v_perm_b32 v227, v227, v227, v205
    v_xor_b32 v227, v206, v227
    v_mfma_f32_16x16x32_bf16 v[228:231], v[216:219], v[28:31], v[228:231]
    buffer_load_dwordx4 v[96:99], v1, s[8:11], s59 offen offset:0 sc1
    v_perm_b32 v216, v216, v216, v205
    v_xor_b32 v216, v206, v216
    v_perm_b32 v217, v217, v217, v205
    v_xor_b32 v217, v206, v217
    v_perm_b32 v218, v218, v218, v205
    v_xor_b32 v218, v206, v218
    v_perm_b32 v219, v219, v219, v205
    v_xor_b32 v219, v206, v219
    v_mfma_f32_16x16x32_bf16 v[232:235], v[220:223], v[32:35], v[232:235]
    buffer_load_dwordx4 v[92:95], v9, s[8:11], s62 offen sc1
    v_xor_b32 v220, v207, v220
    v_cndmask_b32 v220, v220, v202, s[36:37]
    v_xor_b32 v221, v207, v221
    v_xor_b32 v222, v207, v222
    v_xor_b32 v223, v207, v223
    v_mfma_f32_16x16x32_bf16 v[228:231], v[212:215], v[32:35], v[228:231]
    buffer_load_dwordx4 v[100:103], v10, s[8:11], s59 offen offset:1024 sc1
    v_xor_b32 v212, v207, v212
    v_cndmask_b32 v212, v212, v202, s[36:37]
    v_xor_b32 v213, v207, v213
    v_xor_b32 v214, v207, v214
    v_xor_b32 v215, v207, v215
    v_mfma_f32_16x16x32_bf16 v[232:235], v[224:227], v[36:39], v[232:235]
    buffer_load_dwordx4 v[104:107], v10, s[8:11], s59 offen offset:1536 sc1
    v_xor_b32 v224, v207, v224
    v_xor_b32 v225, v207, v225
    v_xor_b32 v226, v207, v226
    v_xor_b32 v227, v207, v227
    v_mfma_f32_16x16x32_bf16 v[228:231], v[216:219], v[36:39], v[228:231]
    v_xor_b32 v216, v207, v216
    v_xor_b32 v217, v207, v217
    v_xor_b32 v218, v207, v218
    v_xor_b32 v219, v207, v219
    v_mfma_f32_16x16x32_bf16 v[232:235], v[220:223], v[40:43], v[232:235]
    v_mfma_f32_16x16x32_bf16 v[228:231], v[212:215], v[40:43], v[228:231]
    v_mfma_f32_16x16x32_bf16 v[232:235], v[224:227], v[44:47], v[232:235]
    v_mfma_f32_16x16x32_bf16 v[228:231], v[216:219], v[44:47], v[228:231]
    s_nop 6
    ds_write_b128 v203, v[232:235] offset:37376
p3_m3:
    s_cbranch_scc1 p3_m4
    s_waitcnt lgkmcnt(5)
    v_mfma_f32_16x16x32_bf16 v[236:239], v[56:59], v[16:19], 0
    v_mfma_f32_16x16x32_bf16 v[236:239], v[60:63], v[20:23], v[236:239]
    v_mfma_f32_16x16x32_bf16 v[236:239], v[64:67], v[24:27], v[236:239]
    v_mfma_f32_16x16x32_bf16 v[236:239], v[68:71], v[28:31], v[236:239]
    v_mfma_f32_16x16x32_bf16 v[236:239], v[72:75], v[32:35], v[236:239]
    v_mfma_f32_16x16x32_bf16 v[236:239], v[76:79], v[36:39], v[236:239]
    v_mfma_f32_16x16x32_bf16 v[236:239], v[80:83], v[40:43], v[236:239]
    v_mfma_f32_16x16x32_bf16 v[236:239], v[84:87], v[44:47], v[236:239]
    s_nop 7
    ds_write_b128 v203, v[236:239] offset:45568
p3_m4:
    s_waitcnt lgkmcnt(0)
    s_barrier
    ds_read_b128 v[56:59], v203 offset:57344
    ds_read_b128 v[60:63], v204 offset:45568
    ds_read_b128 v[232:235], v204 offset:37376
    s_setprio 3
    s_cbranch_vccnz p3_nd
    buffer_load_dwordx4 v[88:91], v9, s[8:11], s58 offen sc1
    buffer_load_dwordx4 v[96:99], v1, s[8:11], s59 offen offset:0 sc1
    buffer_load_dwordx4 v[92:95], v9, s[8:11], s62 offen sc1
    buffer_load_dwordx4 v[100:103], v10, s[8:11], s59 offen offset:1024 sc1
    buffer_load_dwordx4 v[104:107], v10, s[8:11], s59 offen offset:1536 sc1
p3_nd:
    s_waitcnt lgkmcnt(0)
    v_pk_add_f32 v[244:245], v[244:245], v[56:57]
    v_pk_add_f32 v[246:247], v[246:247], v[58:59]
    v_pk_mul_f32 v[244:245], v[244:245], v[248:249] op_sel_hi:[1,0]
    v_pk_mul_f32 v[246:247], v[246:247], v[248:249] op_sel_hi:[1,0]
    v_cvt_pk_bf16_f32 v56, v244, v245
    v_cvt_pk_bf16_f32 v57, v246, v247
    buffer_store_dwordx2 v[56:57], v210, s[8:11], s20 offen sc1
    v_pk_add_f32 v[236:237], v[236:237], v[60:61]
    v_pk_add_f32 v[238:239], v[238:239], v[62:63]
    v_pk_mul_f32 v[236:237], v[236:237], v[248:249] op_sel_hi:[1,0]
    v_pk_mul_f32 v[238:239], v[238:239], v[248:249] op_sel_hi:[1,0]
    v_cvt_pk_bf16_f32 v60, v236, v237
    v_cvt_pk_bf16_f32 v61, v238, v239
    buffer_store_dwordx2 v[60:61], v208, s[8:11], s30 offen sc1
    s_cbranch_vccnz p3_y4
    v_mov_b64 v[220:221], -1
    v_mov_b64 v[222:223], -1
    buffer_store_dwordx4 v[220:223], v13, s[8:11], s31 offen sc1
    s_branch p3_end
p3_y4:
    v_pk_add_f32 v[212:213], v[228:229], v[232:233]
    v_pk_add_f32 v[232:233], v[228:229], v[232:233] neg_lo:[0,1] neg_hi:[0,1]
    v_pk_add_f32 v[214:215], v[230:231], v[234:235]
    v_pk_add_f32 v[234:235], v[230:231], v[234:235] neg_lo:[0,1] neg_hi:[0,1]
    v_pk_mul_f32 v[212:213], v[212:213], s[32:33]
    v_pk_mul_f32 v[232:233], v[232:233], s[34:35]
    v_pk_mul_f32 v[214:215], v[214:215], s[32:33]
    v_pk_mul_f32 v[234:235], v[234:235], s[34:35]
    v_cvt_pk_bf16_f32 v228, v212, v213
    v_cvt_pk_bf16_f32 v229, v214, v215
    v_cvt_pk_bf16_f32 v230, v232, v233
    v_cvt_pk_bf16_f32 v231, v234, v235
    s_nop 0
    v_permlane16_swap_b32 v228, v230
    v_permlane16_swap_b32 v229, v231
    s_nop 0
    buffer_store_dwordx4 v[228:231], v200, s[8:11], s21 offen sc1
p3_end:
    buffer_load_dwordx4 v[108:111], v1, s[8:11], s59 offen offset:2048 sc1
    buffer_load_dwordx4 v[112:115], v10, s[8:11], s59 offen offset:3072 sc1
    buffer_load_dwordx4 v[116:119], v10, s[8:11], s59 offen offset:3584 sc1
    s_add_u32 s59, s59, 4096
    v_mov_b64 v[220:221], -1
    v_mov_b64 v[222:223], -1
    s_lshl_b32 s21, s16, 10
    s_add_u32 m0, s21, 53760
    v_mfma_f32_32x32x16_bf16 v[56:71], v[48:51], v[48:51], 0
    v_mfma_f32_32x32x16_bf16 v[72:87], v[48:51], v[48:51], 0
    v_mfma_f32_32x32x16_bf16 v[240:255], v[48:51], v[48:51], 0
    s_setprio 2
    s_waitcnt vmcnt(6)
    v_max3_u32 v14, v96, v100, v104
    v_max3_u32 v14, v14, v88, v92
    v_cmp_eq_u32 vcc, -1, v14
    s_cbranch_vccnz k4_t0
k4_t0_back:
    v_mfma_f32_32x32x16_bf16 v[16:31], v[96:99], v[88:91], 0
    v_mfma_f32_32x32x16_bf16 v[32:47], v[96:99], v[92:95], 0
    buffer_load_dwordx4 v[120:123], v1, s[8:11], s59 offen offset:0 sc1
    buffer_load_dwordx4 v[124:127], v10, s[8:11], s59 offen offset:1024 sc1
    buffer_load_dwordx4 v[128:131], v10, s[8:11], s59 offen offset:1536 sc1
    s_nop 7
    v_exp_f32 v16, v16
    v_exp_f32 v17, v17
    v_exp_f32 v18, v18
    v_exp_f32 v19, v19
    v_exp_f32 v20, v20
    v_exp_f32 v21, v21
    v_exp_f32 v22, v22
    v_exp_f32 v23, v23
    v_exp_f32 v24, v24
    v_exp_f32 v25, v25
    v_smfmac_f32_32x32x32_bf16 v[56:71], v[100:103], v[16:23], v55
    v_exp_f32 v26, v26
    v_exp_f32 v27, v27
    v_exp_f32 v28, v28
    v_exp_f32 v29, v29
    v_exp_f32 v30, v30
    v_exp_f32 v31, v31
    v_exp_f32 v32, v32
    s_waitcnt vmcnt(3)
    v_max3_u32 v14, v108, v112, v116
    v_exp_f32 v33, v33
    v_cmp_eq_u32 vcc, -1, v14
    v_smfmac_f32_32x32x32_bf16 v[56:71], v[104:107], v[24:31], v55
    s_cbranch_vccnz k4_t1
k4_t1_back:
    s_add_u32 s41, s40, 16384
    s_add_u32 s42, s40, 32768
    s_setprio 3
    v_exp_f32 v34, v34
    v_exp_f32 v35, v35
    v_exp_f32 v36, v36
    v_mfma_f32_32x32x16_bf16 v[16:31], v[108:111], v[88:91], 0
    buffer_load_dwordx4 v[132:135], v1, s[8:11], s59 offen offset:2048 sc1
    v_exp_f32 v37, v37
    v_exp_f32 v38, v38
    v_exp_f32 v39, v39
    v_exp_f32 v40, v40
    v_exp_f32 v41, v41
    v_smfmac_f32_32x32x32_bf16 v[72:87], v[100:103], v[32:39], v55
    buffer_load_dwordx4 v[136:139], v10, s[8:11], s59 offen offset:3072 sc1
    buffer_load_dwordx4 v[140:143], v10, s[8:11], s59 offen offset:3584 sc1
    v_exp_f32 v42, v42
    v_exp_f32 v43, v43
    v_exp_f32 v44, v44
    v_exp_f32 v45, v45
    v_exp_f32 v46, v46
    v_exp_f32 v47, v47
    v_exp_f32 v16, v16
    v_exp_f32 v17, v17
    v_smfmac_f32_32x32x32_bf16 v[72:87], v[104:107], v[40:47], v55
    s_add_u32 s59, s59, 4096
    v_exp_f32 v18, v18
    v_exp_f32 v19, v19
    v_exp_f32 v20, v20
    v_mfma_f32_32x32x16_bf16 v[32:47], v[108:111], v[92:95], 0
    buffer_load_dwordx4 v[144:147], v1, s[8:11], s59 offen offset:0 sc1
    v_exp_f32 v21, v21
    v_exp_f32 v22, v22
    v_exp_f32 v23, v23
    v_exp_f32 v24, v24
    v_exp_f32 v25, v25
    v_smfmac_f32_32x32x32_bf16 v[56:71], v[112:115], v[16:23], v55
    buffer_load_dwordx4 v[148:151], v10, s[8:11], s59 offen offset:1024 sc1
    buffer_load_dwordx4 v[152:155], v10, s[8:11], s59 offen offset:1536 sc1
    v_exp_f32 v26, v26
    v_exp_f32 v27, v27
    v_exp_f32 v28, v28
    v_exp_f32 v29, v29
    v_exp_f32 v30, v30
    v_exp_f32 v31, v31
    v_exp_f32 v32, v32
    s_waitcnt vmcnt(6)
    v_max3_u32 v14, v120, v124, v128
    v_exp_f32 v33, v33
    v_cmp_eq_u32 vcc, -1, v14
    v_smfmac_f32_32x32x32_bf16 v[56:71], v[116:119], v[24:31], v55
    s_cbranch_vccnz k4_t2
k4_t2_back:
    s_add_u32 s43, s40, 49152
    v_exp_f32 v34, v34
    v_exp_f32 v35, v35
    v_exp_f32 v36, v36
    v_mfma_f32_32x32x16_bf16 v[16:31], v[120:123], v[88:91], 0
    buffer_load_dwordx4 v[156:159], v1, s[8:11], s59 offen offset:2048 sc1
    v_exp_f32 v37, v37
    v_exp_f32 v38, v38
    v_exp_f32 v39, v39
    v_exp_f32 v40, v40
    v_exp_f32 v41, v41
    v_smfmac_f32_32x32x32_bf16 v[72:87], v[112:115], v[32:39], v55
    buffer_load_dwordx4 v[160:163], v10, s[8:11], s59 offen offset:3072 sc1
    buffer_load_dwordx4 v[164:167], v10, s[8:11], s59 offen offset:3584 sc1
    v_exp_f32 v42, v42
    v_exp_f32 v43, v43
    v_exp_f32 v44, v44
    v_exp_f32 v45, v45
    v_exp_f32 v46, v46
    v_exp_f32 v47, v47
    v_exp_f32 v16, v16
    v_exp_f32 v17, v17
    v_smfmac_f32_32x32x32_bf16 v[72:87], v[116:119], v[40:47], v55
    s_add_u32 s59, s59, 4096
    v_exp_f32 v18, v18
    v_exp_f32 v19, v19
    v_exp_f32 v20, v20
    v_mfma_f32_32x32x16_bf16 v[32:47], v[120:123], v[92:95], 0
    buffer_load_dwordx4 v[168:171], v1, s[8:11], s59 offen offset:0 sc1
    v_exp_f32 v21, v21
    v_exp_f32 v22, v22
    v_exp_f32 v23, v23
    v_exp_f32 v24, v24
    v_exp_f32 v25, v25
    v_smfmac_f32_32x32x32_bf16 v[56:71], v[124:127], v[16:23], v55
    buffer_load_dwordx4 v[172:175], v10, s[8:11], s59 offen offset:1024 sc1
    buffer_load_dwordx4 v[176:179], v10, s[8:11], s59 offen offset:1536 sc1
    v_exp_f32 v26, v26
    v_exp_f32 v27, v27
    v_exp_f32 v28, v28
    v_exp_f32 v29, v29
    v_exp_f32 v30, v30
    v_exp_f32 v31, v31
    v_exp_f32 v32, v32
    s_waitcnt vmcnt(9)
    v_max3_u32 v14, v132, v136, v140
    v_exp_f32 v33, v33
    v_cmp_eq_u32 vcc, -1, v14
    v_smfmac_f32_32x32x32_bf16 v[56:71], v[128:131], v[24:31], v55
    s_cbranch_vccnz k4_t3
k4_t3_back:
    v_exp_f32 v34, v34
    v_exp_f32 v35, v35
    v_exp_f32 v36, v36
    v_mfma_f32_32x32x16_bf16 v[16:31], v[132:135], v[88:91], 0
    buffer_load_dwordx4 v[180:183], v1, s[8:11], s59 offen offset:2048 sc1
    v_exp_f32 v37, v37
    v_exp_f32 v38, v38
    v_exp_f32 v39, v39
    v_exp_f32 v40, v40
    v_exp_f32 v41, v41
    v_smfmac_f32_32x32x32_bf16 v[72:87], v[124:127], v[32:39], v55
    buffer_load_dwordx4 v[184:187], v10, s[8:11], s59 offen offset:3072 sc1
    buffer_load_dwordx4 v[188:191], v10, s[8:11], s59 offen offset:3584 sc1
    v_exp_f32 v42, v42
    v_exp_f32 v43, v43
    v_exp_f32 v44, v44
    v_exp_f32 v45, v45
    v_exp_f32 v46, v46
    v_exp_f32 v47, v47
    v_exp_f32 v16, v16
    v_exp_f32 v17, v17
    v_smfmac_f32_32x32x32_bf16 v[72:87], v[128:131], v[40:47], v55
    v_exp_f32 v18, v18
    v_exp_f32 v19, v19
    v_exp_f32 v20, v20
    v_mfma_f32_32x32x16_bf16 v[32:47], v[132:135], v[92:95], 0
    s_add_u32 s31, s31, 2097152
    v_exp_f32 v21, v21
    v_exp_f32 v22, v22
    v_exp_f32 v23, v23
    v_exp_f32 v24, v24
    v_exp_f32 v25, v25
    v_smfmac_f32_32x32x32_bf16 v[56:71], v[136:139], v[16:23], v55
    buffer_store_dwordx4 v[220:223], v13, s[8:11], s31 offen sc1
    v_exp_f32 v26, v26
    v_exp_f32 v27, v27
    v_exp_f32 v28, v28
    v_exp_f32 v29, v29
    v_exp_f32 v30, v30
    v_exp_f32 v31, v31
    v_exp_f32 v32, v32
    s_waitcnt vmcnt(10)
    v_max3_u32 v14, v144, v148, v152
    v_exp_f32 v33, v33
    v_cmp_eq_u32 vcc, -1, v14
    v_smfmac_f32_32x32x32_bf16 v[56:71], v[140:143], v[24:31], v55
    s_cbranch_vccnz k4_t4
k4_t4_back:
    buffer_load_dwordx4 v[192:195], v1, s[8:11], s40 offen offset:0
    v_exp_f32 v34, v34
    v_exp_f32 v35, v35
    v_exp_f32 v36, v36
    v_mfma_f32_32x32x16_bf16 v[16:31], v[144:147], v[88:91], 0
    s_add_u32 s31, s31, 2621440
    v_exp_f32 v37, v37
    v_exp_f32 v38, v38
    v_exp_f32 v39, v39
    v_exp_f32 v40, v40
    v_exp_f32 v41, v41
    v_smfmac_f32_32x32x32_bf16 v[72:87], v[136:139], v[32:39], v55
    buffer_store_dwordx4 v[220:223], v13, s[8:11], s31 offen sc1
    v_exp_f32 v42, v42
    v_exp_f32 v43, v43
    v_exp_f32 v44, v44
    v_exp_f32 v45, v45
    v_exp_f32 v46, v46
    v_exp_f32 v47, v47
    v_exp_f32 v16, v16
    v_exp_f32 v17, v17
    v_smfmac_f32_32x32x32_bf16 v[72:87], v[140:143], v[40:47], v55
    buffer_load_dwordx4 v[196:199], v1, s[8:11], s40 offen offset:1024
    v_exp_f32 v18, v18
    v_exp_f32 v19, v19
    v_exp_f32 v20, v20
    v_mfma_f32_32x32x16_bf16 v[32:47], v[144:147], v[92:95], 0
    s_add_u32 s20, s58, 524288
    v_exp_f32 v21, v21
    v_exp_f32 v22, v22
    v_exp_f32 v23, v23
    v_exp_f32 v24, v24
    v_exp_f32 v25, v25
    v_smfmac_f32_32x32x32_bf16 v[56:71], v[148:151], v[16:23], v55
    s_add_u32 s21, s58, 786432
    s_add_u32 s44, s40, 4096
    s_add_u32 s45, s40, 20480
    buffer_load_dwordx4 v[224:227], v9, s[8:11], s20 offen sc1
    v_exp_f32 v26, v26
    v_exp_f32 v27, v27
    v_exp_f32 v28, v28
    v_exp_f32 v29, v29
    v_exp_f32 v30, v30
    v_exp_f32 v31, v31
    v_exp_f32 v32, v32
    s_waitcnt vmcnt(11)
    v_max3_u32 v14, v156, v160, v164
    v_exp_f32 v33, v33
    v_cmp_eq_u32 vcc, -1, v14
    v_smfmac_f32_32x32x32_bf16 v[56:71], v[152:155], v[24:31], v55
    s_cbranch_vccnz k4_t5
k4_t5_back:
    s_setprio 2
    buffer_load_dwordx4 v[228:231], v9, s[8:11], s21 offen sc1
    v_exp_f32 v34, v34
    v_exp_f32 v35, v35
    v_exp_f32 v36, v36
    v_mfma_f32_32x32x16_bf16 v[16:31], v[156:159], v[88:91], 0
    buffer_load_dwordx4 v[200:203], v1, s[8:11], s41 offen offset:0
    v_exp_f32 v37, v37
    v_exp_f32 v38, v38
    v_exp_f32 v39, v39
    v_exp_f32 v40, v40
    v_exp_f32 v41, v41
    v_smfmac_f32_32x32x32_bf16 v[72:87], v[148:151], v[32:39], v55
    s_add_u32 s46, s40, 36864
    s_add_u32 s47, s40, 53248
    buffer_load_dwordx2 v[232:233], v8, s[8:11], s57 offen sc1
    v_exp_f32 v42, v42
    v_exp_f32 v43, v43
    v_exp_f32 v44, v44
    v_exp_f32 v45, v45
    v_exp_f32 v46, v46
    v_exp_f32 v47, v47
    v_exp_f32 v16, v16
    v_exp_f32 v17, v17
    v_smfmac_f32_32x32x32_bf16 v[72:87], v[152:155], v[40:47], v55
    buffer_load_dwordx2 v[234:235], v8, s[8:11], s56 offen sc1
    v_exp_f32 v18, v18
    v_exp_f32 v19, v19
    v_exp_f32 v20, v20
    v_mfma_f32_32x32x16_bf16 v[32:47], v[156:159], v[92:95], 0
    buffer_load_dwordx4 v[204:207], v1, s[8:11], s41 offen offset:1024
    v_exp_f32 v21, v21
    v_exp_f32 v22, v22
    v_exp_f32 v23, v23
    v_exp_f32 v24, v24
    v_exp_f32 v25, v25
    v_smfmac_f32_32x32x32_bf16 v[56:71], v[160:163], v[16:23], v55
    s_add_u32 s48, s40, 8192
    s_add_u32 s49, s40, 24576
    buffer_load_dwordx4 v[208:211], v1, s[8:11], s42 offen offset:0
    v_exp_f32 v26, v26
    v_exp_f32 v27, v27
    v_exp_f32 v28, v28
    v_exp_f32 v29, v29
    v_exp_f32 v30, v30
    v_exp_f32 v31, v31
    v_exp_f32 v32, v32
    s_waitcnt vmcnt(14)
    v_max3_u32 v14, v168, v172, v176
    v_exp_f32 v33, v33
    v_cmp_eq_u32 vcc, -1, v14
    v_smfmac_f32_32x32x32_bf16 v[56:71], v[164:167], v[24:31], v55
    s_cbranch_vccnz k4_t6
k4_t6_back:
    v_exp_f32 v34, v34
    v_exp_f32 v35, v35
    v_exp_f32 v36, v36
    v_mfma_f32_32x32x16_bf16 v[16:31], v[168:171], v[88:91], 0
    v_exp_f32 v37, v37
    v_exp_f32 v38, v38
    v_exp_f32 v39, v39
    v_exp_f32 v40, v40
    v_exp_f32 v41, v41
    v_smfmac_f32_32x32x32_bf16 v[72:87], v[160:163], v[32:39], v55
    s_add_u32 s50, s40, 40960
    s_add_u32 s51, s40, 57344
    buffer_load_dwordx4 v[212:215], v1, s[8:11], s42 offen offset:1024
    v_exp_f32 v42, v42
    v_exp_f32 v43, v43
    v_exp_f32 v44, v44
    v_exp_f32 v45, v45
    v_exp_f32 v46, v46
    v_exp_f32 v47, v47
    v_exp_f32 v16, v16
    v_exp_f32 v17, v17
    v_smfmac_f32_32x32x32_bf16 v[72:87], v[164:167], v[40:47], v55
    v_exp_f32 v18, v18
    v_exp_f32 v19, v19
    v_exp_f32 v20, v20
    v_mfma_f32_32x32x16_bf16 v[32:47], v[168:171], v[92:95], 0
    v_exp_f32 v21, v21
    v_exp_f32 v22, v22
    v_exp_f32 v23, v23
    v_exp_f32 v24, v24
    v_exp_f32 v25, v25
    v_smfmac_f32_32x32x32_bf16 v[56:71], v[172:175], v[16:23], v55
    s_add_u32 s52, s40, 12288
    s_add_u32 s53, s40, 28672
    buffer_load_dwordx4 v[216:219], v1, s[8:11], s43 offen offset:0
    v_exp_f32 v26, v26
    v_exp_f32 v27, v27
    v_exp_f32 v28, v28
    v_exp_f32 v29, v29
    v_exp_f32 v30, v30
    s_waitcnt vmcnt(13)
    v_max3_u32 v14, v180, v184, v188
    v_exp_f32 v31, v31
    s_waitcnt vmcnt(4)
    v_max3_u32 v14, v14, v224, v228
    v_exp_f32 v32, v32
    v_max3_u32 v14, v14, v232, v234
    v_exp_f32 v33, v33
    v_cmp_eq_u32 vcc, -1, v14
    v_smfmac_f32_32x32x32_bf16 v[56:71], v[176:179], v[24:31], v55
    s_cbranch_vccnz k4_t7
k4_t7_back:
    v_exp_f32 v34, v34
    v_exp_f32 v35, v35
    v_exp_f32 v36, v36
    v_mfma_f32_32x32x16_bf16 v[16:31], v[180:183], v[88:91], 0
    v_exp_f32 v37, v37
    v_exp_f32 v38, v38
    v_mov_b64 v[88:89], v[224:225]
    v_exp_f32 v39, v39
    v_mov_b64 v[90:91], v[226:227]
    v_exp_f32 v40, v40
    v_exp_f32 v41, v41
    v_smfmac_f32_32x32x32_bf16 v[72:87], v[172:175], v[32:39], v55
    s_add_u32 s54, s40, 45056
    s_add_u32 s55, s40, 61440
    buffer_load_dwordx4 v[220:223], v1, s[8:11], s43 offen offset:1024
    v_exp_f32 v42, v42
    v_exp_f32 v43, v43
    v_exp_f32 v44, v44
    v_exp_f32 v45, v45
    v_exp_f32 v46, v46
    v_exp_f32 v47, v47
    s_mov_b32 s20, 0xffff0000
    s_cmp_eq_u32 s17, 1
    s_cbranch_scc1 k4_init1
    v_permlane16_swap_b32 v232, v233
    v_permlane16_swap_b32 v234, v235
    v_lshlrev_b32 v240, 16, v232
    v_and_b32 v241, s20, v232
    v_lshlrev_b32 v248, 16, v233
    v_and_b32 v249, s20, v233
    v_lshlrev_b32 v244, 16, v234
    v_and_b32 v245, s20, v234
    v_lshlrev_b32 v252, 16, v235
    v_and_b32 v253, s20, v235
    s_branch k4_init2
k4_init1:
    v_lshlrev_b32 v240, 16, v232
    v_and_b32 v244, s20, v232
    v_lshlrev_b32 v248, 16, v233
    v_and_b32 v252, s20, v233
    v_lshlrev_b32 v241, 16, v234
    v_and_b32 v245, s20, v234
    v_lshlrev_b32 v249, 16, v235
    v_and_b32 v253, s20, v235
k4_init2:
    v_exp_f32 v16, v16
    v_exp_f32 v17, v17
    v_smfmac_f32_32x32x32_bf16 v[72:87], v[176:179], v[40:47], v55
    v_exp_f32 v18, v18
    v_exp_f32 v19, v19
    v_exp_f32 v20, v20
    v_mfma_f32_32x32x16_bf16 v[32:47], v[180:183], v[92:95], 0
    v_exp_f32 v21, v21
    v_exp_f32 v22, v22
    v_mov_b64 v[92:93], v[228:229]
    v_exp_f32 v23, v23
    v_mov_b64 v[94:95], v[230:231]
    v_exp_f32 v24, v24
    v_exp_f32 v25, v25
    v_smfmac_f32_32x32x32_bf16 v[56:71], v[184:187], v[16:23], v55
    s_lshl_b32 s20, s16, 18
    s_add_u32 s20, s20, s58
    buffer_load_dwordx4 v9, s[8:11], s20 offen sc1 lds
    v_exp_f32 v26, v26
    v_exp_f32 v27, v27
    v_exp_f32 v28, v28
    v_exp_f32 v29, v29
    v_exp_f32 v30, v30
    v_exp_f32 v31, v31
    v_exp_f32 v32, v32
    v_exp_f32 v33, v33
    v_smfmac_f32_32x32x32_bf16 v[56:71], v[188:191], v[24:31], v55
    v_exp_f32 v34, v34
    v_exp_f32 v35, v35
    v_exp_f32 v36, v36
    v_mfma_f32_32x32x16_bf16 v[16:31], v[96:99], v[88:91], 0
    v_exp_f32 v37, v37
    v_exp_f32 v38, v38
    v_exp_f32 v39, v39
    v_exp_f32 v40, v40
    v_exp_f32 v41, v41
    v_smfmac_f32_32x32x32_bf16 v[72:87], v[184:187], v[32:39], v55
    v_exp_f32 v42, v42
    v_add_u32 v7, 2048, v7
    v_exp_f32 v43, v43
    ds_write_b128 v2, v[56:59] offset:0
    v_exp_f32 v44, v44
    ds_write_b128 v2, v[60:63] offset:16
    v_exp_f32 v45, v45
    ds_write2_b32 v2, v7, v64 offset0:8 offset1:9
    v_exp_f32 v46, v46
    v_exp_f32 v47, v47
    v_mfma_f32_32x32x16_bf16 v[56:71], v[48:51], v[48:51], 0
    v_exp_f32 v16, v16
    v_exp_f32 v17, v17
    v_smfmac_f32_32x32x32_bf16 v[72:87], v[188:191], v[40:47], v55
    v_exp_f32 v18, v18
    v_exp_f32 v19, v19
    v_exp_f32 v20, v20
    v_mfma_f32_32x32x16_bf16 v[32:47], v[96:99], v[92:95], 0
    v_exp_f32 v21, v21
    v_exp_f32 v22, v22
    v_exp_f32 v23, v23
    v_exp_f32 v24, v24
    v_exp_f32 v25, v25
    v_smfmac_f32_32x32x32_bf16 v[56:71], v[100:103], v[16:23], v55
    v_exp_f32 v26, v26
    v_exp_f32 v27, v27
    ds_write_b128 v2, v[72:75] offset:3072
    v_exp_f32 v28, v28
    ds_write_b128 v2, v[76:79] offset:3088
    v_exp_f32 v29, v29
    ds_write2_b32 v53, v7, v80 offset0:8 offset1:9
    v_exp_f32 v30, v30
    v_mfma_f32_32x32x16_bf16 v[72:87], v[48:51], v[48:51], 0
    v_exp_f32 v31, v31
    v_exp_f32 v32, v32
    v_exp_f32 v33, v33
    v_smfmac_f32_32x32x32_bf16 v[56:71], v[104:107], v[24:31], v55
    s_setprio 1
    v_exp_f32 v34, v34
    v_exp_f32 v35, v35
    v_exp_f32 v36, v36
    v_mfma_f32_32x32x16_bf16 v[16:31], v[108:111], v[88:91], 0
    v_exp_f32 v37, v37
    v_exp_f32 v38, v38
    v_exp_f32 v39, v39
    v_exp_f32 v40, v40
    v_exp_f32 v41, v41
    v_smfmac_f32_32x32x32_bf16 v[72:87], v[100:103], v[32:39], v55
    v_exp_f32 v42, v42
    v_exp_f32 v43, v43
    v_exp_f32 v44, v44
    v_exp_f32 v45, v45
    v_exp_f32 v46, v46
    v_exp_f32 v47, v47
    v_exp_f32 v16, v16
    v_exp_f32 v17, v17
    v_smfmac_f32_32x32x32_bf16 v[72:87], v[104:107], v[40:47], v55
    ds_read_b64 v[8:9], v4 offset:32
    v_exp_f32 v18, v18
    v_exp_f32 v19, v19
    v_exp_f32 v20, v20
    v_mfma_f32_32x32x16_bf16 v[32:47], v[108:111], v[92:95], 0
    ds_read2st64_b64 v[224:227], v3 offset0:0 offset1:12
    v_exp_f32 v21, v21
    v_exp_f32 v22, v22
    v_exp_f32 v23, v23
    v_exp_f32 v24, v24
    v_exp_f32 v25, v25
    v_smfmac_f32_32x32x32_bf16 v[56:71], v[112:115], v[16:23], v55
    ds_read2st64_b64 v[228:231], v3 offset0:24 offset1:36
    v_exp_f32 v26, v26
    v_exp_f32 v27, v27
    v_exp_f32 v28, v28
    v_exp_f32 v29, v29
    v_exp_f32 v30, v30
    v_exp_f32 v31, v31
    v_exp_f32 v32, v32
    v_exp_f32 v33, v33
    v_smfmac_f32_32x32x32_bf16 v[56:71], v[116:119], v[24:31], v55
    ds_read2st64_b64 v[232:235], v3 offset0:48 offset1:60
    v_exp_f32 v34, v34
    v_exp_f32 v35, v35
    v_exp_f32 v36, v36
    v_mfma_f32_32x32x16_bf16 v[16:31], v[120:123], v[88:91], 0
    ds_read2st64_b64 v[236:239], v3 offset0:72 offset1:84
    v_exp_f32 v37, v37
    v_exp_f32 v38, v38
    v_exp_f32 v39, v39
    v_exp_f32 v40, v40
    v_exp_f32 v41, v41
    v_smfmac_f32_32x32x32_bf16 v[72:87], v[112:115], v[32:39], v55
    s_waitcnt lgkmcnt(0)
    s_waitcnt vmcnt(0)
    v_exp_f32 v42, v42
    v_exp_f32 v43, v43
    v_exp_f32 v44, v44
    v_exp_f32 v45, v45
    v_exp_f32 v46, v46
    v_exp_f32 v47, v47
    v_exp_f32 v16, v16
    v_exp_f32 v17, v17
    v_cmp_gt_u32 vcc, 2048, v8
    v_smfmac_f32_32x32x32_bf16 v[72:87], v[116:119], v[40:47], v55
    s_cbranch_vccnz k4_s11
k4_s11_back:
    v_exp_f32 v18, v18
    v_add_f32_dpp v9, v9, v9 quad_perm:[1,0,3,2] row_mask:0xf bank_mask:0xf
    v_exp_f32 v19, v19
    v_add_f32 v224, v224, v226
    v_exp_f32 v20, v20
    v_add_f32 v225, v225, v227
    v_mfma_f32_32x32x16_bf16 v[32:47], v[120:123], v[92:95], 0
    v_exp_f32 v21, v21
    v_add_f32_dpp v9, v9, v9 quad_perm:[2,3,0,1] row_mask:0xf bank_mask:0xf
    v_exp_f32 v22, v22
    v_add_f32 v228, v228, v230
    v_exp_f32 v23, v23
    v_add_f32 v229, v229, v231
    v_exp_f32 v24, v24
    v_add_f32_dpp v9, v9, v9 row_ror:8 row_mask:0xf bank_mask:0xf
    v_exp_f32 v25, v25
    v_add_f32 v232, v232, v234
    v_smfmac_f32_32x32x32_bf16 v[56:71], v[124:127], v[16:23], v55
    v_exp_f32 v26, v26
    v_add_f32 v233, v233, v235
    v_exp_f32 v27, v27
    v_rcp_f32 v10, v9
    v_exp_f32 v28, v28
    v_add_f32 v236, v236, v238
    v_exp_f32 v29, v29
    v_add_f32 v237, v237, v239
    v_exp_f32 v30, v30
    v_add_f32 v224, v224, v228
    v_exp_f32 v31, v31
    v_add_f32 v225, v225, v229
    v_exp_f32 v32, v32
    v_add_f32 v232, v232, v236
    v_exp_f32 v33, v33
    v_add_f32 v233, v233, v237
    v_smfmac_f32_32x32x32_bf16 v[56:71], v[128:131], v[24:31], v55
    v_exp_f32 v34, v34
    v_add_f32 v224, v224, v232
    v_exp_f32 v35, v35
    v_add_f32 v225, v225, v233
    v_exp_f32 v36, v36
    v_mul_f32 v224, v224, v10
    v_mfma_f32_32x32x16_bf16 v[16:31], v[132:135], v[88:91], 0
    buffer_load_dwordx4 v[232:235], v1, s[8:11], s40 offen offset:2048
    v_exp_f32 v37, v37
    v_mul_f32 v225, v225, v10
    v_exp_f32 v38, v38
    v_cvt_pk_bf16_f32 v224, v224, v225
    v_exp_f32 v39, v39
    ds_write2st64_b32 v5, v224, v7 offset0:192 offset1:200
    v_exp_f32 v40, v40
    v_max3_u32 v11, v11, v9, v10
    v_exp_f32 v41, v41
    v_smfmac_f32_32x32x32_bf16 v[72:87], v[124:127], v[32:39], v55
    s_setprio 0
    buffer_load_dwordx4 v[236:239], v1, s[8:11], s40 offen offset:3072
    v_exp_f32 v42, v42
    v_exp_f32 v43, v43
    v_exp_f32 v44, v44
    v_exp_f32 v45, v45
    v_exp_f32 v46, v46
    v_exp_f32 v47, v47
    v_exp_f32 v16, v16
    v_exp_f32 v17, v17
    v_smfmac_f32_32x32x32_bf16 v[72:87], v[128:131], v[40:47], v55
    v_exp_f32 v18, v18
    v_exp_f32 v19, v19
    v_exp_f32 v20, v20
    v_mfma_f32_32x32x16_bf16 v[32:47], v[132:135], v[92:95], 0
    ds_read_b32 v8, v52 offset:51200
    v_exp_f32 v21, v21
    v_exp_f32 v22, v22
    v_exp_f32 v23, v23
    v_exp_f32 v24, v24
    v_exp_f32 v25, v25
    v_smfmac_f32_32x32x32_bf16 v[56:71], v[136:139], v[16:23], v55
    ds_read_b128 v[224:227], v1 offset:49152
    v_exp_f32 v26, v26
    v_exp_f32 v27, v27
    v_exp_f32 v28, v28
    v_exp_f32 v29, v29
    v_exp_f32 v30, v30
    v_exp_f32 v31, v31
    v_exp_f32 v32, v32
    v_exp_f32 v33, v33
    v_smfmac_f32_32x32x32_bf16 v[56:71], v[140:143], v[24:31], v55
    ds_read_b128 v[228:231], v1 offset:50176
    v_exp_f32 v34, v34
    v_exp_f32 v35, v35
    v_exp_f32 v36, v36
    v_mfma_f32_32x32x16_bf16 v[16:31], v[144:147], v[88:91], 0
    s_waitcnt lgkmcnt(0)
    v_exp_f32 v37, v37
    v_exp_f32 v38, v38
    v_exp_f32 v39, v39
    v_exp_f32 v40, v40
    v_exp_f32 v41, v41
    v_cmp_gt_u32 vcc, 2048, v8
    v_smfmac_f32_32x32x32_bf16 v[72:87], v[136:139], v[32:39], v55
    s_cbranch_vccnz k4_s21
k4_s21_back:
    s_setprio 3
    v_exp_f32 v42, v42
    v_exp_f32 v43, v43
    v_exp_f32 v44, v44
    v_exp_f32 v45, v45
    v_smfmac_f32_16x16x64_bf16 v[240:243], v[224:227], v[192:199], v54
    buffer_load_dwordx4 v[192:195], v1, s[8:11], s41 offen offset:2048
    v_exp_f32 v46, v46
    v_exp_f32 v47, v47
    v_exp_f32 v16, v16
    v_exp_f32 v17, v17
    v_smfmac_f32_32x32x32_bf16 v[72:87], v[140:143], v[40:47], v55
    buffer_load_dwordx4 v[196:199], v1, s[8:11], s41 offen offset:3072
    v_exp_f32 v18, v18
    v_exp_f32 v19, v19
    v_exp_f32 v20, v20
    v_mfma_f32_32x32x16_bf16 v[32:47], v[144:147], v[92:95], 0
    v_exp_f32 v21, v21
    v_exp_f32 v22, v22
    v_exp_f32 v23, v23
    v_exp_f32 v24, v24
    v_exp_f32 v25, v25
    v_smfmac_f32_32x32x32_bf16 v[56:71], v[148:151], v[16:23], v55
    v_exp_f32 v26, v26
    v_exp_f32 v27, v27
    v_exp_f32 v28, v28
    v_exp_f32 v29, v29
    v_smfmac_f32_16x16x64_bf16 v[244:247], v[224:227], v[200:207], v54
    buffer_load_dwordx4 v[200:203], v1, s[8:11], s42 offen offset:2048
    v_exp_f32 v30, v30
    v_exp_f32 v31, v31
    v_exp_f32 v32, v32
    v_exp_f32 v33, v33
    v_smfmac_f32_32x32x32_bf16 v[56:71], v[152:155], v[24:31], v55
    v_exp_f32 v34, v34
    v_exp_f32 v35, v35
    v_exp_f32 v36, v36
    v_mfma_f32_32x32x16_bf16 v[16:31], v[156:159], v[88:91], 0
    v_exp_f32 v37, v37
    v_exp_f32 v38, v38
    v_exp_f32 v39, v39
    v_exp_f32 v40, v40
    v_exp_f32 v41, v41
    v_smfmac_f32_32x32x32_bf16 v[72:87], v[148:151], v[32:39], v55
    buffer_load_dwordx4 v[204:207], v1, s[8:11], s42 offen offset:3072
    v_exp_f32 v42, v42
    v_exp_f32 v43, v43
    v_exp_f32 v44, v44
    v_exp_f32 v45, v45
    v_smfmac_f32_16x16x64_bf16 v[248:251], v[224:227], v[208:215], v54
    v_exp_f32 v46, v46
    v_exp_f32 v47, v47
    v_exp_f32 v16, v16
    v_exp_f32 v17, v17
    v_smfmac_f32_32x32x32_bf16 v[72:87], v[152:155], v[40:47], v55
    v_exp_f32 v18, v18
    v_exp_f32 v19, v19
    v_exp_f32 v20, v20
    v_mfma_f32_32x32x16_bf16 v[32:47], v[156:159], v[92:95], 0
    buffer_load_dwordx4 v[208:211], v1, s[8:11], s43 offen offset:2048
    v_exp_f32 v21, v21
    v_exp_f32 v22, v22
    v_exp_f32 v23, v23
    v_exp_f32 v24, v24
    v_exp_f32 v25, v25
    v_smfmac_f32_32x32x32_bf16 v[56:71], v[160:163], v[16:23], v55
    v_exp_f32 v26, v26
    v_exp_f32 v27, v27
    v_exp_f32 v28, v28
    v_exp_f32 v29, v29
    v_smfmac_f32_16x16x64_bf16 v[252:255], v[224:227], v[216:223], v54
    v_exp_f32 v30, v30
    v_exp_f32 v31, v31
    v_exp_f32 v32, v32
    v_exp_f32 v33, v33
    v_smfmac_f32_32x32x32_bf16 v[56:71], v[164:167], v[24:31], v55
    buffer_load_dwordx4 v[212:215], v1, s[8:11], s43 offen offset:3072
    v_exp_f32 v34, v34
    v_exp_f32 v35, v35
    v_exp_f32 v36, v36
    v_mfma_f32_32x32x16_bf16 v[16:31], v[168:171], v[88:91], 0
    v_exp_f32 v37, v37
    v_exp_f32 v38, v38
    v_exp_f32 v39, v39
    v_exp_f32 v40, v40
    v_exp_f32 v41, v41
    v_smfmac_f32_32x32x32_bf16 v[72:87], v[160:163], v[32:39], v55
    s_waitcnt vmcnt(6)
    v_exp_f32 v42, v42
    v_exp_f32 v43, v43
    v_exp_f32 v44, v44
    v_exp_f32 v45, v45
    v_smfmac_f32_16x16x64_bf16 v[240:243], v[228:231], v[232:239], v54
    buffer_load_dwordx4 v[216:219], v1, s[8:11], s47 offen offset:0
    v_exp_f32 v46, v46
    v_exp_f32 v47, v47
    v_exp_f32 v16, v16
    v_exp_f32 v17, v17
    v_smfmac_f32_32x32x32_bf16 v[72:87], v[164:167], v[40:47], v55
    s_setprio 2
    v_exp_f32 v18, v18
    v_exp_f32 v19, v19
    v_exp_f32 v20, v20
    v_mfma_f32_32x32x16_bf16 v[32:47], v[168:171], v[92:95], 0
    v_exp_f32 v21, v21
    v_exp_f32 v22, v22
    v_exp_f32 v23, v23
    v_exp_f32 v24, v24
    v_exp_f32 v25, v25
    v_smfmac_f32_32x32x32_bf16 v[56:71], v[172:175], v[16:23], v55
    s_waitcnt vmcnt(5)
    buffer_load_dwordx4 v[220:223], v1, s[8:11], s47 offen offset:1024
    v_exp_f32 v26, v26
    v_exp_f32 v27, v27
    v_exp_f32 v28, v28
    v_exp_f32 v29, v29
    v_smfmac_f32_16x16x64_bf16 v[244:247], v[228:231], v[192:199], v54
    v_exp_f32 v30, v30
    v_exp_f32 v31, v31
    v_exp_f32 v32, v32
    v_exp_f32 v33, v33
    v_smfmac_f32_32x32x32_bf16 v[56:71], v[176:179], v[24:31], v55
    v_exp_f32 v34, v34
    v_exp_f32 v35, v35
    v_exp_f32 v36, v36
    v_mfma_f32_32x32x16_bf16 v[16:31], v[180:183], v[88:91], 0
    ds_read_b128 v[88:91], v7 offset:55808
    v_exp_f32 v37, v37
    v_exp_f32 v38, v38
    v_exp_f32 v39, v39
    v_exp_f32 v40, v40
    v_exp_f32 v41, v41
    v_smfmac_f32_32x32x32_bf16 v[72:87], v[172:175], v[32:39], v55
    s_waitcnt vmcnt(4)
    buffer_load_dwordx4 v[192:195], v1, s[8:11], s44 offen offset:0
    v_exp_f32 v42, v42
    v_exp_f32 v43, v43
    v_exp_f32 v44, v44
    v_exp_f32 v45, v45
    v_smfmac_f32_16x16x64_bf16 v[248:251], v[228:231], v[200:207], v54
    v_exp_f32 v46, v46
    v_exp_f32 v47, v47
    v_exp_f32 v16, v16
    v_exp_f32 v17, v17
    v_smfmac_f32_32x32x32_bf16 v[72:87], v[176:179], v[40:47], v55
    buffer_load_dwordx4 v[196:199], v1, s[8:11], s44 offen offset:1024
    v_exp_f32 v18, v18
    v_exp_f32 v19, v19
    v_exp_f32 v20, v20
    v_mfma_f32_32x32x16_bf16 v[32:47], v[180:183], v[92:95], 0
    ds_read_b128 v[92:95], v7 offset:56832
    v_exp_f32 v21, v21
    v_exp_f32 v22, v22
    v_exp_f32 v23, v23
    v_exp_f32 v24, v24
    v_exp_f32 v25, v25
    v_smfmac_f32_32x32x32_bf16 v[56:71], v[184:187], v[16:23], v55
    s_waitcnt vmcnt(4)
    v_exp_f32 v26, v26
    v_exp_f32 v27, v27
    v_exp_f32 v28, v28
    v_exp_f32 v29, v29
    v_smfmac_f32_16x16x64_bf16 v[252:255], v[228:231], v[208:215], v54
    buffer_load_dwordx4 v[200:203], v1, s[8:11], s45 offen offset:0
    v_exp_f32 v30, v30
    v_exp_f32 v31, v31
    v_exp_f32 v32, v32
    v_exp_f32 v33, v33
    v_smfmac_f32_32x32x32_bf16 v[56:71], v[188:191], v[24:31], v55
    s_waitcnt lgkmcnt(0)
    v_exp_f32 v34, v34
    v_exp_f32 v35, v35
    v_exp_f32 v36, v36
    v_mfma_f32_32x32x16_bf16 v[16:31], v[96:99], v[88:91], 0
    v_exp_f32 v37, v37
    v_exp_f32 v38, v38
    v_exp_f32 v39, v39
    v_exp_f32 v40, v40
    v_exp_f32 v41, v41
    v_smfmac_f32_32x32x32_bf16 v[72:87], v[184:187], v[32:39], v55
    buffer_load_dwordx4 v[204:207], v1, s[8:11], s45 offen offset:1024
    v_exp_f32 v42, v42
    v_add_u32 v7, 2048, v7
    v_exp_f32 v43, v43
    ds_write_b128 v2, v[56:59] offset:0
    v_exp_f32 v44, v44
    ds_write_b128 v2, v[60:63] offset:16
    v_exp_f32 v45, v45
    ds_write2_b32 v2, v7, v64 offset0:8 offset1:9
    v_exp_f32 v46, v46
    v_exp_f32 v47, v47
    v_mfma_f32_32x32x16_bf16 v[56:71], v[48:51], v[48:51], 0
    v_exp_f32 v16, v16
    v_exp_f32 v17, v17
    v_smfmac_f32_32x32x32_bf16 v[72:87], v[188:191], v[40:47], v55
    v_exp_f32 v18, v18
    v_exp_f32 v19, v19
    v_exp_f32 v20, v20
    v_mfma_f32_32x32x16_bf16 v[32:47], v[96:99], v[92:95], 0
    buffer_load_dwordx4 v[208:211], v1, s[8:11], s46 offen offset:0
    v_exp_f32 v21, v21
    v_exp_f32 v22, v22
    v_exp_f32 v23, v23
    v_exp_f32 v24, v24
    v_exp_f32 v25, v25
    v_smfmac_f32_32x32x32_bf16 v[56:71], v[100:103], v[16:23], v55
    v_exp_f32 v26, v26
    v_exp_f32 v27, v27
    ds_write_b128 v2, v[72:75] offset:3072
    v_exp_f32 v28, v28
    ds_write_b128 v2, v[76:79] offset:3088
    v_exp_f32 v29, v29
    ds_write2_b32 v53, v7, v80 offset0:8 offset1:9
    v_exp_f32 v30, v30
    v_mfma_f32_32x32x16_bf16 v[72:87], v[48:51], v[48:51], 0
    v_exp_f32 v31, v31
    v_exp_f32 v32, v32
    v_exp_f32 v33, v33
    v_smfmac_f32_32x32x32_bf16 v[56:71], v[104:107], v[24:31], v55
    s_setprio 1
    buffer_load_dwordx4 v[212:215], v1, s[8:11], s46 offen offset:1024
    v_exp_f32 v34, v34
    v_exp_f32 v35, v35
    v_exp_f32 v36, v36
    v_mfma_f32_32x32x16_bf16 v[16:31], v[108:111], v[88:91], 0
    v_exp_f32 v37, v37
    v_exp_f32 v38, v38
    v_exp_f32 v39, v39
    v_exp_f32 v40, v40
    v_exp_f32 v41, v41
    v_smfmac_f32_32x32x32_bf16 v[72:87], v[100:103], v[32:39], v55
    v_exp_f32 v42, v42
    v_exp_f32 v43, v43
    v_exp_f32 v44, v44
    v_exp_f32 v45, v45
    v_exp_f32 v46, v46
    v_exp_f32 v47, v47
    v_exp_f32 v16, v16
    v_exp_f32 v17, v17
    v_smfmac_f32_32x32x32_bf16 v[72:87], v[104:107], v[40:47], v55
    ds_read_b64 v[8:9], v4 offset:32
    v_exp_f32 v18, v18
    v_exp_f32 v19, v19
    v_exp_f32 v20, v20
    v_mfma_f32_32x32x16_bf16 v[32:47], v[108:111], v[92:95], 0
    ds_read2st64_b64 v[224:227], v3 offset0:0 offset1:12
    v_exp_f32 v21, v21
    v_exp_f32 v22, v22
    v_exp_f32 v23, v23
    v_exp_f32 v24, v24
    v_exp_f32 v25, v25
    v_smfmac_f32_32x32x32_bf16 v[56:71], v[112:115], v[16:23], v55
    ds_read2st64_b64 v[228:231], v3 offset0:24 offset1:36
    v_exp_f32 v26, v26
    v_exp_f32 v27, v27
    v_exp_f32 v28, v28
    v_exp_f32 v29, v29
    v_exp_f32 v30, v30
    v_exp_f32 v31, v31
    v_exp_f32 v32, v32
    v_exp_f32 v33, v33
    v_smfmac_f32_32x32x32_bf16 v[56:71], v[116:119], v[24:31], v55
    ds_read2st64_b64 v[232:235], v3 offset0:48 offset1:60
    v_exp_f32 v34, v34
    v_exp_f32 v35, v35
    v_exp_f32 v36, v36
    v_mfma_f32_32x32x16_bf16 v[16:31], v[120:123], v[88:91], 0
    ds_read2st64_b64 v[236:239], v3 offset0:72 offset1:84
    v_exp_f32 v37, v37
    v_exp_f32 v38, v38
    v_exp_f32 v39, v39
    v_exp_f32 v40, v40
    v_exp_f32 v41, v41
    v_smfmac_f32_32x32x32_bf16 v[72:87], v[112:115], v[32:39], v55
    s_waitcnt lgkmcnt(0)
    v_exp_f32 v42, v42
    v_exp_f32 v43, v43
    v_exp_f32 v44, v44
    v_exp_f32 v45, v45
    v_exp_f32 v46, v46
    v_exp_f32 v47, v47
    v_exp_f32 v16, v16
    v_exp_f32 v17, v17
    v_cmp_gt_u32 vcc, 4096, v8
    v_smfmac_f32_32x32x32_bf16 v[72:87], v[116:119], v[40:47], v55
    s_cbranch_vccnz k4_s12
k4_s12_back:
    v_exp_f32 v18, v18
    v_add_f32_dpp v9, v9, v9 quad_perm:[1,0,3,2] row_mask:0xf bank_mask:0xf
    v_exp_f32 v19, v19
    v_add_f32 v224, v224, v226
    v_exp_f32 v20, v20
    v_add_f32 v225, v225, v227
    v_mfma_f32_32x32x16_bf16 v[32:47], v[120:123], v[92:95], 0
    v_exp_f32 v21, v21
    v_add_f32_dpp v9, v9, v9 quad_perm:[2,3,0,1] row_mask:0xf bank_mask:0xf
    v_exp_f32 v22, v22
    v_add_f32 v228, v228, v230
    v_exp_f32 v23, v23
    v_add_f32 v229, v229, v231
    v_exp_f32 v24, v24
    v_add_f32_dpp v9, v9, v9 row_ror:8 row_mask:0xf bank_mask:0xf
    v_exp_f32 v25, v25
    v_add_f32 v232, v232, v234
    v_smfmac_f32_32x32x32_bf16 v[56:71], v[124:127], v[16:23], v55
    v_exp_f32 v26, v26
    v_add_f32 v233, v233, v235
    v_exp_f32 v27, v27
    v_rcp_f32 v10, v9
    v_exp_f32 v28, v28
    v_add_f32 v236, v236, v238
    v_exp_f32 v29, v29
    v_add_f32 v237, v237, v239
    v_exp_f32 v30, v30
    v_add_f32 v224, v224, v228
    v_exp_f32 v31, v31
    v_add_f32 v225, v225, v229
    v_exp_f32 v32, v32
    v_add_f32 v232, v232, v236
    v_exp_f32 v33, v33
    v_add_f32 v233, v233, v237
    v_smfmac_f32_32x32x32_bf16 v[56:71], v[128:131], v[24:31], v55
    v_exp_f32 v34, v34
    v_add_f32 v224, v224, v232
    v_exp_f32 v35, v35
    v_add_f32 v225, v225, v233
    v_exp_f32 v36, v36
    v_mul_f32 v224, v224, v10
    v_mfma_f32_32x32x16_bf16 v[16:31], v[132:135], v[88:91], 0
    buffer_load_dwordx4 v[232:235], v1, s[8:11], s44 offen offset:2048
    v_exp_f32 v37, v37
    v_mul_f32 v225, v225, v10
    v_exp_f32 v38, v38
    v_cvt_pk_bf16_f32 v224, v224, v225
    v_exp_f32 v39, v39
    ds_write2st64_b32 v5, v224, v7 offset0:192 offset1:200
    v_exp_f32 v40, v40
    v_max3_u32 v11, v11, v9, v10
    v_exp_f32 v41, v41
    v_smfmac_f32_32x32x32_bf16 v[72:87], v[124:127], v[32:39], v55
    s_setprio 0
    buffer_load_dwordx4 v[236:239], v1, s[8:11], s44 offen offset:3072
    v_exp_f32 v42, v42
    v_exp_f32 v43, v43
    v_exp_f32 v44, v44
    v_exp_f32 v45, v45
    v_exp_f32 v46, v46
    v_exp_f32 v47, v47
    v_exp_f32 v16, v16
    v_exp_f32 v17, v17
    v_smfmac_f32_32x32x32_bf16 v[72:87], v[128:131], v[40:47], v55
    v_exp_f32 v18, v18
    v_exp_f32 v19, v19
    v_exp_f32 v20, v20
    v_mfma_f32_32x32x16_bf16 v[32:47], v[132:135], v[92:95], 0
    ds_read_b32 v8, v52 offset:51200
    v_exp_f32 v21, v21
    v_exp_f32 v22, v22
    v_exp_f32 v23, v23
    v_exp_f32 v24, v24
    v_exp_f32 v25, v25
    v_smfmac_f32_32x32x32_bf16 v[56:71], v[136:139], v[16:23], v55
    ds_read_b128 v[224:227], v1 offset:49152
    v_exp_f32 v26, v26
    v_exp_f32 v27, v27
    v_exp_f32 v28, v28
    v_exp_f32 v29, v29
    v_exp_f32 v30, v30
    v_exp_f32 v31, v31
    v_exp_f32 v32, v32
    v_exp_f32 v33, v33
    v_smfmac_f32_32x32x32_bf16 v[56:71], v[140:143], v[24:31], v55
    ds_read_b128 v[228:231], v1 offset:50176
    v_exp_f32 v34, v34
    v_exp_f32 v35, v35
    v_exp_f32 v36, v36
    v_mfma_f32_32x32x16_bf16 v[16:31], v[144:147], v[88:91], 0
    s_waitcnt lgkmcnt(0)
    v_exp_f32 v37, v37
    v_exp_f32 v38, v38
    v_exp_f32 v39, v39
    v_exp_f32 v40, v40
    v_exp_f32 v41, v41
    v_cmp_gt_u32 vcc, 4096, v8
    v_smfmac_f32_32x32x32_bf16 v[72:87], v[136:139], v[32:39], v55
    s_cbranch_vccnz k4_s22
k4_s22_back:
    s_waitcnt vmcnt(6)
    s_setprio 3
    v_exp_f32 v42, v42
    v_exp_f32 v43, v43
    v_exp_f32 v44, v44
    v_exp_f32 v45, v45
    v_smfmac_f32_16x16x64_bf16 v[240:243], v[224:227], v[192:199], v54
    buffer_load_dwordx4 v[192:195], v1, s[8:11], s45 offen offset:2048
    v_exp_f32 v46, v46
    v_exp_f32 v47, v47
    v_exp_f32 v16, v16
    v_exp_f32 v17, v17
    v_smfmac_f32_32x32x32_bf16 v[72:87], v[140:143], v[40:47], v55
    buffer_load_dwordx4 v[196:199], v1, s[8:11], s45 offen offset:3072
    v_exp_f32 v18, v18
    v_exp_f32 v19, v19
    v_exp_f32 v20, v20
    v_mfma_f32_32x32x16_bf16 v[32:47], v[144:147], v[92:95], 0
    v_exp_f32 v21, v21
    v_exp_f32 v22, v22
    v_exp_f32 v23, v23
    v_exp_f32 v24, v24
    v_exp_f32 v25, v25
    v_smfmac_f32_32x32x32_bf16 v[56:71], v[148:151], v[16:23], v55
    s_waitcnt vmcnt(6)
    v_exp_f32 v26, v26
    v_exp_f32 v27, v27
    v_exp_f32 v28, v28
    v_exp_f32 v29, v29
    v_smfmac_f32_16x16x64_bf16 v[244:247], v[224:227], v[200:207], v54
    buffer_load_dwordx4 v[200:203], v1, s[8:11], s46 offen offset:2048
    v_exp_f32 v30, v30
    v_exp_f32 v31, v31
    v_exp_f32 v32, v32
    v_exp_f32 v33, v33
    v_smfmac_f32_32x32x32_bf16 v[56:71], v[152:155], v[24:31], v55
    v_exp_f32 v34, v34
    v_exp_f32 v35, v35
    v_exp_f32 v36, v36
    v_mfma_f32_32x32x16_bf16 v[16:31], v[156:159], v[88:91], 0
    v_exp_f32 v37, v37
    v_exp_f32 v38, v38
    v_exp_f32 v39, v39
    v_exp_f32 v40, v40
    v_exp_f32 v41, v41
    v_smfmac_f32_32x32x32_bf16 v[72:87], v[148:151], v[32:39], v55
    s_waitcnt vmcnt(5)
    buffer_load_dwordx4 v[204:207], v1, s[8:11], s46 offen offset:3072
    v_exp_f32 v42, v42
    v_exp_f32 v43, v43
    v_exp_f32 v44, v44
    v_exp_f32 v45, v45
    v_smfmac_f32_16x16x64_bf16 v[248:251], v[224:227], v[208:215], v54
    v_exp_f32 v46, v46
    v_exp_f32 v47, v47
    v_exp_f32 v16, v16
    v_exp_f32 v17, v17
    v_smfmac_f32_32x32x32_bf16 v[72:87], v[152:155], v[40:47], v55
    buffer_load_dwordx4 v[208:211], v1, s[8:11], s47 offen offset:2048
    v_exp_f32 v18, v18
    v_exp_f32 v19, v19
    v_exp_f32 v20, v20
    v_mfma_f32_32x32x16_bf16 v[32:47], v[156:159], v[92:95], 0
    v_exp_f32 v21, v21
    v_exp_f32 v22, v22
    v_exp_f32 v23, v23
    v_exp_f32 v24, v24
    v_exp_f32 v25, v25
    v_smfmac_f32_32x32x32_bf16 v[56:71], v[160:163], v[16:23], v55
    v_exp_f32 v26, v26
    v_exp_f32 v27, v27
    v_exp_f32 v28, v28
    v_exp_f32 v29, v29
    v_smfmac_f32_16x16x64_bf16 v[252:255], v[224:227], v[216:223], v54
    buffer_load_dwordx4 v[212:215], v1, s[8:11], s47 offen offset:3072
    v_exp_f32 v30, v30
    v_exp_f32 v31, v31
    v_exp_f32 v32, v32
    v_exp_f32 v33, v33
    v_smfmac_f32_32x32x32_bf16 v[56:71], v[164:167], v[24:31], v55
    v_exp_f32 v34, v34
    v_exp_f32 v35, v35
    v_exp_f32 v36, v36
    v_mfma_f32_32x32x16_bf16 v[16:31], v[168:171], v[88:91], 0
    v_exp_f32 v37, v37
    v_exp_f32 v38, v38
    v_exp_f32 v39, v39
    v_exp_f32 v40, v40
    v_exp_f32 v41, v41
    v_smfmac_f32_32x32x32_bf16 v[72:87], v[160:163], v[32:39], v55
    s_waitcnt vmcnt(6)
    buffer_load_dwordx4 v[216:219], v1, s[8:11], s51 offen offset:0
    v_exp_f32 v42, v42
    v_exp_f32 v43, v43
    v_exp_f32 v44, v44
    v_exp_f32 v45, v45
    v_smfmac_f32_16x16x64_bf16 v[240:243], v[228:231], v[232:239], v54
    v_exp_f32 v46, v46
    v_exp_f32 v47, v47
    v_exp_f32 v16, v16
    v_exp_f32 v17, v17
    v_smfmac_f32_32x32x32_bf16 v[72:87], v[164:167], v[40:47], v55
    s_setprio 2
    v_exp_f32 v18, v18
    v_exp_f32 v19, v19
    v_exp_f32 v20, v20
    v_mfma_f32_32x32x16_bf16 v[32:47], v[168:171], v[92:95], 0
    buffer_load_dwordx4 v[220:223], v1, s[8:11], s51 offen offset:1024
    v_exp_f32 v21, v21
    v_exp_f32 v22, v22
    v_exp_f32 v23, v23
    v_exp_f32 v24, v24
    v_exp_f32 v25, v25
    v_smfmac_f32_32x32x32_bf16 v[56:71], v[172:175], v[16:23], v55
    s_waitcnt vmcnt(6)
    v_exp_f32 v26, v26
    v_exp_f32 v27, v27
    v_exp_f32 v28, v28
    v_exp_f32 v29, v29
    v_smfmac_f32_16x16x64_bf16 v[244:247], v[228:231], v[192:199], v54
    buffer_load_dwordx4 v[192:195], v1, s[8:11], s48 offen offset:0
    v_exp_f32 v30, v30
    v_exp_f32 v31, v31
    v_exp_f32 v32, v32
    v_exp_f32 v33, v33
    v_smfmac_f32_32x32x32_bf16 v[56:71], v[176:179], v[24:31], v55
    v_exp_f32 v34, v34
    v_exp_f32 v35, v35
    v_exp_f32 v36, v36
    v_mfma_f32_32x32x16_bf16 v[16:31], v[180:183], v[88:91], 0
    ds_read_b128 v[88:91], v7 offset:55808
    v_exp_f32 v37, v37
    v_exp_f32 v38, v38
    v_exp_f32 v39, v39
    v_exp_f32 v40, v40
    v_exp_f32 v41, v41
    v_smfmac_f32_32x32x32_bf16 v[72:87], v[172:175], v[32:39], v55
    s_waitcnt vmcnt(5)
    buffer_load_dwordx4 v[196:199], v1, s[8:11], s48 offen offset:1024
    v_exp_f32 v42, v42
    v_exp_f32 v43, v43
    v_exp_f32 v44, v44
    v_exp_f32 v45, v45
    v_smfmac_f32_16x16x64_bf16 v[248:251], v[228:231], v[200:207], v54
    v_exp_f32 v46, v46
    v_exp_f32 v47, v47
    v_exp_f32 v16, v16
    v_exp_f32 v17, v17
    v_smfmac_f32_32x32x32_bf16 v[72:87], v[176:179], v[40:47], v55
    v_exp_f32 v18, v18
    v_exp_f32 v19, v19
    v_exp_f32 v20, v20
    v_mfma_f32_32x32x16_bf16 v[32:47], v[180:183], v[92:95], 0
    ds_read_b128 v[92:95], v7 offset:56832
    v_exp_f32 v21, v21
    v_exp_f32 v22, v22
    v_exp_f32 v23, v23
    v_exp_f32 v24, v24
    v_exp_f32 v25, v25
    v_smfmac_f32_32x32x32_bf16 v[56:71], v[184:187], v[16:23], v55
    s_waitcnt vmcnt(4)
    buffer_load_dwordx4 v[200:203], v1, s[8:11], s49 offen offset:0
    v_exp_f32 v26, v26
    v_exp_f32 v27, v27
    v_exp_f32 v28, v28
    v_exp_f32 v29, v29
    v_smfmac_f32_16x16x64_bf16 v[252:255], v[228:231], v[208:215], v54
    v_exp_f32 v30, v30
    v_exp_f32 v31, v31
    v_exp_f32 v32, v32
    v_exp_f32 v33, v33
    v_smfmac_f32_32x32x32_bf16 v[56:71], v[188:191], v[24:31], v55
    s_waitcnt lgkmcnt(0)
    buffer_load_dwordx4 v[204:207], v1, s[8:11], s49 offen offset:1024
    v_exp_f32 v34, v34
    v_exp_f32 v35, v35
    v_exp_f32 v36, v36
    v_mfma_f32_32x32x16_bf16 v[16:31], v[96:99], v[88:91], 0
    v_exp_f32 v37, v37
    v_exp_f32 v38, v38
    v_exp_f32 v39, v39
    v_exp_f32 v40, v40
    v_exp_f32 v41, v41
    v_smfmac_f32_32x32x32_bf16 v[72:87], v[184:187], v[32:39], v55
    buffer_load_dwordx4 v[208:211], v1, s[8:11], s50 offen offset:0
    v_exp_f32 v42, v42
    v_add_u32 v7, 2048, v7
    v_exp_f32 v43, v43
    ds_write_b128 v2, v[56:59] offset:0
    v_exp_f32 v44, v44
    ds_write_b128 v2, v[60:63] offset:16
    v_exp_f32 v45, v45
    ds_write2_b32 v2, v7, v64 offset0:8 offset1:9
    v_exp_f32 v46, v46
    v_exp_f32 v47, v47
    v_mfma_f32_32x32x16_bf16 v[56:71], v[48:51], v[48:51], 0
    v_exp_f32 v16, v16
    v_exp_f32 v17, v17
    v_smfmac_f32_32x32x32_bf16 v[72:87], v[188:191], v[40:47], v55
    v_exp_f32 v18, v18
    v_exp_f32 v19, v19
    v_exp_f32 v20, v20
    v_mfma_f32_32x32x16_bf16 v[32:47], v[96:99], v[92:95], 0
    buffer_load_dwordx4 v[212:215], v1, s[8:11], s50 offen offset:1024
    v_exp_f32 v21, v21
    v_exp_f32 v22, v22
    v_exp_f32 v23, v23
    v_exp_f32 v24, v24
    v_exp_f32 v25, v25
    v_smfmac_f32_32x32x32_bf16 v[56:71], v[100:103], v[16:23], v55
    v_exp_f32 v26, v26
    v_exp_f32 v27, v27
    ds_write_b128 v2, v[72:75] offset:3072
    v_exp_f32 v28, v28
    ds_write_b128 v2, v[76:79] offset:3088
    v_exp_f32 v29, v29
    ds_write2_b32 v53, v7, v80 offset0:8 offset1:9
    v_exp_f32 v30, v30
    v_mfma_f32_32x32x16_bf16 v[72:87], v[48:51], v[48:51], 0
    v_exp_f32 v31, v31
    v_exp_f32 v32, v32
    v_exp_f32 v33, v33
    v_smfmac_f32_32x32x32_bf16 v[56:71], v[104:107], v[24:31], v55
    s_setprio 1
    buffer_load_dwordx4 v[96:99], v1, s[8:11], s52 offen offset:0
    v_exp_f32 v34, v34
    v_exp_f32 v35, v35
    v_exp_f32 v36, v36
    v_mfma_f32_32x32x16_bf16 v[16:31], v[108:111], v[88:91], 0
    v_exp_f32 v37, v37
    v_exp_f32 v38, v38
    v_exp_f32 v39, v39
    v_exp_f32 v40, v40
    v_exp_f32 v41, v41
    v_smfmac_f32_32x32x32_bf16 v[72:87], v[100:103], v[32:39], v55
    buffer_load_dwordx4 v[100:103], v1, s[8:11], s52 offen offset:1024
    v_exp_f32 v42, v42
    v_exp_f32 v43, v43
    v_exp_f32 v44, v44
    v_exp_f32 v45, v45
    v_exp_f32 v46, v46
    v_exp_f32 v47, v47
    v_exp_f32 v16, v16
    v_exp_f32 v17, v17
    v_smfmac_f32_32x32x32_bf16 v[72:87], v[104:107], v[40:47], v55
    ds_read_b64 v[8:9], v4 offset:32
    v_exp_f32 v18, v18
    v_exp_f32 v19, v19
    v_exp_f32 v20, v20
    v_mfma_f32_32x32x16_bf16 v[32:47], v[108:111], v[92:95], 0
    ds_read2st64_b64 v[224:227], v3 offset0:0 offset1:12
    v_exp_f32 v21, v21
    v_exp_f32 v22, v22
    v_exp_f32 v23, v23
    v_exp_f32 v24, v24
    v_exp_f32 v25, v25
    v_smfmac_f32_32x32x32_bf16 v[56:71], v[112:115], v[16:23], v55
    ds_read2st64_b64 v[228:231], v3 offset0:24 offset1:36
    v_exp_f32 v26, v26
    v_exp_f32 v27, v27
    v_exp_f32 v28, v28
    v_exp_f32 v29, v29
    v_exp_f32 v30, v30
    v_exp_f32 v31, v31
    v_exp_f32 v32, v32
    v_exp_f32 v33, v33
    v_smfmac_f32_32x32x32_bf16 v[56:71], v[116:119], v[24:31], v55
    ds_read2st64_b64 v[232:235], v3 offset0:48 offset1:60
    v_exp_f32 v34, v34
    v_exp_f32 v35, v35
    v_exp_f32 v36, v36
    v_mfma_f32_32x32x16_bf16 v[16:31], v[120:123], v[88:91], 0
    ds_read2st64_b64 v[236:239], v3 offset0:72 offset1:84
    v_exp_f32 v37, v37
    v_exp_f32 v38, v38
    v_exp_f32 v39, v39
    v_exp_f32 v40, v40
    v_exp_f32 v41, v41
    v_smfmac_f32_32x32x32_bf16 v[72:87], v[112:115], v[32:39], v55
    s_waitcnt lgkmcnt(0)
    buffer_load_dwordx4 v[104:107], v1, s[8:11], s53 offen offset:0
    v_exp_f32 v42, v42
    v_exp_f32 v43, v43
    v_exp_f32 v44, v44
    v_exp_f32 v45, v45
    v_exp_f32 v46, v46
    v_exp_f32 v47, v47
    v_exp_f32 v16, v16
    v_exp_f32 v17, v17
    v_cmp_gt_u32 vcc, 6144, v8
    v_smfmac_f32_32x32x32_bf16 v[72:87], v[116:119], v[40:47], v55
    s_cbranch_vccnz k4_s13
k4_s13_back:
    buffer_load_dwordx4 v[108:111], v1, s[8:11], s53 offen offset:1024
    v_exp_f32 v18, v18
    v_add_f32_dpp v9, v9, v9 quad_perm:[1,0,3,2] row_mask:0xf bank_mask:0xf
    v_exp_f32 v19, v19
    v_add_f32 v224, v224, v226
    v_exp_f32 v20, v20
    v_add_f32 v225, v225, v227
    v_mfma_f32_32x32x16_bf16 v[32:47], v[120:123], v[92:95], 0
    buffer_load_dwordx4 v[112:115], v1, s[8:11], s54 offen offset:0
    v_exp_f32 v21, v21
    v_add_f32_dpp v9, v9, v9 quad_perm:[2,3,0,1] row_mask:0xf bank_mask:0xf
    v_exp_f32 v22, v22
    v_add_f32 v228, v228, v230
    v_exp_f32 v23, v23
    v_add_f32 v229, v229, v231
    v_exp_f32 v24, v24
    v_add_f32_dpp v9, v9, v9 row_ror:8 row_mask:0xf bank_mask:0xf
    v_exp_f32 v25, v25
    v_add_f32 v232, v232, v234
    v_smfmac_f32_32x32x32_bf16 v[56:71], v[124:127], v[16:23], v55
    v_exp_f32 v26, v26
    v_add_f32 v233, v233, v235
    v_exp_f32 v27, v27
    v_rcp_f32 v10, v9
    v_exp_f32 v28, v28
    v_add_f32 v236, v236, v238
    v_exp_f32 v29, v29
    v_add_f32 v237, v237, v239
    v_exp_f32 v30, v30
    v_add_f32 v224, v224, v228
    v_exp_f32 v31, v31
    v_add_f32 v225, v225, v229
    v_exp_f32 v32, v32
    v_add_f32 v232, v232, v236
    v_exp_f32 v33, v33
    v_add_f32 v233, v233, v237
    v_smfmac_f32_32x32x32_bf16 v[56:71], v[128:131], v[24:31], v55
    buffer_load_dwordx4 v[116:119], v1, s[8:11], s54 offen offset:1024
    v_exp_f32 v34, v34
    v_add_f32 v224, v224, v232
    v_exp_f32 v35, v35
    v_add_f32 v225, v225, v233
    v_exp_f32 v36, v36
    v_mul_f32 v224, v224, v10
    v_mfma_f32_32x32x16_bf16 v[16:31], v[132:135], v[88:91], 0
    buffer_load_dwordx4 v[232:235], v1, s[8:11], s48 offen offset:2048
    v_exp_f32 v37, v37
    v_mul_f32 v225, v225, v10
    v_exp_f32 v38, v38
    v_cvt_pk_bf16_f32 v224, v224, v225
    v_exp_f32 v39, v39
    ds_write2st64_b32 v5, v224, v7 offset0:192 offset1:200
    v_exp_f32 v40, v40
    v_max3_u32 v11, v11, v9, v10
    v_exp_f32 v41, v41
    v_smfmac_f32_32x32x32_bf16 v[72:87], v[124:127], v[32:39], v55
    s_setprio 0
    v_exp_f32 v42, v42
    v_exp_f32 v43, v43
    v_exp_f32 v44, v44
    v_exp_f32 v45, v45
    v_exp_f32 v46, v46
    v_exp_f32 v47, v47
    v_exp_f32 v16, v16
    v_exp_f32 v17, v17
    v_smfmac_f32_32x32x32_bf16 v[72:87], v[128:131], v[40:47], v55
    buffer_load_dwordx4 v[236:239], v1, s[8:11], s48 offen offset:3072
    v_exp_f32 v18, v18
    v_exp_f32 v19, v19
    v_exp_f32 v20, v20
    v_mfma_f32_32x32x16_bf16 v[32:47], v[132:135], v[92:95], 0
    ds_read_b32 v8, v52 offset:51200
    v_exp_f32 v21, v21
    v_exp_f32 v22, v22
    v_exp_f32 v23, v23
    v_exp_f32 v24, v24
    v_exp_f32 v25, v25
    v_smfmac_f32_32x32x32_bf16 v[56:71], v[136:139], v[16:23], v55
    ds_read_b128 v[224:227], v1 offset:49152
    v_exp_f32 v26, v26
    v_exp_f32 v27, v27
    v_exp_f32 v28, v28
    v_exp_f32 v29, v29
    v_exp_f32 v30, v30
    v_exp_f32 v31, v31
    v_exp_f32 v32, v32
    v_exp_f32 v33, v33
    v_smfmac_f32_32x32x32_bf16 v[56:71], v[140:143], v[24:31], v55
    ds_read_b128 v[228:231], v1 offset:50176
    v_exp_f32 v34, v34
    v_exp_f32 v35, v35
    v_exp_f32 v36, v36
    v_mfma_f32_32x32x16_bf16 v[16:31], v[144:147], v[88:91], 0
    s_waitcnt lgkmcnt(0)
    buffer_load_dwordx4 v[120:123], v1, s[8:11], s55 offen offset:0
    v_exp_f32 v37, v37
    v_exp_f32 v38, v38
    v_exp_f32 v39, v39
    v_exp_f32 v40, v40
    v_exp_f32 v41, v41
    v_cmp_gt_u32 vcc, 6144, v8
    v_smfmac_f32_32x32x32_bf16 v[72:87], v[136:139], v[32:39], v55
    s_cbranch_vccnz k4_s23
k4_s23_back:
    s_waitcnt vmcnt(13)
    s_setprio 3
    buffer_load_dwordx4 v[124:127], v1, s[8:11], s55 offen offset:1024
    v_exp_f32 v42, v42
    v_exp_f32 v43, v43
    v_exp_f32 v44, v44
    v_exp_f32 v45, v45
    v_smfmac_f32_16x16x64_bf16 v[240:243], v[224:227], v[192:199], v54
    v_exp_f32 v46, v46
    v_exp_f32 v47, v47
    v_exp_f32 v16, v16
    v_exp_f32 v17, v17
    v_smfmac_f32_32x32x32_bf16 v[72:87], v[140:143], v[40:47], v55
    buffer_load_dwordx4 v[192:195], v1, s[8:11], s49 offen offset:2048
    v_exp_f32 v18, v18
    v_exp_f32 v19, v19
    v_exp_f32 v20, v20
    v_mfma_f32_32x32x16_bf16 v[32:47], v[144:147], v[92:95], 0
    v_exp_f32 v21, v21
    v_exp_f32 v22, v22
    v_exp_f32 v23, v23
    v_exp_f32 v24, v24
    v_exp_f32 v25, v25
    v_smfmac_f32_32x32x32_bf16 v[56:71], v[148:151], v[16:23], v55
    s_waitcnt vmcnt(13)
    buffer_load_dwordx4 v[196:199], v1, s[8:11], s49 offen offset:3072
    v_exp_f32 v26, v26
    v_exp_f32 v27, v27
    v_exp_f32 v28, v28
    v_exp_f32 v29, v29
    v_smfmac_f32_16x16x64_bf16 v[244:247], v[224:227], v[200:207], v54
    v_exp_f32 v30, v30
    v_exp_f32 v31, v31
    v_exp_f32 v32, v32
    v_exp_f32 v33, v33
    v_smfmac_f32_32x32x32_bf16 v[56:71], v[152:155], v[24:31], v55
    buffer_load_dwordx4 v[200:203], v1, s[8:11], s50 offen offset:2048
    v_exp_f32 v34, v34
    v_exp_f32 v35, v35
    v_exp_f32 v36, v36
    v_mfma_f32_32x32x16_bf16 v[16:31], v[156:159], v[88:91], 0
    v_exp_f32 v37, v37
    v_exp_f32 v38, v38
    v_exp_f32 v39, v39
    v_exp_f32 v40, v40
    v_exp_f32 v41, v41
    v_smfmac_f32_32x32x32_bf16 v[72:87], v[148:151], v[32:39], v55
    s_waitcnt vmcnt(13)
    buffer_load_dwordx4 v[204:207], v1, s[8:11], s50 offen offset:3072
    v_exp_f32 v42, v42
    v_exp_f32 v43, v43
    v_exp_f32 v44, v44
    v_exp_f32 v45, v45
    v_smfmac_f32_16x16x64_bf16 v[248:251], v[224:227], v[208:215], v54
    v_exp_f32 v46, v46
    v_exp_f32 v47, v47
    v_exp_f32 v16, v16
    v_exp_f32 v17, v17
    v_smfmac_f32_32x32x32_bf16 v[72:87], v[152:155], v[40:47], v55
    buffer_load_dwordx4 v[208:211], v1, s[8:11], s51 offen offset:2048
    v_exp_f32 v18, v18
    v_exp_f32 v19, v19
    v_exp_f32 v20, v20
    v_mfma_f32_32x32x16_bf16 v[32:47], v[156:159], v[92:95], 0
    v_exp_f32 v21, v21
    v_exp_f32 v22, v22
    v_exp_f32 v23, v23
    v_exp_f32 v24, v24
    v_exp_f32 v25, v25
    v_smfmac_f32_32x32x32_bf16 v[56:71], v[160:163], v[16:23], v55
    buffer_load_dwordx4 v[212:215], v1, s[8:11], s51 offen offset:3072
    v_exp_f32 v26, v26
    v_exp_f32 v27, v27
    v_exp_f32 v28, v28
    v_exp_f32 v29, v29
    v_smfmac_f32_16x16x64_bf16 v[252:255], v[224:227], v[216:223], v54
    v_exp_f32 v30, v30
    v_exp_f32 v31, v31
    v_exp_f32 v32, v32
    v_exp_f32 v33, v33
    v_smfmac_f32_32x32x32_bf16 v[56:71], v[164:167], v[24:31], v55
    buffer_load_dwordx4 v[128:131], v1, s[8:11], s52 offen offset:2048
    v_exp_f32 v34, v34
    v_exp_f32 v35, v35
    v_exp_f32 v36, v36
    v_mfma_f32_32x32x16_bf16 v[16:31], v[168:171], v[88:91], 0
    v_exp_f32 v37, v37
    v_exp_f32 v38, v38
    v_exp_f32 v39, v39
    v_exp_f32 v40, v40
    v_exp_f32 v41, v41
    v_smfmac_f32_32x32x32_bf16 v[72:87], v[160:163], v[32:39], v55
    s_waitcnt vmcnt(9)
    buffer_load_dwordx4 v[132:135], v1, s[8:11], s52 offen offset:3072
    v_exp_f32 v42, v42
    v_exp_f32 v43, v43
    v_exp_f32 v44, v44
    v_exp_f32 v45, v45
    v_smfmac_f32_16x16x64_bf16 v[240:243], v[228:231], v[232:239], v54
    v_exp_f32 v46, v46
    v_exp_f32 v47, v47
    v_exp_f32 v16, v16
    v_exp_f32 v17, v17
    v_smfmac_f32_32x32x32_bf16 v[72:87], v[164:167], v[40:47], v55
    s_setprio 2
    buffer_load_dwordx4 v[136:139], v1, s[8:11], s53 offen offset:2048
    v_exp_f32 v18, v18
    v_exp_f32 v19, v19
    v_exp_f32 v20, v20
    v_mfma_f32_32x32x16_bf16 v[32:47], v[168:171], v[92:95], 0
    v_exp_f32 v21, v21
    v_exp_f32 v22, v22
    v_exp_f32 v23, v23
    v_exp_f32 v24, v24
    v_exp_f32 v25, v25
    v_smfmac_f32_32x32x32_bf16 v[56:71], v[172:175], v[16:23], v55
    s_waitcnt vmcnt(7)
    buffer_load_dwordx4 v[140:143], v1, s[8:11], s53 offen offset:3072
    v_exp_f32 v26, v26
    v_exp_f32 v27, v27
    v_exp_f32 v28, v28
    v_exp_f32 v29, v29
    v_smfmac_f32_16x16x64_bf16 v[244:247], v[228:231], v[192:199], v54
    v_exp_f32 v30, v30
    v_exp_f32 v31, v31
    v_exp_f32 v32, v32
    v_exp_f32 v33, v33
    v_smfmac_f32_32x32x32_bf16 v[56:71], v[176:179], v[24:31], v55
    buffer_load_dwordx4 v[144:147], v1, s[8:11], s54 offen offset:2048
    v_exp_f32 v34, v34
    v_exp_f32 v35, v35
    v_exp_f32 v36, v36
    v_mfma_f32_32x32x16_bf16 v[16:31], v[180:183], v[88:91], 0
    v_exp_f32 v37, v37
    v_exp_f32 v38, v38
    v_exp_f32 v39, v39
    v_exp_f32 v40, v40
    v_exp_f32 v41, v41
    v_smfmac_f32_32x32x32_bf16 v[72:87], v[172:175], v[32:39], v55
    s_waitcnt vmcnt(7)
    buffer_load_dwordx4 v[148:151], v1, s[8:11], s54 offen offset:3072
    v_exp_f32 v42, v42
    v_exp_f32 v43, v43
    v_exp_f32 v44, v44
    v_exp_f32 v45, v45
    v_smfmac_f32_16x16x64_bf16 v[248:251], v[228:231], v[200:207], v54
    v_exp_f32 v46, v46
    v_exp_f32 v47, v47
    v_exp_f32 v16, v16
    v_exp_f32 v17, v17
    v_smfmac_f32_32x32x32_bf16 v[72:87], v[176:179], v[40:47], v55
    buffer_load_dwordx4 v[152:155], v1, s[8:11], s55 offen offset:2048
    v_exp_f32 v18, v18
    v_exp_f32 v19, v19
    v_exp_f32 v20, v20
    v_mfma_f32_32x32x16_bf16 v[32:47], v[180:183], v[92:95], 0
    v_exp_f32 v21, v21
    v_exp_f32 v22, v22
    v_exp_f32 v23, v23
    v_exp_f32 v24, v24
    v_exp_f32 v25, v25
    v_smfmac_f32_32x32x32_bf16 v[56:71], v[184:187], v[16:23], v55
    s_waitcnt vmcnt(7)
    buffer_load_dwordx4 v[156:159], v1, s[8:11], s55 offen offset:3072
    v_exp_f32 v26, v26
    v_exp_f32 v27, v27
    v_exp_f32 v28, v28
    v_exp_f32 v29, v29
    v_smfmac_f32_16x16x64_bf16 v[252:255], v[228:231], v[208:215], v54
    v_exp_f32 v30, v30
    v_exp_f32 v31, v31
    v_exp_f32 v32, v32
    v_exp_f32 v33, v33
    v_smfmac_f32_32x32x32_bf16 v[56:71], v[188:191], v[24:31], v55
    v_exp_f32 v34, v34
    v_exp_f32 v35, v35
    v_exp_f32 v36, v36
    v_exp_f32 v37, v37
    v_exp_f32 v38, v38
    v_exp_f32 v39, v39
    v_exp_f32 v40, v40
    v_exp_f32 v41, v41
    v_smfmac_f32_32x32x32_bf16 v[72:87], v[184:187], v[32:39], v55
    v_exp_f32 v42, v42
    v_add_u32 v7, 2048, v7
    v_exp_f32 v43, v43
    ds_write_b128 v2, v[56:59] offset:0
    v_exp_f32 v44, v44
    ds_write_b128 v2, v[60:63] offset:16
    v_exp_f32 v45, v45
    ds_write2_b32 v2, v7, v64 offset0:8 offset1:9
    v_exp_f32 v46, v46
    v_exp_f32 v47, v47
    s_nop 1
    v_smfmac_f32_32x32x32_bf16 v[72:87], v[188:191], v[40:47], v55
    v_and_b32 v16, 0x1cf, v0
    v_cmp_eq_u32 vcc, 0, v16
    v_lshrrev_b32 v18, 1, v0
    v_and_b32 v18, 0xf8, v18
    v_cndmask_b32 v16, 1.0, 0, vcc
    s_cmp_eq_u32 s17, 1
    s_nop 5
    ds_write_b128 v2, v[72:75] offset:3072
    ds_write_b128 v2, v[76:79] offset:3088
    ds_write2_b32 v53, v7, v80 offset0:8 offset1:9
    s_waitcnt lgkmcnt(0)
    s_barrier
    ds_read_b64 v[8:9], v4 offset:32
    ds_read2st64_b64 v[224:227], v3 offset0:0 offset1:12
    ds_read2st64_b64 v[228:231], v3 offset0:24 offset1:36
    ds_read2st64_b64 v[232:235], v3 offset0:48 offset1:60
    ds_read2st64_b64 v[236:239], v3 offset0:72 offset1:84
    s_waitcnt lgkmcnt(4)
    v_add_f32_dpp v9, v9, v9 quad_perm:[1,0,3,2] row_mask:0xf bank_mask:0xf
    s_waitcnt lgkmcnt(3)
    v_pk_add_f32 v[224:225], v[224:225], v[226:227]
    v_add_f32_dpp v9, v9, v9 quad_perm:[2,3,0,1] row_mask:0xf bank_mask:0xf
    s_waitcnt lgkmcnt(2)
    v_pk_add_f32 v[228:229], v[228:229], v[230:231]
    v_add_f32_dpp v9, v9, v9 row_ror:8 row_mask:0xf bank_mask:0xf
    s_waitcnt lgkmcnt(1)
    v_pk_add_f32 v[232:233], v[232:233], v[234:235]
    v_rcp_f32 v10, v9
    v_pk_add_f32 v[224:225], v[224:225], v[228:229]
    s_waitcnt lgkmcnt(0)
    v_pk_add_f32 v[236:237], v[236:237], v[238:239]
    v_pk_add_f32 v[224:225], v[224:225], v[232:233]
    v_max3_u32 v11, v11, v9, v10
    v_pk_add_f32 v[224:225], v[224:225], v[236:237]
    v_pk_mul_f32 v[224:225], v[224:225], v[10:11] op_sel_hi:[1,0]
    v_cvt_pk_bf16_f32 v224, v224, v225
    ds_write2st64_b32 v5, v224, v11 offset0:192 offset1:200
    s_waitcnt lgkmcnt(0)
    s_barrier
    ds_read_b128 v[224:227], v1 offset:49152
    ds_read_b128 v[228:231], v1 offset:50176
    ds_read_b32 v8, v52 offset:51200
    s_waitcnt vmcnt(0) lgkmcnt(2)
    v_smfmac_f32_16x16x64_bf16 v[240:243], v[224:227], v[96:103], v54
    v_smfmac_f32_16x16x64_bf16 v[244:247], v[224:227], v[104:111], v54
    v_smfmac_f32_16x16x64_bf16 v[248:251], v[224:227], v[112:119], v54
    v_smfmac_f32_16x16x64_bf16 v[252:255], v[224:227], v[120:127], v54
    s_waitcnt lgkmcnt(0)
    v_smfmac_f32_16x16x64_bf16 v[240:243], v[228:231], v[128:135], v54
    v_cmp_le_u32 vcc, 0x58800000, v8
    v_smfmac_f32_16x16x64_bf16 v[244:247], v[228:231], v[136:143], v54
    s_cbranch_vccnz k4_fallback
k4_epi:
    v_smfmac_f32_16x16x64_bf16 v[248:251], v[228:231], v[144:151], v54
    s_cbranch_scc1 k4_epi1
    v_smfmac_f32_16x16x64_bf16 v[252:255], v[228:231], v[152:159], v54
    s_nop 1
    v_pk_add_f32 v[240:241], v[240:241], v[242:243]
    s_nop 0
    v_pk_add_f32 v[244:245], v[244:245], v[246:247]
    v_cvt_pk_bf16_f32 v48, v240, v244
    v_cvt_pk_bf16_f32 v49, v241, v245
    v_pk_mul_f32 v[32:33], v[244:245], v[244:245]
    v_pk_add_f32 v[248:249], v[248:249], v[250:251]
    v_pk_add_f32 v[252:253], v[252:253], v[254:255]
    v_cvt_pk_bf16_f32 v50, v248, v252
    v_cvt_pk_bf16_f32 v51, v249, v253
    v_pk_mul_f32 v[32:33], v[32:33], v[16:17] op_sel_hi:[1,0]
    v_permlane16_swap_b32 v48, v50
    v_permlane16_swap_b32 v49, v51
    buffer_store_dwordx4 v[48:51], v6, s[8:11], s60 offen sc1
    v_pk_fma_f32 v[32:33], v[240:241], v[240:241], v[32:33]
    v_pk_fma_f32 v[32:33], v[248:249], v[248:249], v[32:33]
    v_pk_fma_f32 v[32:33], v[252:253], v[252:253], v[32:33]
    s_lshl_b32 s20, s3, 7
    s_nop 0
    v_add_f32_dpp v32, v32, v32 quad_perm:[1,0,3,2] row_mask:0xf bank_mask:0xf
    v_add_f32_dpp v33, v33, v33 quad_perm:[1,0,3,2] row_mask:0xf bank_mask:0xf
    s_add_u32 s20, s20, 20971520
    v_add_f32_dpp v32, v32, v32 quad_perm:[2,3,0,1] row_mask:0xf bank_mask:0xf
    v_add_f32_dpp v33, v33, v33 quad_perm:[2,3,0,1] row_mask:0xf bank_mask:0xf
    s_mov_b32 s17, 1
    v_add_f32_dpp v32, v32, v32 row_half_mirror row_mask:0xf bank_mask:0xf
    v_add_f32_dpp v33, v33, v33 row_half_mirror row_mask:0xf bank_mask:0xf
    s_cmp_lg_u32 s16, 7
    v_add_f32_dpp v32, v32, v32 row_mirror row_mask:0xf bank_mask:0xf
    v_add_f32_dpp v33, v33, v33 row_mirror row_mask:0xf bank_mask:0xf
    ds_write_b64 v18, v[32:33] offset:0
    v_lshrrev_b32 v5, 2, v1
    s_mov_b32 s6, 16777216
    s_waitcnt lgkmcnt(0)
    s_barrier
    s_cbranch_scc1 p2_start
    ds_read_b32 v8, v5 offset:0
    v_mov_b32 v9, 0x4227c5ac
    s_waitcnt lgkmcnt(0)
    v_add_f32_dpp v8, v8, v8 row_ror:8 row_mask:0xf bank_mask:0xf
    v_mov_b32 v10, v8
    s_nop 1
    v_permlane16_swap_b32 v8, v10
    v_add_f32 v8, v8, v10
    v_mov_b32 v10, v8
    s_nop 1
    v_permlane32_swap_b32 v8, v10
    v_add_f32 v8, v8, v10
    v_fmac_f32 v9, 0x42000000, v8
    v_rsq_f32 v9, v9
    s_mov_b32 exec_hi, 0
    buffer_store_dword v9, v5, s[8:11], s20 offen sc1
    s_mov_b64 exec, -1
    s_branch p2_start
k4_epi1:
    v_smfmac_f32_16x16x64_bf16 v[252:255], v[228:231], v[152:159], v54
    s_nop 2
    v_pk_add_f32 v[240:241], v[240:241], v[242:243]
    v_pk_add_f32 v[244:245], v[244:245], v[246:247]
    v_cvt_pk_bf16_f32 v48, v240, v244
    v_cvt_pk_bf16_f32 v50, v241, v245
    v_pk_add_f32 v[248:249], v[248:249], v[250:251]
    v_pk_add_f32 v[252:253], v[252:253], v[254:255]
    v_cvt_pk_bf16_f32 v49, v248, v252
    buffer_store_dwordx2 v[48:49], v6, s[12:15], s60 offen
    v_cvt_pk_bf16_f32 v51, v249, v253
    buffer_store_dwordx2 v[50:51], v6, s[12:15], s61 offen
k4_exit:
    s_endpgm
p3_v1:
    s_waitcnt lgkmcnt(14)
    v_and_b32 v56, v198, v16
    v_mov_b32 v57, v17
    v_mov_b64 v[58:59], v[18:19]
    v_mfma_f32_16x16x32_bf16 v[240:243], v[16:19], v[96:99], 0
    s_nop 0
    v_mfma_f32_16x16x32_bf16 v[244:247], v[56:59], v[16:19], 0
    s_waitcnt lgkmcnt(12)
    v_mfma_f32_16x16x32_bf16 v[244:247], v[20:23], v[20:23], v[244:247]
    v_mfma_f32_16x16x32_bf16 v[240:243], v[20:23], v[100:103], v[240:243]
    s_waitcnt lgkmcnt(10)
    v_mfma_f32_16x16x32_bf16 v[244:247], v[24:27], v[24:27], v[244:247]
    v_mfma_f32_16x16x32_bf16 v[240:243], v[24:27], v[104:107], v[240:243]
    s_waitcnt lgkmcnt(8)
    v_mfma_f32_16x16x32_bf16 v[244:247], v[28:31], v[28:31], v[244:247]
    v_mfma_f32_16x16x32_bf16 v[240:243], v[28:31], v[108:111], v[240:243]
    s_waitcnt lgkmcnt(6)
    v_mfma_f32_16x16x32_bf16 v[244:247], v[32:35], v[32:35], v[244:247]
    v_mfma_f32_16x16x32_bf16 v[240:243], v[32:35], v[112:115], v[240:243]
    s_waitcnt lgkmcnt(4)
    v_mfma_f32_16x16x32_bf16 v[244:247], v[36:39], v[36:39], v[244:247]
    v_mfma_f32_16x16x32_bf16 v[240:243], v[36:39], v[116:119], v[240:243]
    s_waitcnt lgkmcnt(2)
    v_mfma_f32_16x16x32_bf16 v[244:247], v[40:43], v[40:43], v[244:247]
    v_mfma_f32_16x16x32_bf16 v[240:243], v[40:43], v[120:123], v[240:243]
    s_waitcnt lgkmcnt(0)
    v_mfma_f32_16x16x32_bf16 v[244:247], v[44:47], v[44:47], v[244:247]
    v_mfma_f32_16x16x32_bf16 v[240:243], v[44:47], v[124:127], v[240:243]
    s_cmp_eq_u32 s29, 2
    s_branch p3_w1
p3_v2:
    v_lshlrev_b32 v195, 2, v192
    v_sub_u32 v195, v211, v195
    v_lshl_add_u32 v195, v193, 4, v195
    s_nop 3
    v_mfma_f32_16x16x32_bf16 v[236:239], v[16:19], v[64:67], 0
    v_cndmask_b32 v248, v244, v245, s[32:33]
    v_cndmask_b32 v249, v246, v247, s[34:35]
    ds_write_b128 v203, v[240:243] offset:57344
    v_cndmask_b32 v248, v248, v249, s[54:55]
    s_mov_b64 exec, s[38:39]
    ds_write_b32 v196, v248
    v_cmp_u_f32 vcc, v248, v248
    s_mov_b64 exec, -1
    v_mfma_f32_16x16x32_bf16 v[236:239], v[20:23], v[68:71], v[236:239]
    s_cbranch_vccnz p3_bad
p3_okv:
    v_mfma_f32_16x16x32_bf16 v[236:239], v[24:27], v[72:75], v[236:239]
    s_waitcnt lgkmcnt(0)
    s_barrier
    ds_read2_b32 v[248:249], v211 offset0:0 offset1:16
    ds_read_b128 v[252:255], v195
    ds_read_b128 v[60:63], v195 offset:64
    ds_read_b128 v[56:59], v204 offset:57344
    v_mfma_f32_16x16x32_bf16 v[236:239], v[28:31], v[76:79], v[236:239]
    v_mfma_f32_16x16x32_bf16 v[236:239], v[32:35], v[80:83], v[236:239]
    v_mfma_f32_16x16x32_bf16 v[236:239], v[36:39], v[84:87], v[236:239]
    v_mfma_f32_16x16x32_bf16 v[236:239], v[40:43], v[88:91], v[236:239]
    v_mfma_f32_16x16x32_bf16 v[236:239], v[44:47], v[92:95], v[236:239]
    s_waitcnt lgkmcnt(3)
    v_add_f32 v248, v248, v249
    v_fma_f32 v248, 0.5, v248, v194
    v_rsq_f32 v248, v248
    s_waitcnt lgkmcnt(1)
    v_pk_add_f32 v[252:253], v[252:253], v[60:61]
    v_pk_add_f32 v[254:255], v[254:255], v[62:63]
    v_fma_f32 v252, 0.5, v252, v194
    v_fma_f32 v253, 0.5, v253, v194
    v_fma_f32 v254, 0.5, v254, v194
    v_fma_f32 v255, 0.5, v255, v194
    v_rsq_f32 v252, v252
    v_rsq_f32 v253, v253
    v_rsq_f32 v254, v254
    v_rsq_f32 v255, v255
    s_waitcnt lgkmcnt(0)
    v_pk_add_f32 v[236:237], v[236:237], v[56:57]
    v_pk_add_f32 v[238:239], v[238:239], v[58:59]
    v_pk_mul_f32 v[236:237], v[236:237], v[252:253]
    v_pk_mul_f32 v[238:239], v[238:239], v[254:255]
    v_cvt_pk_bf16_f32 v56, v236, v237
    v_cvt_pk_bf16_f32 v57, v238, v239
    s_cmp_eq_u32 s4, 0
    s_branch p3_w2
p3_bad:
    s_sub_u32 s26, s26, 1
    s_cbranch_scc1 p3_gu
    s_mov_b32 s20, 0
p3_bl:
    s_mov_b32 m0, s20
    s_add_u32 s21, s48, s20
    buffer_load_dwordx4 v197, s[8:11], s21 offen sc1 lds
    s_add_u32 s20, s20, 1024
    s_cmp_lt_u32 s20, 65536
    s_cbranch_scc1 p3_bl
    s_waitcnt vmcnt(0) lgkmcnt(0)
    s_branch p3_redo
p3_gu:
    s_cmp_eq_u32 s29, 2
    s_cbranch_scc1 p3_okv
    s_branch p3_oka
k4_t0:
    s_mov_b32 s25, 16384
    s_add_u32 s22, s63, 0
k4_t0_l:
    buffer_load_dwordx4 v[88:91], v9, s[8:11], s58 offen sc1
    buffer_load_dwordx4 v[92:95], v9, s[8:11], s62 offen sc1
    buffer_load_dwordx4 v[96:99], v1, s[8:11], s22 offen offset:0 sc1
    buffer_load_dwordx4 v[100:103], v10, s[8:11], s22 offen offset:1024 sc1
    buffer_load_dwordx4 v[104:107], v10, s[8:11], s22 offen offset:1536 sc1
    s_sub_u32 s25, s25, 1
    s_waitcnt vmcnt(0)
    v_max3_u32 v14, v96, v100, v104
    v_max3_u32 v14, v14, v88, v92
    v_cmp_eq_u32 vcc, -1, v14
    s_cbranch_scc1 k4_t0_back
    s_cbranch_vccnz k4_t0_l
    s_branch k4_t0_back
k4_t1:
    s_mov_b32 s25, 16384
    s_add_u32 s22, s63, 0
k4_t1_l:
    buffer_load_dwordx4 v[108:111], v1, s[8:11], s22 offen offset:2048 sc1
    buffer_load_dwordx4 v[112:115], v10, s[8:11], s22 offen offset:3072 sc1
    buffer_load_dwordx4 v[116:119], v10, s[8:11], s22 offen offset:3584 sc1
    s_sub_u32 s25, s25, 1
    s_waitcnt vmcnt(0)
    v_max3_u32 v14, v108, v112, v116
    v_cmp_eq_u32 vcc, -1, v14
    s_cbranch_scc1 k4_t1_back
    s_cbranch_vccnz k4_t1_l
    s_branch k4_t1_back
k4_t2:
    s_mov_b32 s25, 16384
    s_add_u32 s22, s63, 4096
k4_t2_l:
    buffer_load_dwordx4 v[120:123], v1, s[8:11], s22 offen offset:0 sc1
    buffer_load_dwordx4 v[124:127], v10, s[8:11], s22 offen offset:1024 sc1
    buffer_load_dwordx4 v[128:131], v10, s[8:11], s22 offen offset:1536 sc1
    s_sub_u32 s25, s25, 1
    s_waitcnt vmcnt(0)
    v_max3_u32 v14, v120, v124, v128
    v_cmp_eq_u32 vcc, -1, v14
    s_cbranch_scc1 k4_t2_back
    s_cbranch_vccnz k4_t2_l
    s_branch k4_t2_back
k4_t3:
    s_mov_b32 s25, 16384
    s_add_u32 s22, s63, 4096
k4_t3_l:
    buffer_load_dwordx4 v[132:135], v1, s[8:11], s22 offen offset:2048 sc1
    buffer_load_dwordx4 v[136:139], v10, s[8:11], s22 offen offset:3072 sc1
    buffer_load_dwordx4 v[140:143], v10, s[8:11], s22 offen offset:3584 sc1
    s_sub_u32 s25, s25, 1
    s_waitcnt vmcnt(0)
    v_max3_u32 v14, v132, v136, v140
    v_cmp_eq_u32 vcc, -1, v14
    s_cbranch_scc1 k4_t3_back
    s_cbranch_vccnz k4_t3_l
    s_branch k4_t3_back
k4_t4:
    s_mov_b32 s25, 16384
    s_add_u32 s22, s63, 8192
k4_t4_l:
    buffer_load_dwordx4 v[144:147], v1, s[8:11], s22 offen offset:0 sc1
    buffer_load_dwordx4 v[148:151], v10, s[8:11], s22 offen offset:1024 sc1
    buffer_load_dwordx4 v[152:155], v10, s[8:11], s22 offen offset:1536 sc1
    s_sub_u32 s25, s25, 1
    s_waitcnt vmcnt(0)
    v_max3_u32 v14, v144, v148, v152
    v_cmp_eq_u32 vcc, -1, v14
    s_cbranch_scc1 k4_t4_back
    s_cbranch_vccnz k4_t4_l
    s_branch k4_t4_back
k4_t5:
    s_mov_b32 s25, 16384
    s_add_u32 s22, s63, 8192
k4_t5_l:
    buffer_load_dwordx4 v[156:159], v1, s[8:11], s22 offen offset:2048 sc1
    buffer_load_dwordx4 v[160:163], v10, s[8:11], s22 offen offset:3072 sc1
    buffer_load_dwordx4 v[164:167], v10, s[8:11], s22 offen offset:3584 sc1
    s_sub_u32 s25, s25, 1
    s_waitcnt vmcnt(0)
    v_max3_u32 v14, v156, v160, v164
    v_cmp_eq_u32 vcc, -1, v14
    s_cbranch_scc1 k4_t5_back
    s_cbranch_vccnz k4_t5_l
    s_branch k4_t5_back
k4_t6:
    s_mov_b32 s25, 16384
    s_add_u32 s22, s63, 12288
k4_t6_l:
    buffer_load_dwordx4 v[168:171], v1, s[8:11], s22 offen offset:0 sc1
    buffer_load_dwordx4 v[172:175], v10, s[8:11], s22 offen offset:1024 sc1
    buffer_load_dwordx4 v[176:179], v10, s[8:11], s22 offen offset:1536 sc1
    s_sub_u32 s25, s25, 1
    s_waitcnt vmcnt(0)
    v_max3_u32 v14, v168, v172, v176
    v_cmp_eq_u32 vcc, -1, v14
    s_cbranch_scc1 k4_t6_back
    s_cbranch_vccnz k4_t6_l
    s_branch k4_t6_back
k4_t7:
    s_mov_b32 s25, 16384
    s_add_u32 s22, s63, 12288
k4_t7_l:
    buffer_load_dwordx4 v[180:183], v1, s[8:11], s22 offen offset:2048 sc1
    buffer_load_dwordx4 v[184:187], v10, s[8:11], s22 offen offset:3072 sc1
    buffer_load_dwordx4 v[188:191], v10, s[8:11], s22 offen offset:3584 sc1
    s_add_u32 s20, s58, 524288
    s_add_u32 s21, s58, 786432
    buffer_load_dwordx4 v[224:227], v9, s[8:11], s20 offen sc1
    buffer_load_dwordx4 v[228:231], v9, s[8:11], s21 offen sc1
    buffer_load_dwordx2 v[232:233], v8, s[8:11], s57 offen sc1
    buffer_load_dwordx2 v[234:235], v8, s[8:11], s56 offen sc1
    s_sub_u32 s25, s25, 1
    s_waitcnt vmcnt(0)
    v_max3_u32 v14, v180, v184, v188
    v_max3_u32 v14, v14, v224, v228
    v_max3_u32 v14, v14, v232, v234
    v_cmp_eq_u32 vcc, -1, v14
    s_cbranch_scc1 k4_t7_back
    s_cbranch_vccnz k4_t7_l
    s_branch k4_t7_back
k4_s11:
    s_setprio 0
    s_mov_b32 s25, 0x100000
k4_s11_l:
    ds_read_b64 v[8:9], v4 offset:32
    s_sub_u32 s25, s25, 1
    s_cbranch_scc1 k4_s11_x
    s_waitcnt lgkmcnt(0)
    v_cmp_gt_u32 vcc, 2048, v8
    s_cbranch_vccnz k4_s11_l
k4_s11_x:
    ds_read2st64_b64 v[224:227], v3 offset0:0 offset1:12
    ds_read2st64_b64 v[228:231], v3 offset0:24 offset1:36
    ds_read2st64_b64 v[232:235], v3 offset0:48 offset1:60
    ds_read2st64_b64 v[236:239], v3 offset0:72 offset1:84
    s_waitcnt lgkmcnt(0)
    s_setprio 1
    s_branch k4_s11_back
k4_s21:
    s_setprio 0
    s_mov_b32 s25, 0x100000
k4_s21_l:
    ds_read_b32 v8, v52 offset:51200
    s_sub_u32 s25, s25, 1
    s_cbranch_scc1 k4_s21_x
    s_waitcnt lgkmcnt(0)
    v_cmp_gt_u32 vcc, 2048, v8
    s_cbranch_vccnz k4_s21_l
k4_s21_x:
    ds_read_b128 v[224:227], v1 offset:49152
    ds_read_b128 v[228:231], v1 offset:50176
    s_waitcnt lgkmcnt(0)
    s_setprio 0
    s_branch k4_s21_back
k4_s12:
    s_setprio 0
    s_mov_b32 s25, 0x100000
k4_s12_l:
    ds_read_b64 v[8:9], v4 offset:32
    s_sub_u32 s25, s25, 1
    s_cbranch_scc1 k4_s12_x
    s_waitcnt lgkmcnt(0)
    v_cmp_gt_u32 vcc, 4096, v8
    s_cbranch_vccnz k4_s12_l
k4_s12_x:
    ds_read2st64_b64 v[224:227], v3 offset0:0 offset1:12
    ds_read2st64_b64 v[228:231], v3 offset0:24 offset1:36
    ds_read2st64_b64 v[232:235], v3 offset0:48 offset1:60
    ds_read2st64_b64 v[236:239], v3 offset0:72 offset1:84
    s_waitcnt lgkmcnt(0)
    s_setprio 1
    s_branch k4_s12_back
k4_s22:
    s_setprio 0
    s_mov_b32 s25, 0x100000
k4_s22_l:
    ds_read_b32 v8, v52 offset:51200
    s_sub_u32 s25, s25, 1
    s_cbranch_scc1 k4_s22_x
    s_waitcnt lgkmcnt(0)
    v_cmp_gt_u32 vcc, 4096, v8
    s_cbranch_vccnz k4_s22_l
k4_s22_x:
    ds_read_b128 v[224:227], v1 offset:49152
    ds_read_b128 v[228:231], v1 offset:50176
    s_waitcnt lgkmcnt(0)
    s_setprio 0
    s_branch k4_s22_back
k4_s13:
    s_setprio 0
    s_mov_b32 s25, 0x100000
k4_s13_l:
    ds_read_b64 v[8:9], v4 offset:32
    s_sub_u32 s25, s25, 1
    s_cbranch_scc1 k4_s13_x
    s_waitcnt lgkmcnt(0)
    v_cmp_gt_u32 vcc, 6144, v8
    s_cbranch_vccnz k4_s13_l
k4_s13_x:
    ds_read2st64_b64 v[224:227], v3 offset0:0 offset1:12
    ds_read2st64_b64 v[228:231], v3 offset0:24 offset1:36
    ds_read2st64_b64 v[232:235], v3 offset0:48 offset1:60
    ds_read2st64_b64 v[236:239], v3 offset0:72 offset1:84
    s_waitcnt lgkmcnt(0)
    s_setprio 1
    s_branch k4_s13_back
k4_s23:
    s_setprio 0
    s_mov_b32 s25, 0x100000
k4_s23_l:
    ds_read_b32 v8, v52 offset:51200
    s_sub_u32 s25, s25, 1
    s_cbranch_scc1 k4_s23_x
    s_waitcnt lgkmcnt(0)
    v_cmp_gt_u32 vcc, 6144, v8
    s_cbranch_vccnz k4_s23_l
k4_s23_x:
    ds_read_b128 v[224:227], v1 offset:49152
    ds_read_b128 v[228:231], v1 offset:50176
    s_waitcnt lgkmcnt(0)
    s_setprio 0
    s_branch k4_s23_back
HOT_END:
k4_fallback:
    s_nop 7
    s_nop 7
    s_barrier
    s_add_u32 s7, s6, 16777216
    v_and_b32 v1, 63, v0
    v_lshlrev_b32 v1, 4, v1
    v_lshlrev_b32 v5, 2, v0
    s_and_b32 s3, s2, 31
    s_lshl_b32 s3, s3, 3
    s_lshr_b32 s58, s2, 5
    s_add_u32 s3, s3, s58
    s_lshl_b32 s58, s58, 11
    s_add_u32 s58, s58, s7
    s_and_b32 s20, s2, 24
    s_lshl_b32 s20, s20, 11
    s_add_u32 s58, s58, s20
    s_and_b32 s20, s2, 7
    s_lshl_b32 s20, s20, 8
    s_add_u32 s58, s58, s20
    s_add_u32 s58, s58, 4718592
    s_add_u32 s62, s58, 262144
    s_lshl_b32 s31, s2, 3
    s_add_u32 s31, s31, s16
    s_lshl_b32 s31, s31, 10
    s_add_u32 s31, s31, 33554432
    v_bfe_u32 v8, v0, 3, 2
    v_lshlrev_b32 v9, 16, v8
    v_and_b32 v8, 7, v0
    v_lshl_add_u32 v9, v8, 5, v9
    v_bfe_u32 v8, v0, 5, 1
    v_lshl_add_u32 v9, v8, 4, v9
    v_and_b32 v13, 15, v0
    v_lshlrev_b32 v10, 8, v8
    v_lshl_add_u32 v10, v13, 4, v10
    v_lshlrev_b32 v15, 26, v13
    v_and_b32 v8, 16, v0
    v_cmp_eq_u32 vcc, 0, v8
    v_or_b32 v15, 131072, v15
    s_lshl_b32 s59, s16, 14
    s_add_u32 s59, s59, s7
    s_add_u32 s59, s59, 4259840
    v_cndmask_b32 v10, v15, v10, vcc
    s_mov_b32 s63, s59
    v_bfe_u32 v14, v0, 4, 2
    v_mul_u32_u24 v2, 3, v1
    s_mul_i32 s22, s16, 6144
    v_add_u32 v2, s22, v2
    v_lshrrev_b32 v15, 1, v0
    v_xor_b32 v15, v15, v0
    v_and_b32 v15, 4, v15
    v_mul_u32_u24 v15, 3, v15
    v_xor_b32 v15, v15, v0
    v_bfe_u32 v8, v15, 3, 5
    s_lshr_b32 s22, s16, 2
    s_mul_i32 s22, s22, 3072
    v_mad_u32_u24 v4, v8, 48, s22
    v_and_b32 v8, 1, v0
    v_mul_u32_u24 v3, 1536, v8
    v_and_b32 v8, 2, v0
    v_lshl_add_u32 v3, v8, 3, v3
    v_and_b32 v8, 8, v0
    v_add3_u32 v3, v3, v8, v4
    v_and_b32 v8, 7, v15
    v_mul_u32_u24 v8, 6144, v8
    v_add_u32 v4, v4, v8
    v_mov_b32 v7, v1
    v_mov_b32 v11, 0
    s_lshl_b32 s22, s17, 19
    s_lshl_b32 s21, s16, 16
    s_add_u32 s22, s22, s21
    s_add_u32 s40, s22, 5767168
    s_cmp_eq_u32 s17, 1
    s_cbranch_scc1 k4f_res1
    v_and_b32 v8, 1, v13
    v_bfe_u32 v15, v13, 2, 1
    v_lshl_or_b32 v8, v15, 1, v8
    s_and_b32 s22, s3, 2
    s_bfe_u32 s21, s3, 0x10002
    s_or_b32 s22, s22, s21
    v_xor_b32 v8, s22, v8
    v_lshlrev_b32 v8, 6, v8
    v_and_b32 v6, 31, v0
    v_and_b32 v12, 2, v14
    v_lshl_add_u32 v8, v6, 8, v8
    v_lshl_add_u32 v8, v12, 3, v8
    s_lshr_b32 s22, s3, 3
    s_lshl_b32 s22, s22, 16
    s_and_b32 s21, s3, 1
    s_lshl_b32 s21, s21, 5
    s_add_u32 s22, s22, s21
    s_lshl_b32 s21, s16, 13
    s_add_u32 s22, s22, s21
    s_add_u32 s57, s22, 18874368
    s_add_u32 s56, s57, 8
    v_lshlrev_b32 v6, 5, v6
    v_lshl_or_b32 v6, v12, 3, v6
    s_lshl_b32 s60, s16, 10
    s_lshl_b32 s21, s3, 13
    s_add_u32 s60, s60, s21
    s_add_u32 s60, s60, 16777216
    s_branch k4f_go
k4f_res1:
    v_lshrrev_b32 v8, 2, v13
    v_lshlrev_b32 v8, 16, v8
    v_lshl_add_u32 v8, v14, 6, v8
    v_and_b32 v15, 3, v13
    v_lshl_add_u32 v8, v15, 3, v8
    s_lshl_b32 s21, s16, 18
    s_add_u32 s22, s58, s21
    s_sub_u32 s57, s22, 4718592
    s_add_u32 s56, s57, 32
    v_lshlrev_b32 v6, 16, v14
    v_lshl_or_b32 v6, v13, 3, v6
    s_and_b32 s60, s3, 7
    s_lshl_b32 s60, s60, 18
    s_lshr_b32 s21, s3, 3
    s_lshl_b32 s21, s21, 10
    s_add_u32 s60, s60, s21
    s_lshl_b32 s21, s16, 7
    s_add_u32 s60, s60, s21
    s_add_u32 s61, s60, 32768
k4f_go:
    s_lshl_b32 s20, s17, 30
    v_or_b32 v13, s20, v1
    v_mov_b64 v[48:49], 0
    v_mov_b64 v[50:51], 0
    v_add_u32 v53, 3072, v2
    v_and_b32 v52, 0x3e0, v1
    v_add_u32 v52, v52, v1
    v_mov_b32 v55, 0xdddddddd
    v_bfe_i32 v54, v0, 1, 1
    v_and_b32 v54, 0xaaaaaaaa, v54
    v_or_b32 v54, 0x44444444, v54
    s_lshl_b32 s21, s16, 10
    s_add_u32 m0, s21, 53760
    s_mov_b32 s25, 16384
k4f_ld:
    s_mov_b32 s59, s63
    buffer_load_dwordx4 v[88:91], v9, s[8:11], s58 offen sc1
    buffer_load_dwordx4 v[92:95], v9, s[8:11], s62 offen sc1
    buffer_load_dwordx4 v[96:99], v1, s[8:11], s59 offen offset:0 sc1
    buffer_load_dwordx4 v[100:103], v10, s[8:11], s59 offen offset:1024 sc1
    buffer_load_dwordx4 v[104:107], v10, s[8:11], s59 offen offset:1536 sc1
    buffer_load_dwordx4 v[108:111], v1, s[8:11], s59 offen offset:2048 sc1
    buffer_load_dwordx4 v[112:115], v10, s[8:11], s59 offen offset:3072 sc1
    buffer_load_dwordx4 v[116:119], v10, s[8:11], s59 offen offset:3584 sc1
    s_add_u32 s59, s59, 4096
    buffer_load_dwordx4 v[120:123], v1, s[8:11], s59 offen offset:0 sc1
    buffer_load_dwordx4 v[124:127], v10, s[8:11], s59 offen offset:1024 sc1
    buffer_load_dwordx4 v[128:131], v10, s[8:11], s59 offen offset:1536 sc1
    buffer_load_dwordx4 v[132:135], v1, s[8:11], s59 offen offset:2048 sc1
    buffer_load_dwordx4 v[136:139], v10, s[8:11], s59 offen offset:3072 sc1
    buffer_load_dwordx4 v[140:143], v10, s[8:11], s59 offen offset:3584 sc1
    s_add_u32 s59, s59, 4096
    buffer_load_dwordx4 v[144:147], v1, s[8:11], s59 offen offset:0 sc1
    buffer_load_dwordx4 v[148:151], v10, s[8:11], s59 offen offset:1024 sc1
    buffer_load_dwordx4 v[152:155], v10, s[8:11], s59 offen offset:1536 sc1
    buffer_load_dwordx4 v[156:159], v1, s[8:11], s59 offen offset:2048 sc1
    buffer_load_dwordx4 v[160:163], v10, s[8:11], s59 offen offset:3072 sc1
    buffer_load_dwordx4 v[164:167], v10, s[8:11], s59 offen offset:3584 sc1
    s_add_u32 s59, s59, 4096
    buffer_load_dwordx4 v[168:171], v1, s[8:11], s59 offen offset:0 sc1
    buffer_load_dwordx4 v[172:175], v10, s[8:11], s59 offen offset:1024 sc1
    buffer_load_dwordx4 v[176:179], v10, s[8:11], s59 offen offset:1536 sc1
    buffer_load_dwordx4 v[180:183], v1, s[8:11], s59 offen offset:2048 sc1
    buffer_load_dwordx4 v[184:187], v10, s[8:11], s59 offen offset:3072 sc1
    buffer_load_dwordx4 v[188:191], v10, s[8:11], s59 offen offset:3584 sc1
    s_add_u32 s59, s59, 4096
    s_lshl_b32 s20, s16, 18
    s_add_u32 s20, s20, s58
    buffer_load_dwordx4 v9, s[8:11], s20 offen sc1 lds
    buffer_load_dwordx2 v[232:233], v8, s[8:11], s57 offen sc1
    buffer_load_dwordx2 v[234:235], v8, s[8:11], s56 offen sc1
    s_lshl_b32 s21, s16, 10
    v_add_u32 v14, s21, v1
    s_waitcnt vmcnt(0)
    ds_read_b32 v14, v14 offset:53760
    s_sub_u32 s25, s25, 1
    s_waitcnt lgkmcnt(0)
    v_max3_u32 v14, v14, v232, v234
    v_max3_u32 v14, v14, v88, v92
    v_max3_u32 v14, v14, v96, v100
    v_max3_u32 v14, v14, v104, v108
    v_max3_u32 v14, v14, v112, v116
    v_max3_u32 v14, v14, v120, v124
    v_max3_u32 v14, v14, v128, v132
    v_max3_u32 v14, v14, v136, v140
    v_max3_u32 v14, v14, v144, v148
    v_max3_u32 v14, v14, v152, v156
    v_max3_u32 v14, v14, v160, v164
    v_max3_u32 v14, v14, v168, v172
    v_max3_u32 v14, v14, v176, v180
    v_max3_u32 v14, v14, v184, v188
    v_cmp_eq_u32 vcc, -1, v14
    s_cbranch_scc1 k4f_ok
    s_cbranch_vccnz k4f_ld
k4f_ok:
    s_waitcnt vmcnt(0)
    s_barrier
    s_mov_b32 s22, 0
    v_lshrrev_b32 v11, 2, v1
    s_lshl_b32 s21, s16, 8
    v_add_u32 v12, s21, v11
k4f_mx:
    ds_read_b128 v[56:59], v7 offset:53760
    v_mov_b32 v48, 0xff800000
    s_waitcnt lgkmcnt(0)
    v_mfma_f32_32x32x16_bf16 v[32:47], v[96:99], v[56:59], 0
    s_nop 11
    v_max3_f32 v48, v32, v33, v48
    v_max3_f32 v48, v34, v35, v48
    v_max3_f32 v48, v36, v37, v48
    v_max3_f32 v48, v38, v39, v48
    v_max3_f32 v48, v40, v41, v48
    v_max3_f32 v48, v42, v43, v48
    v_max3_f32 v48, v44, v45, v48
    v_max3_f32 v48, v46, v47, v48
    v_mfma_f32_32x32x16_bf16 v[32:47], v[108:111], v[56:59], 0
    s_nop 11
    v_max3_f32 v48, v32, v33, v48
    v_max3_f32 v48, v34, v35, v48
    v_max3_f32 v48, v36, v37, v48
    v_max3_f32 v48, v38, v39, v48
    v_max3_f32 v48, v40, v41, v48
    v_max3_f32 v48, v42, v43, v48
    v_max3_f32 v48, v44, v45, v48
    v_max3_f32 v48, v46, v47, v48
    v_mfma_f32_32x32x16_bf16 v[32:47], v[120:123], v[56:59], 0
    s_nop 11
    v_max3_f32 v48, v32, v33, v48
    v_max3_f32 v48, v34, v35, v48
    v_max3_f32 v48, v36, v37, v48
    v_max3_f32 v48, v38, v39, v48
    v_max3_f32 v48, v40, v41, v48
    v_max3_f32 v48, v42, v43, v48
    v_max3_f32 v48, v44, v45, v48
    v_max3_f32 v48, v46, v47, v48
    v_mfma_f32_32x32x16_bf16 v[32:47], v[132:135], v[56:59], 0
    s_nop 11
    v_max3_f32 v48, v32, v33, v48
    v_max3_f32 v48, v34, v35, v48
    v_max3_f32 v48, v36, v37, v48
    v_max3_f32 v48, v38, v39, v48
    v_max3_f32 v48, v40, v41, v48
    v_max3_f32 v48, v42, v43, v48
    v_max3_f32 v48, v44, v45, v48
    v_max3_f32 v48, v46, v47, v48
    v_mfma_f32_32x32x16_bf16 v[32:47], v[144:147], v[56:59], 0
    s_nop 11
    v_max3_f32 v48, v32, v33, v48
    v_max3_f32 v48, v34, v35, v48
    v_max3_f32 v48, v36, v37, v48
    v_max3_f32 v48, v38, v39, v48
    v_max3_f32 v48, v40, v41, v48
    v_max3_f32 v48, v42, v43, v48
    v_max3_f32 v48, v44, v45, v48
    v_max3_f32 v48, v46, v47, v48
    v_mfma_f32_32x32x16_bf16 v[32:47], v[156:159], v[56:59], 0
    s_nop 11
    v_max3_f32 v48, v32, v33, v48
    v_max3_f32 v48, v34, v35, v48
    v_max3_f32 v48, v36, v37, v48
    v_max3_f32 v48, v38, v39, v48
    v_max3_f32 v48, v40, v41, v48
    v_max3_f32 v48, v42, v43, v48
    v_max3_f32 v48, v44, v45, v48
    v_max3_f32 v48, v46, v47, v48
    v_mfma_f32_32x32x16_bf16 v[32:47], v[168:171], v[56:59], 0
    s_nop 11
    v_max3_f32 v48, v32, v33, v48
    v_max3_f32 v48, v34, v35, v48
    v_max3_f32 v48, v36, v37, v48
    v_max3_f32 v48, v38, v39, v48
    v_max3_f32 v48, v40, v41, v48
    v_max3_f32 v48, v42, v43, v48
    v_max3_f32 v48, v44, v45, v48
    v_max3_f32 v48, v46, v47, v48
    v_mfma_f32_32x32x16_bf16 v[32:47], v[180:183], v[56:59], 0
    s_nop 11
    v_max3_f32 v48, v32, v33, v48
    v_max3_f32 v48, v34, v35, v48
    v_max3_f32 v48, v36, v37, v48
    v_max3_f32 v48, v38, v39, v48
    v_max3_f32 v48, v40, v41, v48
    v_max3_f32 v48, v42, v43, v48
    v_max3_f32 v48, v44, v45, v48
    v_max3_f32 v48, v46, v47, v48
    v_mov_b32 v49, v48
    s_nop 1
    v_permlane32_swap_b32 v48, v49
    v_max_f32 v48, v48, v49
    ds_write_b32 v12, v48 offset:0
    v_add_u32 v12, 2048, v12
    v_add_u32 v7, 1024, v7
    s_add_u32 s22, s22, 1
    s_cmp_lt_u32 s22, 8
    s_cbranch_scc1 k4f_mx
    s_lshl_b32 s21, s16, 11
    v_add_u32 v11, s21, v11
    s_waitcnt lgkmcnt(0)
    s_barrier
    ds_read_b32 v48, v11 offset:0
    ds_read_b32 v49, v11 offset:256
    ds_read_b32 v50, v11 offset:512
    ds_read_b32 v51, v11 offset:768
    ds_read_b32 v52, v11 offset:1024
    ds_read_b32 v53, v11 offset:1280
    ds_read_b32 v54, v11 offset:1536
    ds_read_b32 v55, v11 offset:1792
    s_lshl_b32 s21, s16, 10
    v_add_u32 v11, s21, v1
    s_waitcnt lgkmcnt(0)
    v_max3_f32 v48, v48, v49, v50
    v_max3_f32 v48, v48, v51, v52
    v_max3_f32 v48, v48, v53, v54
    v_max_f32 v48, v48, v55
    ds_write_b32 v11, v48 offset:64000
    v_mov_b32 v7, v1
    s_waitcnt lgkmcnt(0)
    s_barrier
    v_mov_b64 v[48:49], 0
    v_mov_b64 v[50:51], 0
    v_add_u32 v53, 3072, v2
    v_and_b32 v52, 0x3e0, v1
    v_add_u32 v52, v52, v1
    v_mov_b32 v55, 0xdddddddd
    v_bfe_i32 v54, v0, 1, 1
    v_and_b32 v54, 0xaaaaaaaa, v54
    v_or_b32 v54, 0x44444444, v54
    ds_write_b32 v2, v48 offset:32
    ds_write_b32 v53, v48 offset:32
    ds_write_b32 v5, v48 offset:51200
    v_mfma_f32_32x32x16_bf16 v[56:71], v[48:51], v[48:51], 0
    v_mfma_f32_32x32x16_bf16 v[72:87], v[48:51], v[48:51], 0
    v_mfma_f32_32x32x16_bf16 v[240:255], v[48:51], v[48:51], 0
    s_waitcnt lgkmcnt(0)
    s_barrier
    v_mfma_f32_32x32x16_bf16 v[16:31], v[96:99], v[88:91], 0
    ds_read_b32 v11, v7 offset:64000
    s_waitcnt lgkmcnt(0)
    v_mfma_f32_32x32x16_bf16 v[32:47], v[96:99], v[92:95], 0
    s_nop 8
    v_sub_f32 v16, v16, v11
    v_exp_f32 v16, v16
    v_sub_f32 v17, v17, v11
    v_exp_f32 v17, v17
    v_sub_f32 v18, v18, v11
    v_exp_f32 v18, v18
    v_sub_f32 v19, v19, v11
    v_exp_f32 v19, v19
    v_sub_f32 v20, v20, v11
    v_exp_f32 v20, v20
    v_sub_f32 v21, v21, v11
    v_exp_f32 v21, v21
    v_sub_f32 v22, v22, v11
    v_exp_f32 v22, v22
    v_sub_f32 v23, v23, v11
    v_exp_f32 v23, v23
    v_sub_f32 v24, v24, v11
    v_exp_f32 v24, v24
    v_sub_f32 v25, v25, v11
    v_exp_f32 v25, v25
    v_smfmac_f32_32x32x32_bf16 v[56:71], v[100:103], v[16:23], v55
    v_sub_f32 v26, v26, v11
    v_exp_f32 v26, v26
    v_sub_f32 v27, v27, v11
    v_exp_f32 v27, v27
    v_sub_f32 v28, v28, v11
    v_exp_f32 v28, v28
    v_sub_f32 v29, v29, v11
    v_exp_f32 v29, v29
    v_sub_f32 v30, v30, v11
    v_exp_f32 v30, v30
    v_sub_f32 v31, v31, v11
    v_exp_f32 v31, v31
    ds_read_b32 v12, v7 offset:65024
    s_waitcnt lgkmcnt(0)
    v_sub_f32 v32, v32, v12
    v_exp_f32 v32, v32
    v_sub_f32 v33, v33, v12
    v_exp_f32 v33, v33
    v_smfmac_f32_32x32x32_bf16 v[56:71], v[104:107], v[24:31], v55
    s_add_u32 s41, s40, 16384
    s_add_u32 s42, s40, 32768
    s_setprio 3
    v_sub_f32 v34, v34, v12
    v_exp_f32 v34, v34
    v_sub_f32 v35, v35, v12
    v_exp_f32 v35, v35
    v_sub_f32 v36, v36, v12
    v_exp_f32 v36, v36
    v_mfma_f32_32x32x16_bf16 v[16:31], v[108:111], v[88:91], 0
    v_sub_f32 v37, v37, v12
    v_exp_f32 v37, v37
    v_sub_f32 v38, v38, v12
    v_exp_f32 v38, v38
    v_sub_f32 v39, v39, v12
    v_exp_f32 v39, v39
    v_sub_f32 v40, v40, v12
    v_exp_f32 v40, v40
    v_sub_f32 v41, v41, v12
    v_exp_f32 v41, v41
    v_smfmac_f32_32x32x32_bf16 v[72:87], v[100:103], v[32:39], v55
    v_sub_f32 v42, v42, v12
    v_exp_f32 v42, v42
    v_sub_f32 v43, v43, v12
    v_exp_f32 v43, v43
    v_sub_f32 v44, v44, v12
    v_exp_f32 v44, v44
    v_sub_f32 v45, v45, v12
    v_exp_f32 v45, v45
    v_sub_f32 v46, v46, v12
    v_exp_f32 v46, v46
    v_sub_f32 v47, v47, v12
    v_exp_f32 v47, v47
    v_sub_f32 v16, v16, v11
    v_exp_f32 v16, v16
    v_sub_f32 v17, v17, v11
    v_exp_f32 v17, v17
    v_smfmac_f32_32x32x32_bf16 v[72:87], v[104:107], v[40:47], v55
    v_sub_f32 v18, v18, v11
    v_exp_f32 v18, v18
    v_sub_f32 v19, v19, v11
    v_exp_f32 v19, v19
    v_sub_f32 v20, v20, v11
    v_exp_f32 v20, v20
    v_mfma_f32_32x32x16_bf16 v[32:47], v[108:111], v[92:95], 0
    v_sub_f32 v21, v21, v11
    v_exp_f32 v21, v21
    v_sub_f32 v22, v22, v11
    v_exp_f32 v22, v22
    v_sub_f32 v23, v23, v11
    v_exp_f32 v23, v23
    v_sub_f32 v24, v24, v11
    v_exp_f32 v24, v24
    v_sub_f32 v25, v25, v11
    v_exp_f32 v25, v25
    v_smfmac_f32_32x32x32_bf16 v[56:71], v[112:115], v[16:23], v55
    v_sub_f32 v26, v26, v11
    v_exp_f32 v26, v26
    v_sub_f32 v27, v27, v11
    v_exp_f32 v27, v27
    v_sub_f32 v28, v28, v11
    v_exp_f32 v28, v28
    v_sub_f32 v29, v29, v11
    v_exp_f32 v29, v29
    v_sub_f32 v30, v30, v11
    v_exp_f32 v30, v30
    v_sub_f32 v31, v31, v11
    v_exp_f32 v31, v31
    v_sub_f32 v32, v32, v12
    v_exp_f32 v32, v32
    v_sub_f32 v33, v33, v12
    v_exp_f32 v33, v33
    v_smfmac_f32_32x32x32_bf16 v[56:71], v[116:119], v[24:31], v55
    s_add_u32 s43, s40, 49152
    v_sub_f32 v34, v34, v12
    v_exp_f32 v34, v34
    v_sub_f32 v35, v35, v12
    v_exp_f32 v35, v35
    v_sub_f32 v36, v36, v12
    v_exp_f32 v36, v36
    v_mfma_f32_32x32x16_bf16 v[16:31], v[120:123], v[88:91], 0
    v_sub_f32 v37, v37, v12
    v_exp_f32 v37, v37
    v_sub_f32 v38, v38, v12
    v_exp_f32 v38, v38
    v_sub_f32 v39, v39, v12
    v_exp_f32 v39, v39
    v_sub_f32 v40, v40, v12
    v_exp_f32 v40, v40
    v_sub_f32 v41, v41, v12
    v_exp_f32 v41, v41
    v_smfmac_f32_32x32x32_bf16 v[72:87], v[112:115], v[32:39], v55
    v_sub_f32 v42, v42, v12
    v_exp_f32 v42, v42
    v_sub_f32 v43, v43, v12
    v_exp_f32 v43, v43
    v_sub_f32 v44, v44, v12
    v_exp_f32 v44, v44
    v_sub_f32 v45, v45, v12
    v_exp_f32 v45, v45
    v_sub_f32 v46, v46, v12
    v_exp_f32 v46, v46
    v_sub_f32 v47, v47, v12
    v_exp_f32 v47, v47
    v_sub_f32 v16, v16, v11
    v_exp_f32 v16, v16
    v_sub_f32 v17, v17, v11
    v_exp_f32 v17, v17
    v_smfmac_f32_32x32x32_bf16 v[72:87], v[116:119], v[40:47], v55
    v_sub_f32 v18, v18, v11
    v_exp_f32 v18, v18
    v_sub_f32 v19, v19, v11
    v_exp_f32 v19, v19
    v_sub_f32 v20, v20, v11
    v_exp_f32 v20, v20
    v_mfma_f32_32x32x16_bf16 v[32:47], v[120:123], v[92:95], 0
    v_sub_f32 v21, v21, v11
    v_exp_f32 v21, v21
    v_sub_f32 v22, v22, v11
    v_exp_f32 v22, v22
    v_sub_f32 v23, v23, v11
    v_exp_f32 v23, v23
    v_sub_f32 v24, v24, v11
    v_exp_f32 v24, v24
    v_sub_f32 v25, v25, v11
    v_exp_f32 v25, v25
    v_smfmac_f32_32x32x32_bf16 v[56:71], v[124:127], v[16:23], v55
    v_sub_f32 v26, v26, v11
    v_exp_f32 v26, v26
    v_sub_f32 v27, v27, v11
    v_exp_f32 v27, v27
    v_sub_f32 v28, v28, v11
    v_exp_f32 v28, v28
    v_sub_f32 v29, v29, v11
    v_exp_f32 v29, v29
    v_sub_f32 v30, v30, v11
    v_exp_f32 v30, v30
    v_sub_f32 v31, v31, v11
    v_exp_f32 v31, v31
    v_sub_f32 v32, v32, v12
    v_exp_f32 v32, v32
    v_sub_f32 v33, v33, v12
    v_exp_f32 v33, v33
    v_smfmac_f32_32x32x32_bf16 v[56:71], v[128:131], v[24:31], v55
    v_sub_f32 v34, v34, v12
    v_exp_f32 v34, v34
    v_sub_f32 v35, v35, v12
    v_exp_f32 v35, v35
    v_sub_f32 v36, v36, v12
    v_exp_f32 v36, v36
    v_mfma_f32_32x32x16_bf16 v[16:31], v[132:135], v[88:91], 0
    v_sub_f32 v37, v37, v12
    v_exp_f32 v37, v37
    v_sub_f32 v38, v38, v12
    v_exp_f32 v38, v38
    v_sub_f32 v39, v39, v12
    v_exp_f32 v39, v39
    v_sub_f32 v40, v40, v12
    v_exp_f32 v40, v40
    v_sub_f32 v41, v41, v12
    v_exp_f32 v41, v41
    v_smfmac_f32_32x32x32_bf16 v[72:87], v[124:127], v[32:39], v55
    v_sub_f32 v42, v42, v12
    v_exp_f32 v42, v42
    v_sub_f32 v43, v43, v12
    v_exp_f32 v43, v43
    v_sub_f32 v44, v44, v12
    v_exp_f32 v44, v44
    v_sub_f32 v45, v45, v12
    v_exp_f32 v45, v45
    v_sub_f32 v46, v46, v12
    v_exp_f32 v46, v46
    v_sub_f32 v47, v47, v12
    v_exp_f32 v47, v47
    v_sub_f32 v16, v16, v11
    v_exp_f32 v16, v16
    v_sub_f32 v17, v17, v11
    v_exp_f32 v17, v17
    v_smfmac_f32_32x32x32_bf16 v[72:87], v[128:131], v[40:47], v55
    v_sub_f32 v18, v18, v11
    v_exp_f32 v18, v18
    v_sub_f32 v19, v19, v11
    v_exp_f32 v19, v19
    v_sub_f32 v20, v20, v11
    v_exp_f32 v20, v20
    v_mfma_f32_32x32x16_bf16 v[32:47], v[132:135], v[92:95], 0
    v_sub_f32 v21, v21, v11
    v_exp_f32 v21, v21
    v_sub_f32 v22, v22, v11
    v_exp_f32 v22, v22
    v_sub_f32 v23, v23, v11
    v_exp_f32 v23, v23
    v_sub_f32 v24, v24, v11
    v_exp_f32 v24, v24
    v_sub_f32 v25, v25, v11
    v_exp_f32 v25, v25
    v_smfmac_f32_32x32x32_bf16 v[56:71], v[136:139], v[16:23], v55
    v_sub_f32 v26, v26, v11
    v_exp_f32 v26, v26
    v_sub_f32 v27, v27, v11
    v_exp_f32 v27, v27
    v_sub_f32 v28, v28, v11
    v_exp_f32 v28, v28
    v_sub_f32 v29, v29, v11
    v_exp_f32 v29, v29
    v_sub_f32 v30, v30, v11
    v_exp_f32 v30, v30
    v_sub_f32 v31, v31, v11
    v_exp_f32 v31, v31
    v_sub_f32 v32, v32, v12
    v_exp_f32 v32, v32
    v_sub_f32 v33, v33, v12
    v_exp_f32 v33, v33
    v_smfmac_f32_32x32x32_bf16 v[56:71], v[140:143], v[24:31], v55
    buffer_load_dwordx4 v[192:195], v1, s[8:11], s40 offen offset:0
    v_sub_f32 v34, v34, v12
    v_exp_f32 v34, v34
    v_sub_f32 v35, v35, v12
    v_exp_f32 v35, v35
    v_sub_f32 v36, v36, v12
    v_exp_f32 v36, v36
    v_mfma_f32_32x32x16_bf16 v[16:31], v[144:147], v[88:91], 0
    v_sub_f32 v37, v37, v12
    v_exp_f32 v37, v37
    v_sub_f32 v38, v38, v12
    v_exp_f32 v38, v38
    v_sub_f32 v39, v39, v12
    v_exp_f32 v39, v39
    v_sub_f32 v40, v40, v12
    v_exp_f32 v40, v40
    v_sub_f32 v41, v41, v12
    v_exp_f32 v41, v41
    v_smfmac_f32_32x32x32_bf16 v[72:87], v[136:139], v[32:39], v55
    buffer_load_dwordx4 v[196:199], v1, s[8:11], s40 offen offset:1024
    v_sub_f32 v42, v42, v12
    v_exp_f32 v42, v42
    v_sub_f32 v43, v43, v12
    v_exp_f32 v43, v43
    v_sub_f32 v44, v44, v12
    v_exp_f32 v44, v44
    v_sub_f32 v45, v45, v12
    v_exp_f32 v45, v45
    v_sub_f32 v46, v46, v12
    v_exp_f32 v46, v46
    v_sub_f32 v47, v47, v12
    v_exp_f32 v47, v47
    v_sub_f32 v16, v16, v11
    v_exp_f32 v16, v16
    v_sub_f32 v17, v17, v11
    v_exp_f32 v17, v17
    v_smfmac_f32_32x32x32_bf16 v[72:87], v[140:143], v[40:47], v55
    v_sub_f32 v18, v18, v11
    v_exp_f32 v18, v18
    v_sub_f32 v19, v19, v11
    v_exp_f32 v19, v19
    v_sub_f32 v20, v20, v11
    v_exp_f32 v20, v20
    v_mfma_f32_32x32x16_bf16 v[32:47], v[144:147], v[92:95], 0
    v_sub_f32 v21, v21, v11
    v_exp_f32 v21, v21
    v_sub_f32 v22, v22, v11
    v_exp_f32 v22, v22
    v_sub_f32 v23, v23, v11
    v_exp_f32 v23, v23
    v_sub_f32 v24, v24, v11
    v_exp_f32 v24, v24
    v_sub_f32 v25, v25, v11
    v_exp_f32 v25, v25
    v_smfmac_f32_32x32x32_bf16 v[56:71], v[148:151], v[16:23], v55
    s_add_u32 s44, s40, 4096
    s_add_u32 s45, s40, 20480
    buffer_load_dwordx4 v[200:203], v1, s[8:11], s41 offen offset:0
    v_sub_f32 v26, v26, v11
    v_exp_f32 v26, v26
    v_sub_f32 v27, v27, v11
    v_exp_f32 v27, v27
    v_sub_f32 v28, v28, v11
    v_exp_f32 v28, v28
    v_sub_f32 v29, v29, v11
    v_exp_f32 v29, v29
    v_sub_f32 v30, v30, v11
    v_exp_f32 v30, v30
    v_sub_f32 v31, v31, v11
    v_exp_f32 v31, v31
    v_sub_f32 v32, v32, v12
    v_exp_f32 v32, v32
    v_sub_f32 v33, v33, v12
    v_exp_f32 v33, v33
    v_smfmac_f32_32x32x32_bf16 v[56:71], v[152:155], v[24:31], v55
    s_setprio 2
    v_sub_f32 v34, v34, v12
    v_exp_f32 v34, v34
    v_sub_f32 v35, v35, v12
    v_exp_f32 v35, v35
    v_sub_f32 v36, v36, v12
    v_exp_f32 v36, v36
    v_mfma_f32_32x32x16_bf16 v[16:31], v[156:159], v[88:91], 0
    v_sub_f32 v37, v37, v12
    v_exp_f32 v37, v37
    v_sub_f32 v38, v38, v12
    v_exp_f32 v38, v38
    v_sub_f32 v39, v39, v12
    v_exp_f32 v39, v39
    v_sub_f32 v40, v40, v12
    v_exp_f32 v40, v40
    v_sub_f32 v41, v41, v12
    v_exp_f32 v41, v41
    v_smfmac_f32_32x32x32_bf16 v[72:87], v[148:151], v[32:39], v55
    s_add_u32 s46, s40, 36864
    s_add_u32 s47, s40, 53248
    buffer_load_dwordx2 v[232:233], v8, s[8:11], s57 offen sc1
    v_sub_f32 v42, v42, v12
    v_exp_f32 v42, v42
    v_sub_f32 v43, v43, v12
    v_exp_f32 v43, v43
    v_sub_f32 v44, v44, v12
    v_exp_f32 v44, v44
    v_sub_f32 v45, v45, v12
    v_exp_f32 v45, v45
    v_sub_f32 v46, v46, v12
    v_exp_f32 v46, v46
    v_sub_f32 v47, v47, v12
    v_exp_f32 v47, v47
    v_sub_f32 v16, v16, v11
    v_exp_f32 v16, v16
    v_sub_f32 v17, v17, v11
    v_exp_f32 v17, v17
    v_smfmac_f32_32x32x32_bf16 v[72:87], v[152:155], v[40:47], v55
    buffer_load_dwordx2 v[234:235], v8, s[8:11], s56 offen sc1
    v_sub_f32 v18, v18, v11
    v_exp_f32 v18, v18
    v_sub_f32 v19, v19, v11
    v_exp_f32 v19, v19
    v_sub_f32 v20, v20, v11
    v_exp_f32 v20, v20
    v_mfma_f32_32x32x16_bf16 v[32:47], v[156:159], v[92:95], 0
    buffer_load_dwordx4 v[204:207], v1, s[8:11], s41 offen offset:1024
    v_sub_f32 v21, v21, v11
    v_exp_f32 v21, v21
    v_sub_f32 v22, v22, v11
    v_exp_f32 v22, v22
    v_sub_f32 v23, v23, v11
    v_exp_f32 v23, v23
    v_sub_f32 v24, v24, v11
    v_exp_f32 v24, v24
    v_sub_f32 v25, v25, v11
    v_exp_f32 v25, v25
    v_smfmac_f32_32x32x32_bf16 v[56:71], v[160:163], v[16:23], v55
    s_add_u32 s48, s40, 8192
    s_add_u32 s49, s40, 24576
    buffer_load_dwordx4 v[208:211], v1, s[8:11], s42 offen offset:0
    v_sub_f32 v26, v26, v11
    v_exp_f32 v26, v26
    v_sub_f32 v27, v27, v11
    v_exp_f32 v27, v27
    v_sub_f32 v28, v28, v11
    v_exp_f32 v28, v28
    v_sub_f32 v29, v29, v11
    v_exp_f32 v29, v29
    v_sub_f32 v30, v30, v11
    v_exp_f32 v30, v30
    v_sub_f32 v31, v31, v11
    v_exp_f32 v31, v31
    v_sub_f32 v32, v32, v12
    v_exp_f32 v32, v32
    v_sub_f32 v33, v33, v12
    v_exp_f32 v33, v33
    v_smfmac_f32_32x32x32_bf16 v[56:71], v[164:167], v[24:31], v55
    v_sub_f32 v34, v34, v12
    v_exp_f32 v34, v34
    v_sub_f32 v35, v35, v12
    v_exp_f32 v35, v35
    v_sub_f32 v36, v36, v12
    v_exp_f32 v36, v36
    v_mfma_f32_32x32x16_bf16 v[16:31], v[168:171], v[88:91], 0
    v_sub_f32 v37, v37, v12
    v_exp_f32 v37, v37
    v_sub_f32 v38, v38, v12
    v_exp_f32 v38, v38
    v_sub_f32 v39, v39, v12
    v_exp_f32 v39, v39
    v_sub_f32 v40, v40, v12
    v_exp_f32 v40, v40
    v_sub_f32 v41, v41, v12
    v_exp_f32 v41, v41
    v_smfmac_f32_32x32x32_bf16 v[72:87], v[160:163], v[32:39], v55
    s_add_u32 s50, s40, 40960
    s_add_u32 s51, s40, 57344
    buffer_load_dwordx4 v[212:215], v1, s[8:11], s42 offen offset:1024
    v_sub_f32 v42, v42, v12
    v_exp_f32 v42, v42
    v_sub_f32 v43, v43, v12
    v_exp_f32 v43, v43
    v_sub_f32 v44, v44, v12
    v_exp_f32 v44, v44
    v_sub_f32 v45, v45, v12
    v_exp_f32 v45, v45
    v_sub_f32 v46, v46, v12
    v_exp_f32 v46, v46
    v_sub_f32 v47, v47, v12
    v_exp_f32 v47, v47
    s_barrier
    v_sub_f32 v16, v16, v11
    v_exp_f32 v16, v16
    v_sub_f32 v17, v17, v11
    v_exp_f32 v17, v17
    v_smfmac_f32_32x32x32_bf16 v[72:87], v[164:167], v[40:47], v55
    v_sub_f32 v18, v18, v11
    v_exp_f32 v18, v18
    v_sub_f32 v19, v19, v11
    v_exp_f32 v19, v19
    v_sub_f32 v20, v20, v11
    v_exp_f32 v20, v20
    v_mfma_f32_32x32x16_bf16 v[32:47], v[168:171], v[92:95], 0
    v_sub_f32 v21, v21, v11
    v_exp_f32 v21, v21
    v_sub_f32 v22, v22, v11
    v_exp_f32 v22, v22
    v_sub_f32 v23, v23, v11
    v_exp_f32 v23, v23
    v_sub_f32 v24, v24, v11
    v_exp_f32 v24, v24
    v_sub_f32 v25, v25, v11
    v_exp_f32 v25, v25
    v_smfmac_f32_32x32x32_bf16 v[56:71], v[172:175], v[16:23], v55
    s_add_u32 s52, s40, 12288
    s_add_u32 s53, s40, 28672
    buffer_load_dwordx4 v[216:219], v1, s[8:11], s43 offen offset:0
    v_sub_f32 v26, v26, v11
    v_exp_f32 v26, v26
    v_sub_f32 v27, v27, v11
    v_exp_f32 v27, v27
    v_sub_f32 v28, v28, v11
    v_exp_f32 v28, v28
    v_sub_f32 v29, v29, v11
    v_exp_f32 v29, v29
    v_sub_f32 v30, v30, v11
    v_exp_f32 v30, v30
    v_sub_f32 v31, v31, v11
    v_exp_f32 v31, v31
    v_sub_f32 v32, v32, v12
    v_exp_f32 v32, v32
    v_sub_f32 v33, v33, v12
    v_exp_f32 v33, v33
    v_smfmac_f32_32x32x32_bf16 v[56:71], v[176:179], v[24:31], v55
    v_sub_f32 v34, v34, v12
    v_exp_f32 v34, v34
    v_sub_f32 v35, v35, v12
    v_exp_f32 v35, v35
    v_sub_f32 v36, v36, v12
    v_exp_f32 v36, v36
    v_mfma_f32_32x32x16_bf16 v[16:31], v[180:183], v[88:91], 0
    ds_read_b128 v[88:91], v7 offset:55808
    v_sub_f32 v37, v37, v12
    v_exp_f32 v37, v37
    v_sub_f32 v38, v38, v12
    v_exp_f32 v38, v38
    v_sub_f32 v39, v39, v12
    v_exp_f32 v39, v39
    v_sub_f32 v40, v40, v12
    v_exp_f32 v40, v40
    v_sub_f32 v41, v41, v12
    v_exp_f32 v41, v41
    v_smfmac_f32_32x32x32_bf16 v[72:87], v[172:175], v[32:39], v55
    s_add_u32 s54, s40, 45056
    s_add_u32 s55, s40, 61440
    buffer_load_dwordx4 v[220:223], v1, s[8:11], s43 offen offset:1024
    v_sub_f32 v42, v42, v12
    v_exp_f32 v42, v42
    v_sub_f32 v43, v43, v12
    v_exp_f32 v43, v43
    v_sub_f32 v44, v44, v12
    v_exp_f32 v44, v44
    v_sub_f32 v45, v45, v12
    v_exp_f32 v45, v45
    v_sub_f32 v46, v46, v12
    v_exp_f32 v46, v46
    v_sub_f32 v47, v47, v12
    v_exp_f32 v47, v47
    s_waitcnt vmcnt(5)
    s_mov_b32 s20, 0xffff0000
    s_cmp_eq_u32 s17, 1
    s_cbranch_scc1 k4f_init1
    v_permlane16_swap_b32 v232, v233
    v_permlane16_swap_b32 v234, v235
    v_lshlrev_b32 v240, 16, v232
    v_and_b32 v241, s20, v232
    v_lshlrev_b32 v248, 16, v233
    v_and_b32 v249, s20, v233
    v_lshlrev_b32 v244, 16, v234
    v_and_b32 v245, s20, v234
    v_lshlrev_b32 v252, 16, v235
    v_and_b32 v253, s20, v235
    s_branch k4f_init2
k4f_init1:
    v_lshlrev_b32 v240, 16, v232
    v_and_b32 v244, s20, v232
    v_lshlrev_b32 v248, 16, v233
    v_and_b32 v252, s20, v233
    v_lshlrev_b32 v241, 16, v234
    v_and_b32 v245, s20, v234
    v_lshlrev_b32 v249, 16, v235
    v_and_b32 v253, s20, v235
k4f_init2:
    v_sub_f32 v16, v16, v11
    v_exp_f32 v16, v16
    v_sub_f32 v17, v17, v11
    v_exp_f32 v17, v17
    v_smfmac_f32_32x32x32_bf16 v[72:87], v[176:179], v[40:47], v55
    v_sub_f32 v18, v18, v11
    v_exp_f32 v18, v18
    v_sub_f32 v19, v19, v11
    v_exp_f32 v19, v19
    v_sub_f32 v20, v20, v11
    v_exp_f32 v20, v20
    v_mfma_f32_32x32x16_bf16 v[32:47], v[180:183], v[92:95], 0
    ds_read_b128 v[92:95], v7 offset:56832
    v_sub_f32 v21, v21, v11
    v_exp_f32 v21, v21
    v_sub_f32 v22, v22, v11
    v_exp_f32 v22, v22
    v_sub_f32 v23, v23, v11
    v_exp_f32 v23, v23
    v_sub_f32 v24, v24, v11
    v_exp_f32 v24, v24
    v_sub_f32 v25, v25, v11
    v_exp_f32 v25, v25
    v_smfmac_f32_32x32x32_bf16 v[56:71], v[184:187], v[16:23], v55
    v_sub_f32 v26, v26, v11
    v_exp_f32 v26, v26
    v_sub_f32 v27, v27, v11
    v_exp_f32 v27, v27
    v_sub_f32 v28, v28, v11
    v_exp_f32 v28, v28
    v_sub_f32 v29, v29, v11
    v_exp_f32 v29, v29
    v_sub_f32 v30, v30, v11
    v_exp_f32 v30, v30
    v_sub_f32 v31, v31, v11
    v_exp_f32 v31, v31
    v_sub_f32 v32, v32, v12
    v_exp_f32 v32, v32
    v_sub_f32 v33, v33, v12
    v_exp_f32 v33, v33
    v_smfmac_f32_32x32x32_bf16 v[56:71], v[188:191], v[24:31], v55
    s_waitcnt lgkmcnt(0)
    v_sub_f32 v34, v34, v12
    v_exp_f32 v34, v34
    v_sub_f32 v35, v35, v12
    v_exp_f32 v35, v35
    v_sub_f32 v36, v36, v12
    v_exp_f32 v36, v36
    v_mfma_f32_32x32x16_bf16 v[16:31], v[96:99], v[88:91], 0
    v_sub_f32 v37, v37, v12
    v_exp_f32 v37, v37
    v_sub_f32 v38, v38, v12
    v_exp_f32 v38, v38
    v_sub_f32 v39, v39, v12
    v_exp_f32 v39, v39
    v_sub_f32 v40, v40, v12
    v_exp_f32 v40, v40
    v_sub_f32 v41, v41, v12
    v_exp_f32 v41, v41
    v_smfmac_f32_32x32x32_bf16 v[72:87], v[184:187], v[32:39], v55
    v_sub_f32 v42, v42, v12
    v_exp_f32 v42, v42
    v_add_u32 v7, 2048, v7
    v_sub_f32 v43, v43, v12
    v_exp_f32 v43, v43
    ds_write_b128 v2, v[56:59] offset:0
    v_sub_f32 v44, v44, v12
    v_exp_f32 v44, v44
    ds_write_b128 v2, v[60:63] offset:16
    v_sub_f32 v45, v45, v12
    v_exp_f32 v45, v45
    ds_write2_b32 v2, v7, v64 offset0:8 offset1:9
    v_sub_f32 v46, v46, v12
    v_exp_f32 v46, v46
    v_sub_f32 v47, v47, v12
    v_exp_f32 v47, v47
    v_mfma_f32_32x32x16_bf16 v[56:71], v[48:51], v[48:51], 0
    ds_read_b32 v11, v7 offset:64000
    s_waitcnt lgkmcnt(0)
    v_sub_f32 v16, v16, v11
    v_exp_f32 v16, v16
    v_sub_f32 v17, v17, v11
    v_exp_f32 v17, v17
    v_smfmac_f32_32x32x32_bf16 v[72:87], v[188:191], v[40:47], v55
    v_sub_f32 v18, v18, v11
    v_exp_f32 v18, v18
    v_sub_f32 v19, v19, v11
    v_exp_f32 v19, v19
    v_sub_f32 v20, v20, v11
    v_exp_f32 v20, v20
    v_mfma_f32_32x32x16_bf16 v[32:47], v[96:99], v[92:95], 0
    v_sub_f32 v21, v21, v11
    v_exp_f32 v21, v21
    v_sub_f32 v22, v22, v11
    v_exp_f32 v22, v22
    v_sub_f32 v23, v23, v11
    v_exp_f32 v23, v23
    v_sub_f32 v24, v24, v11
    v_exp_f32 v24, v24
    v_sub_f32 v25, v25, v11
    v_exp_f32 v25, v25
    v_smfmac_f32_32x32x32_bf16 v[56:71], v[100:103], v[16:23], v55
    v_sub_f32 v26, v26, v11
    v_exp_f32 v26, v26
    v_sub_f32 v27, v27, v11
    v_exp_f32 v27, v27
    ds_write_b128 v2, v[72:75] offset:3072
    v_sub_f32 v28, v28, v11
    v_exp_f32 v28, v28
    ds_write_b128 v2, v[76:79] offset:3088
    v_sub_f32 v29, v29, v11
    v_exp_f32 v29, v29
    ds_write2_b32 v53, v7, v80 offset0:8 offset1:9
    v_sub_f32 v30, v30, v11
    v_exp_f32 v30, v30
    v_mfma_f32_32x32x16_bf16 v[72:87], v[48:51], v[48:51], 0
    v_sub_f32 v31, v31, v11
    v_exp_f32 v31, v31
    ds_read_b32 v12, v7 offset:65024
    s_waitcnt lgkmcnt(0)
    v_sub_f32 v32, v32, v12
    v_exp_f32 v32, v32
    v_sub_f32 v33, v33, v12
    v_exp_f32 v33, v33
    v_smfmac_f32_32x32x32_bf16 v[56:71], v[104:107], v[24:31], v55
    s_setprio 1
    v_sub_f32 v34, v34, v12
    v_exp_f32 v34, v34
    v_sub_f32 v35, v35, v12
    v_exp_f32 v35, v35
    v_sub_f32 v36, v36, v12
    v_exp_f32 v36, v36
    v_mfma_f32_32x32x16_bf16 v[16:31], v[108:111], v[88:91], 0
    s_waitcnt lgkmcnt(0)
    v_sub_f32 v37, v37, v12
    v_exp_f32 v37, v37
    v_sub_f32 v38, v38, v12
    v_exp_f32 v38, v38
    v_sub_f32 v39, v39, v12
    v_exp_f32 v39, v39
    v_sub_f32 v40, v40, v12
    v_exp_f32 v40, v40
    v_sub_f32 v41, v41, v12
    v_exp_f32 v41, v41
    v_smfmac_f32_32x32x32_bf16 v[72:87], v[100:103], v[32:39], v55
    v_sub_f32 v42, v42, v12
    v_exp_f32 v42, v42
    v_sub_f32 v43, v43, v12
    v_exp_f32 v43, v43
    v_sub_f32 v44, v44, v12
    v_exp_f32 v44, v44
    v_sub_f32 v45, v45, v12
    v_exp_f32 v45, v45
    v_sub_f32 v46, v46, v12
    v_exp_f32 v46, v46
    v_sub_f32 v47, v47, v12
    v_exp_f32 v47, v47
    v_sub_f32 v16, v16, v11
    v_exp_f32 v16, v16
    v_sub_f32 v17, v17, v11
    v_exp_f32 v17, v17
    v_smfmac_f32_32x32x32_bf16 v[72:87], v[104:107], v[40:47], v55
    s_barrier
    ds_read_b64 v[8:9], v4 offset:32
    v_sub_f32 v18, v18, v11
    v_exp_f32 v18, v18
    v_sub_f32 v19, v19, v11
    v_exp_f32 v19, v19
    v_sub_f32 v20, v20, v11
    v_exp_f32 v20, v20
    v_mfma_f32_32x32x16_bf16 v[32:47], v[108:111], v[92:95], 0
    ds_read2st64_b64 v[224:227], v3 offset0:0 offset1:12
    v_sub_f32 v21, v21, v11
    v_exp_f32 v21, v21
    v_sub_f32 v22, v22, v11
    v_exp_f32 v22, v22
    v_sub_f32 v23, v23, v11
    v_exp_f32 v23, v23
    v_sub_f32 v24, v24, v11
    v_exp_f32 v24, v24
    v_sub_f32 v25, v25, v11
    v_exp_f32 v25, v25
    v_smfmac_f32_32x32x32_bf16 v[56:71], v[112:115], v[16:23], v55
    ds_read2st64_b64 v[228:231], v3 offset0:24 offset1:36
    v_sub_f32 v26, v26, v11
    v_exp_f32 v26, v26
    v_sub_f32 v27, v27, v11
    v_exp_f32 v27, v27
    v_sub_f32 v28, v28, v11
    v_exp_f32 v28, v28
    v_sub_f32 v29, v29, v11
    v_exp_f32 v29, v29
    v_sub_f32 v30, v30, v11
    v_exp_f32 v30, v30
    v_sub_f32 v31, v31, v11
    v_exp_f32 v31, v31
    v_sub_f32 v32, v32, v12
    v_exp_f32 v32, v32
    v_sub_f32 v33, v33, v12
    v_exp_f32 v33, v33
    v_smfmac_f32_32x32x32_bf16 v[56:71], v[116:119], v[24:31], v55
    ds_read2st64_b64 v[232:235], v3 offset0:48 offset1:60
    v_sub_f32 v34, v34, v12
    v_exp_f32 v34, v34
    v_sub_f32 v35, v35, v12
    v_exp_f32 v35, v35
    v_sub_f32 v36, v36, v12
    v_exp_f32 v36, v36
    v_mfma_f32_32x32x16_bf16 v[16:31], v[120:123], v[88:91], 0
    ds_read2st64_b64 v[236:239], v3 offset0:72 offset1:84
    v_sub_f32 v37, v37, v12
    v_exp_f32 v37, v37
    v_sub_f32 v38, v38, v12
    v_exp_f32 v38, v38
    v_sub_f32 v39, v39, v12
    v_exp_f32 v39, v39
    v_sub_f32 v40, v40, v12
    v_exp_f32 v40, v40
    v_sub_f32 v41, v41, v12
    v_exp_f32 v41, v41
    v_smfmac_f32_32x32x32_bf16 v[72:87], v[112:115], v[32:39], v55
    s_waitcnt lgkmcnt(0)
    v_sub_f32 v42, v42, v12
    v_exp_f32 v42, v42
    v_sub_f32 v43, v43, v12
    v_exp_f32 v43, v43
    v_sub_f32 v44, v44, v12
    v_exp_f32 v44, v44
    v_sub_f32 v45, v45, v12
    v_exp_f32 v45, v45
    v_sub_f32 v46, v46, v12
    v_exp_f32 v46, v46
    v_sub_f32 v47, v47, v12
    v_exp_f32 v47, v47
    v_sub_f32 v16, v16, v11
    v_exp_f32 v16, v16
    v_sub_f32 v17, v17, v11
    v_exp_f32 v17, v17
    v_smfmac_f32_32x32x32_bf16 v[72:87], v[116:119], v[40:47], v55
    v_sub_f32 v18, v18, v11
    v_exp_f32 v18, v18
    v_add_f32_dpp v9, v9, v9 quad_perm:[1,0,3,2] row_mask:0xf bank_mask:0xf
    v_sub_f32 v19, v19, v11
    v_exp_f32 v19, v19
    v_add_f32 v224, v224, v226
    v_sub_f32 v20, v20, v11
    v_exp_f32 v20, v20
    v_add_f32 v225, v225, v227
    v_mfma_f32_32x32x16_bf16 v[32:47], v[120:123], v[92:95], 0
    v_sub_f32 v21, v21, v11
    v_exp_f32 v21, v21
    v_add_f32_dpp v9, v9, v9 quad_perm:[2,3,0,1] row_mask:0xf bank_mask:0xf
    v_sub_f32 v22, v22, v11
    v_exp_f32 v22, v22
    v_add_f32 v228, v228, v230
    v_sub_f32 v23, v23, v11
    v_exp_f32 v23, v23
    v_add_f32 v229, v229, v231
    v_sub_f32 v24, v24, v11
    v_exp_f32 v24, v24
    v_add_f32_dpp v9, v9, v9 row_ror:8 row_mask:0xf bank_mask:0xf
    v_sub_f32 v25, v25, v11
    v_exp_f32 v25, v25
    v_add_f32 v232, v232, v234
    v_smfmac_f32_32x32x32_bf16 v[56:71], v[124:127], v[16:23], v55
    v_sub_f32 v26, v26, v11
    v_exp_f32 v26, v26
    v_add_f32 v233, v233, v235
    v_sub_f32 v27, v27, v11
    v_exp_f32 v27, v27
    v_rcp_f32 v10, v9
    v_sub_f32 v28, v28, v11
    v_exp_f32 v28, v28
    v_add_f32 v236, v236, v238
    v_sub_f32 v29, v29, v11
    v_exp_f32 v29, v29
    v_add_f32 v237, v237, v239
    v_sub_f32 v30, v30, v11
    v_exp_f32 v30, v30
    v_add_f32 v224, v224, v228
    v_sub_f32 v31, v31, v11
    v_exp_f32 v31, v31
    v_add_f32 v225, v225, v229
    v_sub_f32 v32, v32, v12
    v_exp_f32 v32, v32
    v_add_f32 v232, v232, v236
    v_sub_f32 v33, v33, v12
    v_exp_f32 v33, v33
    v_add_f32 v233, v233, v237
    v_smfmac_f32_32x32x32_bf16 v[56:71], v[128:131], v[24:31], v55
    v_sub_f32 v34, v34, v12
    v_exp_f32 v34, v34
    v_add_f32 v224, v224, v232
    v_sub_f32 v35, v35, v12
    v_exp_f32 v35, v35
    v_add_f32 v225, v225, v233
    v_sub_f32 v36, v36, v12
    v_exp_f32 v36, v36
    v_mul_f32 v224, v224, v10
    v_mfma_f32_32x32x16_bf16 v[16:31], v[132:135], v[88:91], 0
    buffer_load_dwordx4 v[232:235], v1, s[8:11], s40 offen offset:2048
    v_sub_f32 v37, v37, v12
    v_exp_f32 v37, v37
    v_mul_f32 v225, v225, v10
    v_sub_f32 v38, v38, v12
    v_exp_f32 v38, v38
    v_cvt_pk_bf16_f32 v224, v224, v225
    v_sub_f32 v39, v39, v12
    v_exp_f32 v39, v39
    ds_write2st64_b32 v5, v224, v7 offset0:192 offset1:200
    v_sub_f32 v40, v40, v12
    v_exp_f32 v40, v40
    v_sub_f32 v41, v41, v12
    v_exp_f32 v41, v41
    v_smfmac_f32_32x32x32_bf16 v[72:87], v[124:127], v[32:39], v55
    s_setprio 0
    buffer_load_dwordx4 v[236:239], v1, s[8:11], s40 offen offset:3072
    v_sub_f32 v42, v42, v12
    v_exp_f32 v42, v42
    v_sub_f32 v43, v43, v12
    v_exp_f32 v43, v43
    v_sub_f32 v44, v44, v12
    v_exp_f32 v44, v44
    v_sub_f32 v45, v45, v12
    v_exp_f32 v45, v45
    v_sub_f32 v46, v46, v12
    v_exp_f32 v46, v46
    v_sub_f32 v47, v47, v12
    v_exp_f32 v47, v47
    v_sub_f32 v16, v16, v11
    v_exp_f32 v16, v16
    v_sub_f32 v17, v17, v11
    v_exp_f32 v17, v17
    v_smfmac_f32_32x32x32_bf16 v[72:87], v[128:131], v[40:47], v55
    s_waitcnt lgkmcnt(0)
    v_sub_f32 v18, v18, v11
    v_exp_f32 v18, v18
    v_sub_f32 v19, v19, v11
    v_exp_f32 v19, v19
    v_sub_f32 v20, v20, v11
    v_exp_f32 v20, v20
    v_mfma_f32_32x32x16_bf16 v[32:47], v[132:135], v[92:95], 0
    s_barrier
    ds_read_b32 v8, v52 offset:51200
    v_sub_f32 v21, v21, v11
    v_exp_f32 v21, v21
    v_sub_f32 v22, v22, v11
    v_exp_f32 v22, v22
    v_sub_f32 v23, v23, v11
    v_exp_f32 v23, v23
    v_sub_f32 v24, v24, v11
    v_exp_f32 v24, v24
    v_sub_f32 v25, v25, v11
    v_exp_f32 v25, v25
    v_smfmac_f32_32x32x32_bf16 v[56:71], v[136:139], v[16:23], v55
    ds_read_b128 v[224:227], v1 offset:49152
    v_sub_f32 v26, v26, v11
    v_exp_f32 v26, v26
    v_sub_f32 v27, v27, v11
    v_exp_f32 v27, v27
    v_sub_f32 v28, v28, v11
    v_exp_f32 v28, v28
    v_sub_f32 v29, v29, v11
    v_exp_f32 v29, v29
    v_sub_f32 v30, v30, v11
    v_exp_f32 v30, v30
    v_sub_f32 v31, v31, v11
    v_exp_f32 v31, v31
    v_sub_f32 v32, v32, v12
    v_exp_f32 v32, v32
    v_sub_f32 v33, v33, v12
    v_exp_f32 v33, v33
    v_smfmac_f32_32x32x32_bf16 v[56:71], v[140:143], v[24:31], v55
    ds_read_b128 v[228:231], v1 offset:50176
    v_sub_f32 v34, v34, v12
    v_exp_f32 v34, v34
    v_sub_f32 v35, v35, v12
    v_exp_f32 v35, v35
    v_sub_f32 v36, v36, v12
    v_exp_f32 v36, v36
    v_mfma_f32_32x32x16_bf16 v[16:31], v[144:147], v[88:91], 0
    s_waitcnt lgkmcnt(0)
    v_sub_f32 v37, v37, v12
    v_exp_f32 v37, v37
    v_sub_f32 v38, v38, v12
    v_exp_f32 v38, v38
    v_sub_f32 v39, v39, v12
    v_exp_f32 v39, v39
    v_sub_f32 v40, v40, v12
    v_exp_f32 v40, v40
    v_sub_f32 v41, v41, v12
    v_exp_f32 v41, v41
    v_smfmac_f32_32x32x32_bf16 v[72:87], v[136:139], v[32:39], v55
    s_setprio 3
    v_sub_f32 v42, v42, v12
    v_exp_f32 v42, v42
    v_sub_f32 v43, v43, v12
    v_exp_f32 v43, v43
    v_sub_f32 v44, v44, v12
    v_exp_f32 v44, v44
    v_sub_f32 v45, v45, v12
    v_exp_f32 v45, v45
    v_smfmac_f32_16x16x64_bf16 v[240:243], v[224:227], v[192:199], v54
    buffer_load_dwordx4 v[192:195], v1, s[8:11], s41 offen offset:2048
    v_sub_f32 v46, v46, v12
    v_exp_f32 v46, v46
    v_sub_f32 v47, v47, v12
    v_exp_f32 v47, v47
    v_sub_f32 v16, v16, v11
    v_exp_f32 v16, v16
    v_sub_f32 v17, v17, v11
    v_exp_f32 v17, v17
    v_smfmac_f32_32x32x32_bf16 v[72:87], v[140:143], v[40:47], v55
    buffer_load_dwordx4 v[196:199], v1, s[8:11], s41 offen offset:3072
    v_sub_f32 v18, v18, v11
    v_exp_f32 v18, v18
    v_sub_f32 v19, v19, v11
    v_exp_f32 v19, v19
    v_sub_f32 v20, v20, v11
    v_exp_f32 v20, v20
    v_mfma_f32_32x32x16_bf16 v[32:47], v[144:147], v[92:95], 0
    v_sub_f32 v21, v21, v11
    v_exp_f32 v21, v21
    v_sub_f32 v22, v22, v11
    v_exp_f32 v22, v22
    v_sub_f32 v23, v23, v11
    v_exp_f32 v23, v23
    v_sub_f32 v24, v24, v11
    v_exp_f32 v24, v24
    v_sub_f32 v25, v25, v11
    v_exp_f32 v25, v25
    v_smfmac_f32_32x32x32_bf16 v[56:71], v[148:151], v[16:23], v55
    s_waitcnt vmcnt(8)
    v_sub_f32 v26, v26, v11
    v_exp_f32 v26, v26
    v_sub_f32 v27, v27, v11
    v_exp_f32 v27, v27
    v_sub_f32 v28, v28, v11
    v_exp_f32 v28, v28
    v_sub_f32 v29, v29, v11
    v_exp_f32 v29, v29
    v_smfmac_f32_16x16x64_bf16 v[244:247], v[224:227], v[200:207], v54
    buffer_load_dwordx4 v[200:203], v1, s[8:11], s42 offen offset:2048
    v_sub_f32 v30, v30, v11
    v_exp_f32 v30, v30
    v_sub_f32 v31, v31, v11
    v_exp_f32 v31, v31
    v_sub_f32 v32, v32, v12
    v_exp_f32 v32, v32
    v_sub_f32 v33, v33, v12
    v_exp_f32 v33, v33
    v_smfmac_f32_32x32x32_bf16 v[56:71], v[152:155], v[24:31], v55
    v_sub_f32 v34, v34, v12
    v_exp_f32 v34, v34
    v_sub_f32 v35, v35, v12
    v_exp_f32 v35, v35
    v_sub_f32 v36, v36, v12
    v_exp_f32 v36, v36
    v_mfma_f32_32x32x16_bf16 v[16:31], v[156:159], v[88:91], 0
    v_sub_f32 v37, v37, v12
    v_exp_f32 v37, v37
    v_sub_f32 v38, v38, v12
    v_exp_f32 v38, v38
    v_sub_f32 v39, v39, v12
    v_exp_f32 v39, v39
    v_sub_f32 v40, v40, v12
    v_exp_f32 v40, v40
    v_sub_f32 v41, v41, v12
    v_exp_f32 v41, v41
    v_smfmac_f32_32x32x32_bf16 v[72:87], v[148:151], v[32:39], v55
    s_waitcnt vmcnt(7)
    buffer_load_dwordx4 v[204:207], v1, s[8:11], s42 offen offset:3072
    v_sub_f32 v42, v42, v12
    v_exp_f32 v42, v42
    v_sub_f32 v43, v43, v12
    v_exp_f32 v43, v43
    v_sub_f32 v44, v44, v12
    v_exp_f32 v44, v44
    v_sub_f32 v45, v45, v12
    v_exp_f32 v45, v45
    v_smfmac_f32_16x16x64_bf16 v[248:251], v[224:227], v[208:215], v54
    v_sub_f32 v46, v46, v12
    v_exp_f32 v46, v46
    v_sub_f32 v47, v47, v12
    v_exp_f32 v47, v47
    v_sub_f32 v16, v16, v11
    v_exp_f32 v16, v16
    v_sub_f32 v17, v17, v11
    v_exp_f32 v17, v17
    v_smfmac_f32_32x32x32_bf16 v[72:87], v[152:155], v[40:47], v55
    v_sub_f32 v18, v18, v11
    v_exp_f32 v18, v18
    v_sub_f32 v19, v19, v11
    v_exp_f32 v19, v19
    v_sub_f32 v20, v20, v11
    v_exp_f32 v20, v20
    v_mfma_f32_32x32x16_bf16 v[32:47], v[156:159], v[92:95], 0
    buffer_load_dwordx4 v[208:211], v1, s[8:11], s43 offen offset:2048
    v_sub_f32 v21, v21, v11
    v_exp_f32 v21, v21
    v_sub_f32 v22, v22, v11
    v_exp_f32 v22, v22
    v_sub_f32 v23, v23, v11
    v_exp_f32 v23, v23
    v_sub_f32 v24, v24, v11
    v_exp_f32 v24, v24
    v_sub_f32 v25, v25, v11
    v_exp_f32 v25, v25
    v_smfmac_f32_32x32x32_bf16 v[56:71], v[160:163], v[16:23], v55
    s_waitcnt vmcnt(7)
    v_sub_f32 v26, v26, v11
    v_exp_f32 v26, v26
    v_sub_f32 v27, v27, v11
    v_exp_f32 v27, v27
    v_sub_f32 v28, v28, v11
    v_exp_f32 v28, v28
    v_sub_f32 v29, v29, v11
    v_exp_f32 v29, v29
    v_smfmac_f32_16x16x64_bf16 v[252:255], v[224:227], v[216:223], v54
    v_sub_f32 v30, v30, v11
    v_exp_f32 v30, v30
    v_sub_f32 v31, v31, v11
    v_exp_f32 v31, v31
    v_sub_f32 v32, v32, v12
    v_exp_f32 v32, v32
    v_sub_f32 v33, v33, v12
    v_exp_f32 v33, v33
    v_smfmac_f32_32x32x32_bf16 v[56:71], v[164:167], v[24:31], v55
    buffer_load_dwordx4 v[212:215], v1, s[8:11], s43 offen offset:3072
    v_sub_f32 v34, v34, v12
    v_exp_f32 v34, v34
    v_sub_f32 v35, v35, v12
    v_exp_f32 v35, v35
    v_sub_f32 v36, v36, v12
    v_exp_f32 v36, v36
    v_mfma_f32_32x32x16_bf16 v[16:31], v[168:171], v[88:91], 0
    v_sub_f32 v37, v37, v12
    v_exp_f32 v37, v37
    v_sub_f32 v38, v38, v12
    v_exp_f32 v38, v38
    v_sub_f32 v39, v39, v12
    v_exp_f32 v39, v39
    v_sub_f32 v40, v40, v12
    v_exp_f32 v40, v40
    v_sub_f32 v41, v41, v12
    v_exp_f32 v41, v41
    v_smfmac_f32_32x32x32_bf16 v[72:87], v[160:163], v[32:39], v55
    s_waitcnt vmcnt(6)
    v_sub_f32 v42, v42, v12
    v_exp_f32 v42, v42
    v_sub_f32 v43, v43, v12
    v_exp_f32 v43, v43
    v_sub_f32 v44, v44, v12
    v_exp_f32 v44, v44
    v_sub_f32 v45, v45, v12
    v_exp_f32 v45, v45
    v_smfmac_f32_16x16x64_bf16 v[240:243], v[228:231], v[232:239], v54
    buffer_load_dwordx4 v[216:219], v1, s[8:11], s47 offen offset:0
    v_sub_f32 v46, v46, v12
    v_exp_f32 v46, v46
    v_sub_f32 v47, v47, v12
    v_exp_f32 v47, v47
    v_sub_f32 v16, v16, v11
    v_exp_f32 v16, v16
    v_sub_f32 v17, v17, v11
    v_exp_f32 v17, v17
    v_smfmac_f32_32x32x32_bf16 v[72:87], v[164:167], v[40:47], v55
    s_setprio 2
    v_sub_f32 v18, v18, v11
    v_exp_f32 v18, v18
    v_sub_f32 v19, v19, v11
    v_exp_f32 v19, v19
    v_sub_f32 v20, v20, v11
    v_exp_f32 v20, v20
    v_mfma_f32_32x32x16_bf16 v[32:47], v[168:171], v[92:95], 0
    v_sub_f32 v21, v21, v11
    v_exp_f32 v21, v21
    v_sub_f32 v22, v22, v11
    v_exp_f32 v22, v22
    v_sub_f32 v23, v23, v11
    v_exp_f32 v23, v23
    v_sub_f32 v24, v24, v11
    v_exp_f32 v24, v24
    v_sub_f32 v25, v25, v11
    v_exp_f32 v25, v25
    v_smfmac_f32_32x32x32_bf16 v[56:71], v[172:175], v[16:23], v55
    s_waitcnt vmcnt(5)
    buffer_load_dwordx4 v[220:223], v1, s[8:11], s47 offen offset:1024
    v_sub_f32 v26, v26, v11
    v_exp_f32 v26, v26
    v_sub_f32 v27, v27, v11
    v_exp_f32 v27, v27
    v_sub_f32 v28, v28, v11
    v_exp_f32 v28, v28
    v_sub_f32 v29, v29, v11
    v_exp_f32 v29, v29
    v_smfmac_f32_16x16x64_bf16 v[244:247], v[228:231], v[192:199], v54
    v_sub_f32 v30, v30, v11
    v_exp_f32 v30, v30
    v_sub_f32 v31, v31, v11
    v_exp_f32 v31, v31
    v_sub_f32 v32, v32, v12
    v_exp_f32 v32, v32
    v_sub_f32 v33, v33, v12
    v_exp_f32 v33, v33
    v_smfmac_f32_32x32x32_bf16 v[56:71], v[176:179], v[24:31], v55
    v_sub_f32 v34, v34, v12
    v_exp_f32 v34, v34
    v_sub_f32 v35, v35, v12
    v_exp_f32 v35, v35
    v_sub_f32 v36, v36, v12
    v_exp_f32 v36, v36
    v_mfma_f32_32x32x16_bf16 v[16:31], v[180:183], v[88:91], 0
    ds_read_b128 v[88:91], v7 offset:55808
    v_sub_f32 v37, v37, v12
    v_exp_f32 v37, v37
    v_sub_f32 v38, v38, v12
    v_exp_f32 v38, v38
    v_sub_f32 v39, v39, v12
    v_exp_f32 v39, v39
    v_sub_f32 v40, v40, v12
    v_exp_f32 v40, v40
    v_sub_f32 v41, v41, v12
    v_exp_f32 v41, v41
    v_smfmac_f32_32x32x32_bf16 v[72:87], v[172:175], v[32:39], v55
    s_waitcnt vmcnt(4)
    buffer_load_dwordx4 v[192:195], v1, s[8:11], s44 offen offset:0
    v_sub_f32 v42, v42, v12
    v_exp_f32 v42, v42
    v_sub_f32 v43, v43, v12
    v_exp_f32 v43, v43
    v_sub_f32 v44, v44, v12
    v_exp_f32 v44, v44
    v_sub_f32 v45, v45, v12
    v_exp_f32 v45, v45
    v_smfmac_f32_16x16x64_bf16 v[248:251], v[228:231], v[200:207], v54
    v_sub_f32 v46, v46, v12
    v_exp_f32 v46, v46
    v_sub_f32 v47, v47, v12
    v_exp_f32 v47, v47
    v_sub_f32 v16, v16, v11
    v_exp_f32 v16, v16
    v_sub_f32 v17, v17, v11
    v_exp_f32 v17, v17
    v_smfmac_f32_32x32x32_bf16 v[72:87], v[176:179], v[40:47], v55
    buffer_load_dwordx4 v[196:199], v1, s[8:11], s44 offen offset:1024
    v_sub_f32 v18, v18, v11
    v_exp_f32 v18, v18
    v_sub_f32 v19, v19, v11
    v_exp_f32 v19, v19
    v_sub_f32 v20, v20, v11
    v_exp_f32 v20, v20
    v_mfma_f32_32x32x16_bf16 v[32:47], v[180:183], v[92:95], 0
    ds_read_b128 v[92:95], v7 offset:56832
    v_sub_f32 v21, v21, v11
    v_exp_f32 v21, v21
    v_sub_f32 v22, v22, v11
    v_exp_f32 v22, v22
    v_sub_f32 v23, v23, v11
    v_exp_f32 v23, v23
    v_sub_f32 v24, v24, v11
    v_exp_f32 v24, v24
    v_sub_f32 v25, v25, v11
    v_exp_f32 v25, v25
    v_smfmac_f32_32x32x32_bf16 v[56:71], v[184:187], v[16:23], v55
    s_waitcnt vmcnt(4)
    v_sub_f32 v26, v26, v11
    v_exp_f32 v26, v26
    v_sub_f32 v27, v27, v11
    v_exp_f32 v27, v27
    v_sub_f32 v28, v28, v11
    v_exp_f32 v28, v28
    v_sub_f32 v29, v29, v11
    v_exp_f32 v29, v29
    v_smfmac_f32_16x16x64_bf16 v[252:255], v[228:231], v[208:215], v54
    buffer_load_dwordx4 v[200:203], v1, s[8:11], s45 offen offset:0
    v_sub_f32 v30, v30, v11
    v_exp_f32 v30, v30
    v_sub_f32 v31, v31, v11
    v_exp_f32 v31, v31
    v_sub_f32 v32, v32, v12
    v_exp_f32 v32, v32
    v_sub_f32 v33, v33, v12
    v_exp_f32 v33, v33
    v_smfmac_f32_32x32x32_bf16 v[56:71], v[188:191], v[24:31], v55
    s_waitcnt lgkmcnt(0)
    v_sub_f32 v34, v34, v12
    v_exp_f32 v34, v34
    v_sub_f32 v35, v35, v12
    v_exp_f32 v35, v35
    v_sub_f32 v36, v36, v12
    v_exp_f32 v36, v36
    v_mfma_f32_32x32x16_bf16 v[16:31], v[96:99], v[88:91], 0
    v_sub_f32 v37, v37, v12
    v_exp_f32 v37, v37
    v_sub_f32 v38, v38, v12
    v_exp_f32 v38, v38
    v_sub_f32 v39, v39, v12
    v_exp_f32 v39, v39
    v_sub_f32 v40, v40, v12
    v_exp_f32 v40, v40
    v_sub_f32 v41, v41, v12
    v_exp_f32 v41, v41
    v_smfmac_f32_32x32x32_bf16 v[72:87], v[184:187], v[32:39], v55
    buffer_load_dwordx4 v[204:207], v1, s[8:11], s45 offen offset:1024
    v_sub_f32 v42, v42, v12
    v_exp_f32 v42, v42
    v_add_u32 v7, 2048, v7
    v_sub_f32 v43, v43, v12
    v_exp_f32 v43, v43
    ds_write_b128 v2, v[56:59] offset:0
    v_sub_f32 v44, v44, v12
    v_exp_f32 v44, v44
    ds_write_b128 v2, v[60:63] offset:16
    v_sub_f32 v45, v45, v12
    v_exp_f32 v45, v45
    ds_write2_b32 v2, v7, v64 offset0:8 offset1:9
    v_sub_f32 v46, v46, v12
    v_exp_f32 v46, v46
    v_sub_f32 v47, v47, v12
    v_exp_f32 v47, v47
    v_mfma_f32_32x32x16_bf16 v[56:71], v[48:51], v[48:51], 0
    ds_read_b32 v11, v7 offset:64000
    s_waitcnt lgkmcnt(0)
    v_sub_f32 v16, v16, v11
    v_exp_f32 v16, v16
    v_sub_f32 v17, v17, v11
    v_exp_f32 v17, v17
    v_smfmac_f32_32x32x32_bf16 v[72:87], v[188:191], v[40:47], v55
    v_sub_f32 v18, v18, v11
    v_exp_f32 v18, v18
    v_sub_f32 v19, v19, v11
    v_exp_f32 v19, v19
    v_sub_f32 v20, v20, v11
    v_exp_f32 v20, v20
    v_mfma_f32_32x32x16_bf16 v[32:47], v[96:99], v[92:95], 0
    buffer_load_dwordx4 v[208:211], v1, s[8:11], s46 offen offset:0
    v_sub_f32 v21, v21, v11
    v_exp_f32 v21, v21
    v_sub_f32 v22, v22, v11
    v_exp_f32 v22, v22
    v_sub_f32 v23, v23, v11
    v_exp_f32 v23, v23
    v_sub_f32 v24, v24, v11
    v_exp_f32 v24, v24
    v_sub_f32 v25, v25, v11
    v_exp_f32 v25, v25
    v_smfmac_f32_32x32x32_bf16 v[56:71], v[100:103], v[16:23], v55
    v_sub_f32 v26, v26, v11
    v_exp_f32 v26, v26
    v_sub_f32 v27, v27, v11
    v_exp_f32 v27, v27
    ds_write_b128 v2, v[72:75] offset:3072
    v_sub_f32 v28, v28, v11
    v_exp_f32 v28, v28
    ds_write_b128 v2, v[76:79] offset:3088
    v_sub_f32 v29, v29, v11
    v_exp_f32 v29, v29
    ds_write2_b32 v53, v7, v80 offset0:8 offset1:9
    v_sub_f32 v30, v30, v11
    v_exp_f32 v30, v30
    v_mfma_f32_32x32x16_bf16 v[72:87], v[48:51], v[48:51], 0
    v_sub_f32 v31, v31, v11
    v_exp_f32 v31, v31
    ds_read_b32 v12, v7 offset:65024
    s_waitcnt lgkmcnt(0)
    v_sub_f32 v32, v32, v12
    v_exp_f32 v32, v32
    v_sub_f32 v33, v33, v12
    v_exp_f32 v33, v33
    v_smfmac_f32_32x32x32_bf16 v[56:71], v[104:107], v[24:31], v55
    s_setprio 1
    buffer_load_dwordx4 v[212:215], v1, s[8:11], s46 offen offset:1024
    v_sub_f32 v34, v34, v12
    v_exp_f32 v34, v34
    v_sub_f32 v35, v35, v12
    v_exp_f32 v35, v35
    v_sub_f32 v36, v36, v12
    v_exp_f32 v36, v36
    v_mfma_f32_32x32x16_bf16 v[16:31], v[108:111], v[88:91], 0
    s_waitcnt lgkmcnt(0)
    v_sub_f32 v37, v37, v12
    v_exp_f32 v37, v37
    v_sub_f32 v38, v38, v12
    v_exp_f32 v38, v38
    v_sub_f32 v39, v39, v12
    v_exp_f32 v39, v39
    v_sub_f32 v40, v40, v12
    v_exp_f32 v40, v40
    v_sub_f32 v41, v41, v12
    v_exp_f32 v41, v41
    v_smfmac_f32_32x32x32_bf16 v[72:87], v[100:103], v[32:39], v55
    v_sub_f32 v42, v42, v12
    v_exp_f32 v42, v42
    v_sub_f32 v43, v43, v12
    v_exp_f32 v43, v43
    v_sub_f32 v44, v44, v12
    v_exp_f32 v44, v44
    v_sub_f32 v45, v45, v12
    v_exp_f32 v45, v45
    v_sub_f32 v46, v46, v12
    v_exp_f32 v46, v46
    v_sub_f32 v47, v47, v12
    v_exp_f32 v47, v47
    v_sub_f32 v16, v16, v11
    v_exp_f32 v16, v16
    v_sub_f32 v17, v17, v11
    v_exp_f32 v17, v17
    v_smfmac_f32_32x32x32_bf16 v[72:87], v[104:107], v[40:47], v55
    s_barrier
    ds_read_b64 v[8:9], v4 offset:32
    v_sub_f32 v18, v18, v11
    v_exp_f32 v18, v18
    v_sub_f32 v19, v19, v11
    v_exp_f32 v19, v19
    v_sub_f32 v20, v20, v11
    v_exp_f32 v20, v20
    v_mfma_f32_32x32x16_bf16 v[32:47], v[108:111], v[92:95], 0
    ds_read2st64_b64 v[224:227], v3 offset0:0 offset1:12
    v_sub_f32 v21, v21, v11
    v_exp_f32 v21, v21
    v_sub_f32 v22, v22, v11
    v_exp_f32 v22, v22
    v_sub_f32 v23, v23, v11
    v_exp_f32 v23, v23
    v_sub_f32 v24, v24, v11
    v_exp_f32 v24, v24
    v_sub_f32 v25, v25, v11
    v_exp_f32 v25, v25
    v_smfmac_f32_32x32x32_bf16 v[56:71], v[112:115], v[16:23], v55
    ds_read2st64_b64 v[228:231], v3 offset0:24 offset1:36
    v_sub_f32 v26, v26, v11
    v_exp_f32 v26, v26
    v_sub_f32 v27, v27, v11
    v_exp_f32 v27, v27
    v_sub_f32 v28, v28, v11
    v_exp_f32 v28, v28
    v_sub_f32 v29, v29, v11
    v_exp_f32 v29, v29
    v_sub_f32 v30, v30, v11
    v_exp_f32 v30, v30
    v_sub_f32 v31, v31, v11
    v_exp_f32 v31, v31
    v_sub_f32 v32, v32, v12
    v_exp_f32 v32, v32
    v_sub_f32 v33, v33, v12
    v_exp_f32 v33, v33
    v_smfmac_f32_32x32x32_bf16 v[56:71], v[116:119], v[24:31], v55
    ds_read2st64_b64 v[232:235], v3 offset0:48 offset1:60
    v_sub_f32 v34, v34, v12
    v_exp_f32 v34, v34
    v_sub_f32 v35, v35, v12
    v_exp_f32 v35, v35
    v_sub_f32 v36, v36, v12
    v_exp_f32 v36, v36
    v_mfma_f32_32x32x16_bf16 v[16:31], v[120:123], v[88:91], 0
    ds_read2st64_b64 v[236:239], v3 offset0:72 offset1:84
    v_sub_f32 v37, v37, v12
    v_exp_f32 v37, v37
    v_sub_f32 v38, v38, v12
    v_exp_f32 v38, v38
    v_sub_f32 v39, v39, v12
    v_exp_f32 v39, v39
    v_sub_f32 v40, v40, v12
    v_exp_f32 v40, v40
    v_sub_f32 v41, v41, v12
    v_exp_f32 v41, v41
    v_smfmac_f32_32x32x32_bf16 v[72:87], v[112:115], v[32:39], v55
    s_waitcnt lgkmcnt(0)
    v_sub_f32 v42, v42, v12
    v_exp_f32 v42, v42
    v_sub_f32 v43, v43, v12
    v_exp_f32 v43, v43
    v_sub_f32 v44, v44, v12
    v_exp_f32 v44, v44
    v_sub_f32 v45, v45, v12
    v_exp_f32 v45, v45
    v_sub_f32 v46, v46, v12
    v_exp_f32 v46, v46
    v_sub_f32 v47, v47, v12
    v_exp_f32 v47, v47
    v_sub_f32 v16, v16, v11
    v_exp_f32 v16, v16
    v_sub_f32 v17, v17, v11
    v_exp_f32 v17, v17
    v_smfmac_f32_32x32x32_bf16 v[72:87], v[116:119], v[40:47], v55
    v_sub_f32 v18, v18, v11
    v_exp_f32 v18, v18
    v_add_f32_dpp v9, v9, v9 quad_perm:[1,0,3,2] row_mask:0xf bank_mask:0xf
    v_sub_f32 v19, v19, v11
    v_exp_f32 v19, v19
    v_add_f32 v224, v224, v226
    v_sub_f32 v20, v20, v11
    v_exp_f32 v20, v20
    v_add_f32 v225, v225, v227
    v_mfma_f32_32x32x16_bf16 v[32:47], v[120:123], v[92:95], 0
    v_sub_f32 v21, v21, v11
    v_exp_f32 v21, v21
    v_add_f32_dpp v9, v9, v9 quad_perm:[2,3,0,1] row_mask:0xf bank_mask:0xf
    v_sub_f32 v22, v22, v11
    v_exp_f32 v22, v22
    v_add_f32 v228, v228, v230
    v_sub_f32 v23, v23, v11
    v_exp_f32 v23, v23
    v_add_f32 v229, v229, v231
    v_sub_f32 v24, v24, v11
    v_exp_f32 v24, v24
    v_add_f32_dpp v9, v9, v9 row_ror:8 row_mask:0xf bank_mask:0xf
    v_sub_f32 v25, v25, v11
    v_exp_f32 v25, v25
    v_add_f32 v232, v232, v234
    v_smfmac_f32_32x32x32_bf16 v[56:71], v[124:127], v[16:23], v55
    v_sub_f32 v26, v26, v11
    v_exp_f32 v26, v26
    v_add_f32 v233, v233, v235
    v_sub_f32 v27, v27, v11
    v_exp_f32 v27, v27
    v_rcp_f32 v10, v9
    v_sub_f32 v28, v28, v11
    v_exp_f32 v28, v28
    v_add_f32 v236, v236, v238
    v_sub_f32 v29, v29, v11
    v_exp_f32 v29, v29
    v_add_f32 v237, v237, v239
    v_sub_f32 v30, v30, v11
    v_exp_f32 v30, v30
    v_add_f32 v224, v224, v228
    v_sub_f32 v31, v31, v11
    v_exp_f32 v31, v31
    v_add_f32 v225, v225, v229
    v_sub_f32 v32, v32, v12
    v_exp_f32 v32, v32
    v_add_f32 v232, v232, v236
    v_sub_f32 v33, v33, v12
    v_exp_f32 v33, v33
    v_add_f32 v233, v233, v237
    v_smfmac_f32_32x32x32_bf16 v[56:71], v[128:131], v[24:31], v55
    v_sub_f32 v34, v34, v12
    v_exp_f32 v34, v34
    v_add_f32 v224, v224, v232
    v_sub_f32 v35, v35, v12
    v_exp_f32 v35, v35
    v_add_f32 v225, v225, v233
    v_sub_f32 v36, v36, v12
    v_exp_f32 v36, v36
    v_mul_f32 v224, v224, v10
    v_mfma_f32_32x32x16_bf16 v[16:31], v[132:135], v[88:91], 0
    buffer_load_dwordx4 v[232:235], v1, s[8:11], s44 offen offset:2048
    v_sub_f32 v37, v37, v12
    v_exp_f32 v37, v37
    v_mul_f32 v225, v225, v10
    v_sub_f32 v38, v38, v12
    v_exp_f32 v38, v38
    v_cvt_pk_bf16_f32 v224, v224, v225
    v_sub_f32 v39, v39, v12
    v_exp_f32 v39, v39
    ds_write2st64_b32 v5, v224, v7 offset0:192 offset1:200
    v_sub_f32 v40, v40, v12
    v_exp_f32 v40, v40
    v_sub_f32 v41, v41, v12
    v_exp_f32 v41, v41
    v_smfmac_f32_32x32x32_bf16 v[72:87], v[124:127], v[32:39], v55
    s_setprio 0
    buffer_load_dwordx4 v[236:239], v1, s[8:11], s44 offen offset:3072
    v_sub_f32 v42, v42, v12
    v_exp_f32 v42, v42
    v_sub_f32 v43, v43, v12
    v_exp_f32 v43, v43
    v_sub_f32 v44, v44, v12
    v_exp_f32 v44, v44
    v_sub_f32 v45, v45, v12
    v_exp_f32 v45, v45
    v_sub_f32 v46, v46, v12
    v_exp_f32 v46, v46
    v_sub_f32 v47, v47, v12
    v_exp_f32 v47, v47
    v_sub_f32 v16, v16, v11
    v_exp_f32 v16, v16
    v_sub_f32 v17, v17, v11
    v_exp_f32 v17, v17
    v_smfmac_f32_32x32x32_bf16 v[72:87], v[128:131], v[40:47], v55
    s_waitcnt lgkmcnt(0)
    v_sub_f32 v18, v18, v11
    v_exp_f32 v18, v18
    v_sub_f32 v19, v19, v11
    v_exp_f32 v19, v19
    v_sub_f32 v20, v20, v11
    v_exp_f32 v20, v20
    v_mfma_f32_32x32x16_bf16 v[32:47], v[132:135], v[92:95], 0
    s_barrier
    ds_read_b32 v8, v52 offset:51200
    v_sub_f32 v21, v21, v11
    v_exp_f32 v21, v21
    v_sub_f32 v22, v22, v11
    v_exp_f32 v22, v22
    v_sub_f32 v23, v23, v11
    v_exp_f32 v23, v23
    v_sub_f32 v24, v24, v11
    v_exp_f32 v24, v24
    v_sub_f32 v25, v25, v11
    v_exp_f32 v25, v25
    v_smfmac_f32_32x32x32_bf16 v[56:71], v[136:139], v[16:23], v55
    ds_read_b128 v[224:227], v1 offset:49152
    v_sub_f32 v26, v26, v11
    v_exp_f32 v26, v26
    v_sub_f32 v27, v27, v11
    v_exp_f32 v27, v27
    v_sub_f32 v28, v28, v11
    v_exp_f32 v28, v28
    v_sub_f32 v29, v29, v11
    v_exp_f32 v29, v29
    v_sub_f32 v30, v30, v11
    v_exp_f32 v30, v30
    v_sub_f32 v31, v31, v11
    v_exp_f32 v31, v31
    v_sub_f32 v32, v32, v12
    v_exp_f32 v32, v32
    v_sub_f32 v33, v33, v12
    v_exp_f32 v33, v33
    v_smfmac_f32_32x32x32_bf16 v[56:71], v[140:143], v[24:31], v55
    ds_read_b128 v[228:231], v1 offset:50176
    v_sub_f32 v34, v34, v12
    v_exp_f32 v34, v34
    v_sub_f32 v35, v35, v12
    v_exp_f32 v35, v35
    v_sub_f32 v36, v36, v12
    v_exp_f32 v36, v36
    v_mfma_f32_32x32x16_bf16 v[16:31], v[144:147], v[88:91], 0
    s_waitcnt lgkmcnt(0)
    v_sub_f32 v37, v37, v12
    v_exp_f32 v37, v37
    v_sub_f32 v38, v38, v12
    v_exp_f32 v38, v38
    v_sub_f32 v39, v39, v12
    v_exp_f32 v39, v39
    v_sub_f32 v40, v40, v12
    v_exp_f32 v40, v40
    v_sub_f32 v41, v41, v12
    v_exp_f32 v41, v41
    v_smfmac_f32_32x32x32_bf16 v[72:87], v[136:139], v[32:39], v55
    s_waitcnt vmcnt(6)
    s_setprio 3
    v_sub_f32 v42, v42, v12
    v_exp_f32 v42, v42
    v_sub_f32 v43, v43, v12
    v_exp_f32 v43, v43
    v_sub_f32 v44, v44, v12
    v_exp_f32 v44, v44
    v_sub_f32 v45, v45, v12
    v_exp_f32 v45, v45
    v_smfmac_f32_16x16x64_bf16 v[240:243], v[224:227], v[192:199], v54
    buffer_load_dwordx4 v[192:195], v1, s[8:11], s45 offen offset:2048
    v_sub_f32 v46, v46, v12
    v_exp_f32 v46, v46
    v_sub_f32 v47, v47, v12
    v_exp_f32 v47, v47
    v_sub_f32 v16, v16, v11
    v_exp_f32 v16, v16
    v_sub_f32 v17, v17, v11
    v_exp_f32 v17, v17
    v_smfmac_f32_32x32x32_bf16 v[72:87], v[140:143], v[40:47], v55
    buffer_load_dwordx4 v[196:199], v1, s[8:11], s45 offen offset:3072
    v_sub_f32 v18, v18, v11
    v_exp_f32 v18, v18
    v_sub_f32 v19, v19, v11
    v_exp_f32 v19, v19
    v_sub_f32 v20, v20, v11
    v_exp_f32 v20, v20
    v_mfma_f32_32x32x16_bf16 v[32:47], v[144:147], v[92:95], 0
    v_sub_f32 v21, v21, v11
    v_exp_f32 v21, v21
    v_sub_f32 v22, v22, v11
    v_exp_f32 v22, v22
    v_sub_f32 v23, v23, v11
    v_exp_f32 v23, v23
    v_sub_f32 v24, v24, v11
    v_exp_f32 v24, v24
    v_sub_f32 v25, v25, v11
    v_exp_f32 v25, v25
    v_smfmac_f32_32x32x32_bf16 v[56:71], v[148:151], v[16:23], v55
    s_waitcnt vmcnt(6)
    v_sub_f32 v26, v26, v11
    v_exp_f32 v26, v26
    v_sub_f32 v27, v27, v11
    v_exp_f32 v27, v27
    v_sub_f32 v28, v28, v11
    v_exp_f32 v28, v28
    v_sub_f32 v29, v29, v11
    v_exp_f32 v29, v29
    v_smfmac_f32_16x16x64_bf16 v[244:247], v[224:227], v[200:207], v54
    buffer_load_dwordx4 v[200:203], v1, s[8:11], s46 offen offset:2048
    v_sub_f32 v30, v30, v11
    v_exp_f32 v30, v30
    v_sub_f32 v31, v31, v11
    v_exp_f32 v31, v31
    v_sub_f32 v32, v32, v12
    v_exp_f32 v32, v32
    v_sub_f32 v33, v33, v12
    v_exp_f32 v33, v33
    v_smfmac_f32_32x32x32_bf16 v[56:71], v[152:155], v[24:31], v55
    v_sub_f32 v34, v34, v12
    v_exp_f32 v34, v34
    v_sub_f32 v35, v35, v12
    v_exp_f32 v35, v35
    v_sub_f32 v36, v36, v12
    v_exp_f32 v36, v36
    v_mfma_f32_32x32x16_bf16 v[16:31], v[156:159], v[88:91], 0
    v_sub_f32 v37, v37, v12
    v_exp_f32 v37, v37
    v_sub_f32 v38, v38, v12
    v_exp_f32 v38, v38
    v_sub_f32 v39, v39, v12
    v_exp_f32 v39, v39
    v_sub_f32 v40, v40, v12
    v_exp_f32 v40, v40
    v_sub_f32 v41, v41, v12
    v_exp_f32 v41, v41
    v_smfmac_f32_32x32x32_bf16 v[72:87], v[148:151], v[32:39], v55
    s_waitcnt vmcnt(5)
    buffer_load_dwordx4 v[204:207], v1, s[8:11], s46 offen offset:3072
    v_sub_f32 v42, v42, v12
    v_exp_f32 v42, v42
    v_sub_f32 v43, v43, v12
    v_exp_f32 v43, v43
    v_sub_f32 v44, v44, v12
    v_exp_f32 v44, v44
    v_sub_f32 v45, v45, v12
    v_exp_f32 v45, v45
    v_smfmac_f32_16x16x64_bf16 v[248:251], v[224:227], v[208:215], v54
    v_sub_f32 v46, v46, v12
    v_exp_f32 v46, v46
    v_sub_f32 v47, v47, v12
    v_exp_f32 v47, v47
    v_sub_f32 v16, v16, v11
    v_exp_f32 v16, v16
    v_sub_f32 v17, v17, v11
    v_exp_f32 v17, v17
    v_smfmac_f32_32x32x32_bf16 v[72:87], v[152:155], v[40:47], v55
    buffer_load_dwordx4 v[208:211], v1, s[8:11], s47 offen offset:2048
    v_sub_f32 v18, v18, v11
    v_exp_f32 v18, v18
    v_sub_f32 v19, v19, v11
    v_exp_f32 v19, v19
    v_sub_f32 v20, v20, v11
    v_exp_f32 v20, v20
    v_mfma_f32_32x32x16_bf16 v[32:47], v[156:159], v[92:95], 0
    v_sub_f32 v21, v21, v11
    v_exp_f32 v21, v21
    v_sub_f32 v22, v22, v11
    v_exp_f32 v22, v22
    v_sub_f32 v23, v23, v11
    v_exp_f32 v23, v23
    v_sub_f32 v24, v24, v11
    v_exp_f32 v24, v24
    v_sub_f32 v25, v25, v11
    v_exp_f32 v25, v25
    v_smfmac_f32_32x32x32_bf16 v[56:71], v[160:163], v[16:23], v55
    v_sub_f32 v26, v26, v11
    v_exp_f32 v26, v26
    v_sub_f32 v27, v27, v11
    v_exp_f32 v27, v27
    v_sub_f32 v28, v28, v11
    v_exp_f32 v28, v28
    v_sub_f32 v29, v29, v11
    v_exp_f32 v29, v29
    v_smfmac_f32_16x16x64_bf16 v[252:255], v[224:227], v[216:223], v54
    buffer_load_dwordx4 v[212:215], v1, s[8:11], s47 offen offset:3072
    v_sub_f32 v30, v30, v11
    v_exp_f32 v30, v30
    v_sub_f32 v31, v31, v11
    v_exp_f32 v31, v31
    v_sub_f32 v32, v32, v12
    v_exp_f32 v32, v32
    v_sub_f32 v33, v33, v12
    v_exp_f32 v33, v33
    v_smfmac_f32_32x32x32_bf16 v[56:71], v[164:167], v[24:31], v55
    v_sub_f32 v34, v34, v12
    v_exp_f32 v34, v34
    v_sub_f32 v35, v35, v12
    v_exp_f32 v35, v35
    v_sub_f32 v36, v36, v12
    v_exp_f32 v36, v36
    v_mfma_f32_32x32x16_bf16 v[16:31], v[168:171], v[88:91], 0
    v_sub_f32 v37, v37, v12
    v_exp_f32 v37, v37
    v_sub_f32 v38, v38, v12
    v_exp_f32 v38, v38
    v_sub_f32 v39, v39, v12
    v_exp_f32 v39, v39
    v_sub_f32 v40, v40, v12
    v_exp_f32 v40, v40
    v_sub_f32 v41, v41, v12
    v_exp_f32 v41, v41
    v_smfmac_f32_32x32x32_bf16 v[72:87], v[160:163], v[32:39], v55
    s_waitcnt vmcnt(6)
    buffer_load_dwordx4 v[216:219], v1, s[8:11], s51 offen offset:0
    v_sub_f32 v42, v42, v12
    v_exp_f32 v42, v42
    v_sub_f32 v43, v43, v12
    v_exp_f32 v43, v43
    v_sub_f32 v44, v44, v12
    v_exp_f32 v44, v44
    v_sub_f32 v45, v45, v12
    v_exp_f32 v45, v45
    v_smfmac_f32_16x16x64_bf16 v[240:243], v[228:231], v[232:239], v54
    v_sub_f32 v46, v46, v12
    v_exp_f32 v46, v46
    v_sub_f32 v47, v47, v12
    v_exp_f32 v47, v47
    v_sub_f32 v16, v16, v11
    v_exp_f32 v16, v16
    v_sub_f32 v17, v17, v11
    v_exp_f32 v17, v17
    v_smfmac_f32_32x32x32_bf16 v[72:87], v[164:167], v[40:47], v55
    s_setprio 2
    v_sub_f32 v18, v18, v11
    v_exp_f32 v18, v18
    v_sub_f32 v19, v19, v11
    v_exp_f32 v19, v19
    v_sub_f32 v20, v20, v11
    v_exp_f32 v20, v20
    v_mfma_f32_32x32x16_bf16 v[32:47], v[168:171], v[92:95], 0
    buffer_load_dwordx4 v[220:223], v1, s[8:11], s51 offen offset:1024
    v_sub_f32 v21, v21, v11
    v_exp_f32 v21, v21
    v_sub_f32 v22, v22, v11
    v_exp_f32 v22, v22
    v_sub_f32 v23, v23, v11
    v_exp_f32 v23, v23
    v_sub_f32 v24, v24, v11
    v_exp_f32 v24, v24
    v_sub_f32 v25, v25, v11
    v_exp_f32 v25, v25
    v_smfmac_f32_32x32x32_bf16 v[56:71], v[172:175], v[16:23], v55
    s_waitcnt vmcnt(6)
    v_sub_f32 v26, v26, v11
    v_exp_f32 v26, v26
    v_sub_f32 v27, v27, v11
    v_exp_f32 v27, v27
    v_sub_f32 v28, v28, v11
    v_exp_f32 v28, v28
    v_sub_f32 v29, v29, v11
    v_exp_f32 v29, v29
    v_smfmac_f32_16x16x64_bf16 v[244:247], v[228:231], v[192:199], v54
    buffer_load_dwordx4 v[192:195], v1, s[8:11], s48 offen offset:0
    v_sub_f32 v30, v30, v11
    v_exp_f32 v30, v30
    v_sub_f32 v31, v31, v11
    v_exp_f32 v31, v31
    v_sub_f32 v32, v32, v12
    v_exp_f32 v32, v32
    v_sub_f32 v33, v33, v12
    v_exp_f32 v33, v33
    v_smfmac_f32_32x32x32_bf16 v[56:71], v[176:179], v[24:31], v55
    v_sub_f32 v34, v34, v12
    v_exp_f32 v34, v34
    v_sub_f32 v35, v35, v12
    v_exp_f32 v35, v35
    v_sub_f32 v36, v36, v12
    v_exp_f32 v36, v36
    v_mfma_f32_32x32x16_bf16 v[16:31], v[180:183], v[88:91], 0
    ds_read_b128 v[88:91], v7 offset:55808
    v_sub_f32 v37, v37, v12
    v_exp_f32 v37, v37
    v_sub_f32 v38, v38, v12
    v_exp_f32 v38, v38
    v_sub_f32 v39, v39, v12
    v_exp_f32 v39, v39
    v_sub_f32 v40, v40, v12
    v_exp_f32 v40, v40
    v_sub_f32 v41, v41, v12
    v_exp_f32 v41, v41
    v_smfmac_f32_32x32x32_bf16 v[72:87], v[172:175], v[32:39], v55
    s_waitcnt vmcnt(5)
    buffer_load_dwordx4 v[196:199], v1, s[8:11], s48 offen offset:1024
    v_sub_f32 v42, v42, v12
    v_exp_f32 v42, v42
    v_sub_f32 v43, v43, v12
    v_exp_f32 v43, v43
    v_sub_f32 v44, v44, v12
    v_exp_f32 v44, v44
    v_sub_f32 v45, v45, v12
    v_exp_f32 v45, v45
    v_smfmac_f32_16x16x64_bf16 v[248:251], v[228:231], v[200:207], v54
    v_sub_f32 v46, v46, v12
    v_exp_f32 v46, v46
    v_sub_f32 v47, v47, v12
    v_exp_f32 v47, v47
    v_sub_f32 v16, v16, v11
    v_exp_f32 v16, v16
    v_sub_f32 v17, v17, v11
    v_exp_f32 v17, v17
    v_smfmac_f32_32x32x32_bf16 v[72:87], v[176:179], v[40:47], v55
    v_sub_f32 v18, v18, v11
    v_exp_f32 v18, v18
    v_sub_f32 v19, v19, v11
    v_exp_f32 v19, v19
    v_sub_f32 v20, v20, v11
    v_exp_f32 v20, v20
    v_mfma_f32_32x32x16_bf16 v[32:47], v[180:183], v[92:95], 0
    ds_read_b128 v[92:95], v7 offset:56832
    v_sub_f32 v21, v21, v11
    v_exp_f32 v21, v21
    v_sub_f32 v22, v22, v11
    v_exp_f32 v22, v22
    v_sub_f32 v23, v23, v11
    v_exp_f32 v23, v23
    v_sub_f32 v24, v24, v11
    v_exp_f32 v24, v24
    v_sub_f32 v25, v25, v11
    v_exp_f32 v25, v25
    v_smfmac_f32_32x32x32_bf16 v[56:71], v[184:187], v[16:23], v55
    s_waitcnt vmcnt(4)
    buffer_load_dwordx4 v[200:203], v1, s[8:11], s49 offen offset:0
    v_sub_f32 v26, v26, v11
    v_exp_f32 v26, v26
    v_sub_f32 v27, v27, v11
    v_exp_f32 v27, v27
    v_sub_f32 v28, v28, v11
    v_exp_f32 v28, v28
    v_sub_f32 v29, v29, v11
    v_exp_f32 v29, v29
    v_smfmac_f32_16x16x64_bf16 v[252:255], v[228:231], v[208:215], v54
    v_sub_f32 v30, v30, v11
    v_exp_f32 v30, v30
    v_sub_f32 v31, v31, v11
    v_exp_f32 v31, v31
    v_sub_f32 v32, v32, v12
    v_exp_f32 v32, v32
    v_sub_f32 v33, v33, v12
    v_exp_f32 v33, v33
    v_smfmac_f32_32x32x32_bf16 v[56:71], v[188:191], v[24:31], v55
    s_waitcnt lgkmcnt(0)
    buffer_load_dwordx4 v[204:207], v1, s[8:11], s49 offen offset:1024
    v_sub_f32 v34, v34, v12
    v_exp_f32 v34, v34
    v_sub_f32 v35, v35, v12
    v_exp_f32 v35, v35
    v_sub_f32 v36, v36, v12
    v_exp_f32 v36, v36
    v_mfma_f32_32x32x16_bf16 v[16:31], v[96:99], v[88:91], 0
    v_sub_f32 v37, v37, v12
    v_exp_f32 v37, v37
    v_sub_f32 v38, v38, v12
    v_exp_f32 v38, v38
    v_sub_f32 v39, v39, v12
    v_exp_f32 v39, v39
    v_sub_f32 v40, v40, v12
    v_exp_f32 v40, v40
    v_sub_f32 v41, v41, v12
    v_exp_f32 v41, v41
    v_smfmac_f32_32x32x32_bf16 v[72:87], v[184:187], v[32:39], v55
    buffer_load_dwordx4 v[208:211], v1, s[8:11], s50 offen offset:0
    v_sub_f32 v42, v42, v12
    v_exp_f32 v42, v42
    v_add_u32 v7, 2048, v7
    v_sub_f32 v43, v43, v12
    v_exp_f32 v43, v43
    ds_write_b128 v2, v[56:59] offset:0
    v_sub_f32 v44, v44, v12
    v_exp_f32 v44, v44
    ds_write_b128 v2, v[60:63] offset:16
    v_sub_f32 v45, v45, v12
    v_exp_f32 v45, v45
    ds_write2_b32 v2, v7, v64 offset0:8 offset1:9
    v_sub_f32 v46, v46, v12
    v_exp_f32 v46, v46
    v_sub_f32 v47, v47, v12
    v_exp_f32 v47, v47
    v_mfma_f32_32x32x16_bf16 v[56:71], v[48:51], v[48:51], 0
    ds_read_b32 v11, v7 offset:64000
    s_waitcnt lgkmcnt(0)
    v_sub_f32 v16, v16, v11
    v_exp_f32 v16, v16
    v_sub_f32 v17, v17, v11
    v_exp_f32 v17, v17
    v_smfmac_f32_32x32x32_bf16 v[72:87], v[188:191], v[40:47], v55
    v_sub_f32 v18, v18, v11
    v_exp_f32 v18, v18
    v_sub_f32 v19, v19, v11
    v_exp_f32 v19, v19
    v_sub_f32 v20, v20, v11
    v_exp_f32 v20, v20
    v_mfma_f32_32x32x16_bf16 v[32:47], v[96:99], v[92:95], 0
    buffer_load_dwordx4 v[212:215], v1, s[8:11], s50 offen offset:1024
    v_sub_f32 v21, v21, v11
    v_exp_f32 v21, v21
    v_sub_f32 v22, v22, v11
    v_exp_f32 v22, v22
    v_sub_f32 v23, v23, v11
    v_exp_f32 v23, v23
    v_sub_f32 v24, v24, v11
    v_exp_f32 v24, v24
    v_sub_f32 v25, v25, v11
    v_exp_f32 v25, v25
    v_smfmac_f32_32x32x32_bf16 v[56:71], v[100:103], v[16:23], v55
    v_sub_f32 v26, v26, v11
    v_exp_f32 v26, v26
    v_sub_f32 v27, v27, v11
    v_exp_f32 v27, v27
    ds_write_b128 v2, v[72:75] offset:3072
    v_sub_f32 v28, v28, v11
    v_exp_f32 v28, v28
    ds_write_b128 v2, v[76:79] offset:3088
    v_sub_f32 v29, v29, v11
    v_exp_f32 v29, v29
    ds_write2_b32 v53, v7, v80 offset0:8 offset1:9
    v_sub_f32 v30, v30, v11
    v_exp_f32 v30, v30
    v_mfma_f32_32x32x16_bf16 v[72:87], v[48:51], v[48:51], 0
    v_sub_f32 v31, v31, v11
    v_exp_f32 v31, v31
    ds_read_b32 v12, v7 offset:65024
    s_waitcnt lgkmcnt(0)
    v_sub_f32 v32, v32, v12
    v_exp_f32 v32, v32
    v_sub_f32 v33, v33, v12
    v_exp_f32 v33, v33
    v_smfmac_f32_32x32x32_bf16 v[56:71], v[104:107], v[24:31], v55
    s_setprio 1
    buffer_load_dwordx4 v[96:99], v1, s[8:11], s52 offen offset:0
    v_sub_f32 v34, v34, v12
    v_exp_f32 v34, v34
    v_sub_f32 v35, v35, v12
    v_exp_f32 v35, v35
    v_sub_f32 v36, v36, v12
    v_exp_f32 v36, v36
    v_mfma_f32_32x32x16_bf16 v[16:31], v[108:111], v[88:91], 0
    s_waitcnt lgkmcnt(0)
    v_sub_f32 v37, v37, v12
    v_exp_f32 v37, v37
    v_sub_f32 v38, v38, v12
    v_exp_f32 v38, v38
    v_sub_f32 v39, v39, v12
    v_exp_f32 v39, v39
    v_sub_f32 v40, v40, v12
    v_exp_f32 v40, v40
    v_sub_f32 v41, v41, v12
    v_exp_f32 v41, v41
    v_smfmac_f32_32x32x32_bf16 v[72:87], v[100:103], v[32:39], v55
    buffer_load_dwordx4 v[100:103], v1, s[8:11], s52 offen offset:1024
    v_sub_f32 v42, v42, v12
    v_exp_f32 v42, v42
    v_sub_f32 v43, v43, v12
    v_exp_f32 v43, v43
    v_sub_f32 v44, v44, v12
    v_exp_f32 v44, v44
    v_sub_f32 v45, v45, v12
    v_exp_f32 v45, v45
    v_sub_f32 v46, v46, v12
    v_exp_f32 v46, v46
    v_sub_f32 v47, v47, v12
    v_exp_f32 v47, v47
    v_sub_f32 v16, v16, v11
    v_exp_f32 v16, v16
    v_sub_f32 v17, v17, v11
    v_exp_f32 v17, v17
    v_smfmac_f32_32x32x32_bf16 v[72:87], v[104:107], v[40:47], v55
    s_barrier
    ds_read_b64 v[8:9], v4 offset:32
    v_sub_f32 v18, v18, v11
    v_exp_f32 v18, v18
    v_sub_f32 v19, v19, v11
    v_exp_f32 v19, v19
    v_sub_f32 v20, v20, v11
    v_exp_f32 v20, v20
    v_mfma_f32_32x32x16_bf16 v[32:47], v[108:111], v[92:95], 0
    ds_read2st64_b64 v[224:227], v3 offset0:0 offset1:12
    v_sub_f32 v21, v21, v11
    v_exp_f32 v21, v21
    v_sub_f32 v22, v22, v11
    v_exp_f32 v22, v22
    v_sub_f32 v23, v23, v11
    v_exp_f32 v23, v23
    v_sub_f32 v24, v24, v11
    v_exp_f32 v24, v24
    v_sub_f32 v25, v25, v11
    v_exp_f32 v25, v25
    v_smfmac_f32_32x32x32_bf16 v[56:71], v[112:115], v[16:23], v55
    ds_read2st64_b64 v[228:231], v3 offset0:24 offset1:36
    v_sub_f32 v26, v26, v11
    v_exp_f32 v26, v26
    v_sub_f32 v27, v27, v11
    v_exp_f32 v27, v27
    v_sub_f32 v28, v28, v11
    v_exp_f32 v28, v28
    v_sub_f32 v29, v29, v11
    v_exp_f32 v29, v29
    v_sub_f32 v30, v30, v11
    v_exp_f32 v30, v30
    v_sub_f32 v31, v31, v11
    v_exp_f32 v31, v31
    v_sub_f32 v32, v32, v12
    v_exp_f32 v32, v32
    v_sub_f32 v33, v33, v12
    v_exp_f32 v33, v33
    v_smfmac_f32_32x32x32_bf16 v[56:71], v[116:119], v[24:31], v55
    ds_read2st64_b64 v[232:235], v3 offset0:48 offset1:60
    v_sub_f32 v34, v34, v12
    v_exp_f32 v34, v34
    v_sub_f32 v35, v35, v12
    v_exp_f32 v35, v35
    v_sub_f32 v36, v36, v12
    v_exp_f32 v36, v36
    v_mfma_f32_32x32x16_bf16 v[16:31], v[120:123], v[88:91], 0
    ds_read2st64_b64 v[236:239], v3 offset0:72 offset1:84
    v_sub_f32 v37, v37, v12
    v_exp_f32 v37, v37
    v_sub_f32 v38, v38, v12
    v_exp_f32 v38, v38
    v_sub_f32 v39, v39, v12
    v_exp_f32 v39, v39
    v_sub_f32 v40, v40, v12
    v_exp_f32 v40, v40
    v_sub_f32 v41, v41, v12
    v_exp_f32 v41, v41
    v_smfmac_f32_32x32x32_bf16 v[72:87], v[112:115], v[32:39], v55
    s_waitcnt lgkmcnt(0)
    buffer_load_dwordx4 v[104:107], v1, s[8:11], s53 offen offset:0
    v_sub_f32 v42, v42, v12
    v_exp_f32 v42, v42
    v_sub_f32 v43, v43, v12
    v_exp_f32 v43, v43
    v_sub_f32 v44, v44, v12
    v_exp_f32 v44, v44
    v_sub_f32 v45, v45, v12
    v_exp_f32 v45, v45
    v_sub_f32 v46, v46, v12
    v_exp_f32 v46, v46
    v_sub_f32 v47, v47, v12
    v_exp_f32 v47, v47
    v_sub_f32 v16, v16, v11
    v_exp_f32 v16, v16
    v_sub_f32 v17, v17, v11
    v_exp_f32 v17, v17
    v_smfmac_f32_32x32x32_bf16 v[72:87], v[116:119], v[40:47], v55
    buffer_load_dwordx4 v[108:111], v1, s[8:11], s53 offen offset:1024
    v_sub_f32 v18, v18, v11
    v_exp_f32 v18, v18
    v_add_f32_dpp v9, v9, v9 quad_perm:[1,0,3,2] row_mask:0xf bank_mask:0xf
    v_sub_f32 v19, v19, v11
    v_exp_f32 v19, v19
    v_add_f32 v224, v224, v226
    v_sub_f32 v20, v20, v11
    v_exp_f32 v20, v20
    v_add_f32 v225, v225, v227
    v_mfma_f32_32x32x16_bf16 v[32:47], v[120:123], v[92:95], 0
    buffer_load_dwordx4 v[112:115], v1, s[8:11], s54 offen offset:0
    v_sub_f32 v21, v21, v11
    v_exp_f32 v21, v21
    v_add_f32_dpp v9, v9, v9 quad_perm:[2,3,0,1] row_mask:0xf bank_mask:0xf
    v_sub_f32 v22, v22, v11
    v_exp_f32 v22, v22
    v_add_f32 v228, v228, v230
    v_sub_f32 v23, v23, v11
    v_exp_f32 v23, v23
    v_add_f32 v229, v229, v231
    v_sub_f32 v24, v24, v11
    v_exp_f32 v24, v24
    v_add_f32_dpp v9, v9, v9 row_ror:8 row_mask:0xf bank_mask:0xf
    v_sub_f32 v25, v25, v11
    v_exp_f32 v25, v25
    v_add_f32 v232, v232, v234
    v_smfmac_f32_32x32x32_bf16 v[56:71], v[124:127], v[16:23], v55
    v_sub_f32 v26, v26, v11
    v_exp_f32 v26, v26
    v_add_f32 v233, v233, v235
    v_sub_f32 v27, v27, v11
    v_exp_f32 v27, v27
    v_rcp_f32 v10, v9
    v_sub_f32 v28, v28, v11
    v_exp_f32 v28, v28
    v_add_f32 v236, v236, v238
    v_sub_f32 v29, v29, v11
    v_exp_f32 v29, v29
    v_add_f32 v237, v237, v239
    v_sub_f32 v30, v30, v11
    v_exp_f32 v30, v30
    v_add_f32 v224, v224, v228
    v_sub_f32 v31, v31, v11
    v_exp_f32 v31, v31
    v_add_f32 v225, v225, v229
    v_sub_f32 v32, v32, v12
    v_exp_f32 v32, v32
    v_add_f32 v232, v232, v236
    v_sub_f32 v33, v33, v12
    v_exp_f32 v33, v33
    v_add_f32 v233, v233, v237
    v_smfmac_f32_32x32x32_bf16 v[56:71], v[128:131], v[24:31], v55
    buffer_load_dwordx4 v[116:119], v1, s[8:11], s54 offen offset:1024
    v_sub_f32 v34, v34, v12
    v_exp_f32 v34, v34
    v_add_f32 v224, v224, v232
    v_sub_f32 v35, v35, v12
    v_exp_f32 v35, v35
    v_add_f32 v225, v225, v233
    v_sub_f32 v36, v36, v12
    v_exp_f32 v36, v36
    v_mul_f32 v224, v224, v10
    v_mfma_f32_32x32x16_bf16 v[16:31], v[132:135], v[88:91], 0
    buffer_load_dwordx4 v[232:235], v1, s[8:11], s48 offen offset:2048
    v_sub_f32 v37, v37, v12
    v_exp_f32 v37, v37
    v_mul_f32 v225, v225, v10
    v_sub_f32 v38, v38, v12
    v_exp_f32 v38, v38
    v_cvt_pk_bf16_f32 v224, v224, v225
    v_sub_f32 v39, v39, v12
    v_exp_f32 v39, v39
    ds_write2st64_b32 v5, v224, v7 offset0:192 offset1:200
    v_sub_f32 v40, v40, v12
    v_exp_f32 v40, v40
    v_sub_f32 v41, v41, v12
    v_exp_f32 v41, v41
    v_smfmac_f32_32x32x32_bf16 v[72:87], v[124:127], v[32:39], v55
    s_setprio 0
    v_sub_f32 v42, v42, v12
    v_exp_f32 v42, v42
    v_sub_f32 v43, v43, v12
    v_exp_f32 v43, v43
    v_sub_f32 v44, v44, v12
    v_exp_f32 v44, v44
    v_sub_f32 v45, v45, v12
    v_exp_f32 v45, v45
    v_sub_f32 v46, v46, v12
    v_exp_f32 v46, v46
    v_sub_f32 v47, v47, v12
    v_exp_f32 v47, v47
    v_sub_f32 v16, v16, v11
    v_exp_f32 v16, v16
    v_sub_f32 v17, v17, v11
    v_exp_f32 v17, v17
    v_smfmac_f32_32x32x32_bf16 v[72:87], v[128:131], v[40:47], v55
    s_waitcnt lgkmcnt(0)
    buffer_load_dwordx4 v[236:239], v1, s[8:11], s48 offen offset:3072
    v_sub_f32 v18, v18, v11
    v_exp_f32 v18, v18
    v_sub_f32 v19, v19, v11
    v_exp_f32 v19, v19
    v_sub_f32 v20, v20, v11
    v_exp_f32 v20, v20
    v_mfma_f32_32x32x16_bf16 v[32:47], v[132:135], v[92:95], 0
    s_barrier
    ds_read_b32 v8, v52 offset:51200
    v_sub_f32 v21, v21, v11
    v_exp_f32 v21, v21
    v_sub_f32 v22, v22, v11
    v_exp_f32 v22, v22
    v_sub_f32 v23, v23, v11
    v_exp_f32 v23, v23
    v_sub_f32 v24, v24, v11
    v_exp_f32 v24, v24
    v_sub_f32 v25, v25, v11
    v_exp_f32 v25, v25
    v_smfmac_f32_32x32x32_bf16 v[56:71], v[136:139], v[16:23], v55
    ds_read_b128 v[224:227], v1 offset:49152
    v_sub_f32 v26, v26, v11
    v_exp_f32 v26, v26
    v_sub_f32 v27, v27, v11
    v_exp_f32 v27, v27
    v_sub_f32 v28, v28, v11
    v_exp_f32 v28, v28
    v_sub_f32 v29, v29, v11
    v_exp_f32 v29, v29
    v_sub_f32 v30, v30, v11
    v_exp_f32 v30, v30
    v_sub_f32 v31, v31, v11
    v_exp_f32 v31, v31
    v_sub_f32 v32, v32, v12
    v_exp_f32 v32, v32
    v_sub_f32 v33, v33, v12
    v_exp_f32 v33, v33
    v_smfmac_f32_32x32x32_bf16 v[56:71], v[140:143], v[24:31], v55
    ds_read_b128 v[228:231], v1 offset:50176
    v_sub_f32 v34, v34, v12
    v_exp_f32 v34, v34
    v_sub_f32 v35, v35, v12
    v_exp_f32 v35, v35
    v_sub_f32 v36, v36, v12
    v_exp_f32 v36, v36
    v_mfma_f32_32x32x16_bf16 v[16:31], v[144:147], v[88:91], 0
    s_waitcnt lgkmcnt(0)
    buffer_load_dwordx4 v[120:123], v1, s[8:11], s55 offen offset:0
    v_sub_f32 v37, v37, v12
    v_exp_f32 v37, v37
    v_sub_f32 v38, v38, v12
    v_exp_f32 v38, v38
    v_sub_f32 v39, v39, v12
    v_exp_f32 v39, v39
    v_sub_f32 v40, v40, v12
    v_exp_f32 v40, v40
    v_sub_f32 v41, v41, v12
    v_exp_f32 v41, v41
    v_smfmac_f32_32x32x32_bf16 v[72:87], v[136:139], v[32:39], v55
    s_waitcnt vmcnt(13)
    s_setprio 3
    buffer_load_dwordx4 v[124:127], v1, s[8:11], s55 offen offset:1024
    v_sub_f32 v42, v42, v12
    v_exp_f32 v42, v42
    v_sub_f32 v43, v43, v12
    v_exp_f32 v43, v43
    v_sub_f32 v44, v44, v12
    v_exp_f32 v44, v44
    v_sub_f32 v45, v45, v12
    v_exp_f32 v45, v45
    v_smfmac_f32_16x16x64_bf16 v[240:243], v[224:227], v[192:199], v54
    v_sub_f32 v46, v46, v12
    v_exp_f32 v46, v46
    v_sub_f32 v47, v47, v12
    v_exp_f32 v47, v47
    v_sub_f32 v16, v16, v11
    v_exp_f32 v16, v16
    v_sub_f32 v17, v17, v11
    v_exp_f32 v17, v17
    v_smfmac_f32_32x32x32_bf16 v[72:87], v[140:143], v[40:47], v55
    buffer_load_dwordx4 v[192:195], v1, s[8:11], s49 offen offset:2048
    v_sub_f32 v18, v18, v11
    v_exp_f32 v18, v18
    v_sub_f32 v19, v19, v11
    v_exp_f32 v19, v19
    v_sub_f32 v20, v20, v11
    v_exp_f32 v20, v20
    v_mfma_f32_32x32x16_bf16 v[32:47], v[144:147], v[92:95], 0
    v_sub_f32 v21, v21, v11
    v_exp_f32 v21, v21
    v_sub_f32 v22, v22, v11
    v_exp_f32 v22, v22
    v_sub_f32 v23, v23, v11
    v_exp_f32 v23, v23
    v_sub_f32 v24, v24, v11
    v_exp_f32 v24, v24
    v_sub_f32 v25, v25, v11
    v_exp_f32 v25, v25
    v_smfmac_f32_32x32x32_bf16 v[56:71], v[148:151], v[16:23], v55
    s_waitcnt vmcnt(13)
    buffer_load_dwordx4 v[196:199], v1, s[8:11], s49 offen offset:3072
    v_sub_f32 v26, v26, v11
    v_exp_f32 v26, v26
    v_sub_f32 v27, v27, v11
    v_exp_f32 v27, v27
    v_sub_f32 v28, v28, v11
    v_exp_f32 v28, v28
    v_sub_f32 v29, v29, v11
    v_exp_f32 v29, v29
    v_smfmac_f32_16x16x64_bf16 v[244:247], v[224:227], v[200:207], v54
    v_sub_f32 v30, v30, v11
    v_exp_f32 v30, v30
    v_sub_f32 v31, v31, v11
    v_exp_f32 v31, v31
    v_sub_f32 v32, v32, v12
    v_exp_f32 v32, v32
    v_sub_f32 v33, v33, v12
    v_exp_f32 v33, v33
    v_smfmac_f32_32x32x32_bf16 v[56:71], v[152:155], v[24:31], v55
    buffer_load_dwordx4 v[200:203], v1, s[8:11], s50 offen offset:2048
    v_sub_f32 v34, v34, v12
    v_exp_f32 v34, v34
    v_sub_f32 v35, v35, v12
    v_exp_f32 v35, v35
    v_sub_f32 v36, v36, v12
    v_exp_f32 v36, v36
    v_mfma_f32_32x32x16_bf16 v[16:31], v[156:159], v[88:91], 0
    v_sub_f32 v37, v37, v12
    v_exp_f32 v37, v37
    v_sub_f32 v38, v38, v12
    v_exp_f32 v38, v38
    v_sub_f32 v39, v39, v12
    v_exp_f32 v39, v39
    v_sub_f32 v40, v40, v12
    v_exp_f32 v40, v40
    v_sub_f32 v41, v41, v12
    v_exp_f32 v41, v41
    v_smfmac_f32_32x32x32_bf16 v[72:87], v[148:151], v[32:39], v55
    s_waitcnt vmcnt(13)
    buffer_load_dwordx4 v[204:207], v1, s[8:11], s50 offen offset:3072
    v_sub_f32 v42, v42, v12
    v_exp_f32 v42, v42
    v_sub_f32 v43, v43, v12
    v_exp_f32 v43, v43
    v_sub_f32 v44, v44, v12
    v_exp_f32 v44, v44
    v_sub_f32 v45, v45, v12
    v_exp_f32 v45, v45
    v_smfmac_f32_16x16x64_bf16 v[248:251], v[224:227], v[208:215], v54
    v_sub_f32 v46, v46, v12
    v_exp_f32 v46, v46
    v_sub_f32 v47, v47, v12
    v_exp_f32 v47, v47
    v_sub_f32 v16, v16, v11
    v_exp_f32 v16, v16
    v_sub_f32 v17, v17, v11
    v_exp_f32 v17, v17
    v_smfmac_f32_32x32x32_bf16 v[72:87], v[152:155], v[40:47], v55
    buffer_load_dwordx4 v[208:211], v1, s[8:11], s51 offen offset:2048
    v_sub_f32 v18, v18, v11
    v_exp_f32 v18, v18
    v_sub_f32 v19, v19, v11
    v_exp_f32 v19, v19
    v_sub_f32 v20, v20, v11
    v_exp_f32 v20, v20
    v_mfma_f32_32x32x16_bf16 v[32:47], v[156:159], v[92:95], 0
    v_sub_f32 v21, v21, v11
    v_exp_f32 v21, v21
    v_sub_f32 v22, v22, v11
    v_exp_f32 v22, v22
    v_sub_f32 v23, v23, v11
    v_exp_f32 v23, v23
    v_sub_f32 v24, v24, v11
    v_exp_f32 v24, v24
    v_sub_f32 v25, v25, v11
    v_exp_f32 v25, v25
    v_smfmac_f32_32x32x32_bf16 v[56:71], v[160:163], v[16:23], v55
    buffer_load_dwordx4 v[212:215], v1, s[8:11], s51 offen offset:3072
    v_sub_f32 v26, v26, v11
    v_exp_f32 v26, v26
    v_sub_f32 v27, v27, v11
    v_exp_f32 v27, v27
    v_sub_f32 v28, v28, v11
    v_exp_f32 v28, v28
    v_sub_f32 v29, v29, v11
    v_exp_f32 v29, v29
    v_smfmac_f32_16x16x64_bf16 v[252:255], v[224:227], v[216:223], v54
    v_sub_f32 v30, v30, v11
    v_exp_f32 v30, v30
    v_sub_f32 v31, v31, v11
    v_exp_f32 v31, v31
    v_sub_f32 v32, v32, v12
    v_exp_f32 v32, v32
    v_sub_f32 v33, v33, v12
    v_exp_f32 v33, v33
    v_smfmac_f32_32x32x32_bf16 v[56:71], v[164:167], v[24:31], v55
    buffer_load_dwordx4 v[128:131], v1, s[8:11], s52 offen offset:2048
    v_sub_f32 v34, v34, v12
    v_exp_f32 v34, v34
    v_sub_f32 v35, v35, v12
    v_exp_f32 v35, v35
    v_sub_f32 v36, v36, v12
    v_exp_f32 v36, v36
    v_mfma_f32_32x32x16_bf16 v[16:31], v[168:171], v[88:91], 0
    v_sub_f32 v37, v37, v12
    v_exp_f32 v37, v37
    v_sub_f32 v38, v38, v12
    v_exp_f32 v38, v38
    v_sub_f32 v39, v39, v12
    v_exp_f32 v39, v39
    v_sub_f32 v40, v40, v12
    v_exp_f32 v40, v40
    v_sub_f32 v41, v41, v12
    v_exp_f32 v41, v41
    v_smfmac_f32_32x32x32_bf16 v[72:87], v[160:163], v[32:39], v55
    s_waitcnt vmcnt(9)
    buffer_load_dwordx4 v[132:135], v1, s[8:11], s52 offen offset:3072
    v_sub_f32 v42, v42, v12
    v_exp_f32 v42, v42
    v_sub_f32 v43, v43, v12
    v_exp_f32 v43, v43
    v_sub_f32 v44, v44, v12
    v_exp_f32 v44, v44
    v_sub_f32 v45, v45, v12
    v_exp_f32 v45, v45
    v_smfmac_f32_16x16x64_bf16 v[240:243], v[228:231], v[232:239], v54
    v_sub_f32 v46, v46, v12
    v_exp_f32 v46, v46
    v_sub_f32 v47, v47, v12
    v_exp_f32 v47, v47
    v_sub_f32 v16, v16, v11
    v_exp_f32 v16, v16
    v_sub_f32 v17, v17, v11
    v_exp_f32 v17, v17
    v_smfmac_f32_32x32x32_bf16 v[72:87], v[164:167], v[40:47], v55
    s_setprio 2
    buffer_load_dwordx4 v[136:139], v1, s[8:11], s53 offen offset:2048
    v_sub_f32 v18, v18, v11
    v_exp_f32 v18, v18
    v_sub_f32 v19, v19, v11
    v_exp_f32 v19, v19
    v_sub_f32 v20, v20, v11
    v_exp_f32 v20, v20
    v_mfma_f32_32x32x16_bf16 v[32:47], v[168:171], v[92:95], 0
    v_sub_f32 v21, v21, v11
    v_exp_f32 v21, v21
    v_sub_f32 v22, v22, v11
    v_exp_f32 v22, v22
    v_sub_f32 v23, v23, v11
    v_exp_f32 v23, v23
    v_sub_f32 v24, v24, v11
    v_exp_f32 v24, v24
    v_sub_f32 v25, v25, v11
    v_exp_f32 v25, v25
    v_smfmac_f32_32x32x32_bf16 v[56:71], v[172:175], v[16:23], v55
    s_waitcnt vmcnt(7)
    buffer_load_dwordx4 v[140:143], v1, s[8:11], s53 offen offset:3072
    v_sub_f32 v26, v26, v11
    v_exp_f32 v26, v26
    v_sub_f32 v27, v27, v11
    v_exp_f32 v27, v27
    v_sub_f32 v28, v28, v11
    v_exp_f32 v28, v28
    v_sub_f32 v29, v29, v11
    v_exp_f32 v29, v29
    v_smfmac_f32_16x16x64_bf16 v[244:247], v[228:231], v[192:199], v54
    v_sub_f32 v30, v30, v11
    v_exp_f32 v30, v30
    v_sub_f32 v31, v31, v11
    v_exp_f32 v31, v31
    v_sub_f32 v32, v32, v12
    v_exp_f32 v32, v32
    v_sub_f32 v33, v33, v12
    v_exp_f32 v33, v33
    v_smfmac_f32_32x32x32_bf16 v[56:71], v[176:179], v[24:31], v55
    buffer_load_dwordx4 v[144:147], v1, s[8:11], s54 offen offset:2048
    v_sub_f32 v34, v34, v12
    v_exp_f32 v34, v34
    v_sub_f32 v35, v35, v12
    v_exp_f32 v35, v35
    v_sub_f32 v36, v36, v12
    v_exp_f32 v36, v36
    v_mfma_f32_32x32x16_bf16 v[16:31], v[180:183], v[88:91], 0
    v_sub_f32 v37, v37, v12
    v_exp_f32 v37, v37
    v_sub_f32 v38, v38, v12
    v_exp_f32 v38, v38
    v_sub_f32 v39, v39, v12
    v_exp_f32 v39, v39
    v_sub_f32 v40, v40, v12
    v_exp_f32 v40, v40
    v_sub_f32 v41, v41, v12
    v_exp_f32 v41, v41
    v_smfmac_f32_32x32x32_bf16 v[72:87], v[172:175], v[32:39], v55
    s_waitcnt vmcnt(7)
    buffer_load_dwordx4 v[148:151], v1, s[8:11], s54 offen offset:3072
    v_sub_f32 v42, v42, v12
    v_exp_f32 v42, v42
    v_sub_f32 v43, v43, v12
    v_exp_f32 v43, v43
    v_sub_f32 v44, v44, v12
    v_exp_f32 v44, v44
    v_sub_f32 v45, v45, v12
    v_exp_f32 v45, v45
    v_smfmac_f32_16x16x64_bf16 v[248:251], v[228:231], v[200:207], v54
    v_sub_f32 v46, v46, v12
    v_exp_f32 v46, v46
    v_sub_f32 v47, v47, v12
    v_exp_f32 v47, v47
    v_sub_f32 v16, v16, v11
    v_exp_f32 v16, v16
    v_sub_f32 v17, v17, v11
    v_exp_f32 v17, v17
    v_smfmac_f32_32x32x32_bf16 v[72:87], v[176:179], v[40:47], v55
    buffer_load_dwordx4 v[152:155], v1, s[8:11], s55 offen offset:2048
    v_sub_f32 v18, v18, v11
    v_exp_f32 v18, v18
    v_sub_f32 v19, v19, v11
    v_exp_f32 v19, v19
    v_sub_f32 v20, v20, v11
    v_exp_f32 v20, v20
    v_mfma_f32_32x32x16_bf16 v[32:47], v[180:183], v[92:95], 0
    v_sub_f32 v21, v21, v11
    v_exp_f32 v21, v21
    v_sub_f32 v22, v22, v11
    v_exp_f32 v22, v22
    v_sub_f32 v23, v23, v11
    v_exp_f32 v23, v23
    v_sub_f32 v24, v24, v11
    v_exp_f32 v24, v24
    v_sub_f32 v25, v25, v11
    v_exp_f32 v25, v25
    v_smfmac_f32_32x32x32_bf16 v[56:71], v[184:187], v[16:23], v55
    s_waitcnt vmcnt(7)
    buffer_load_dwordx4 v[156:159], v1, s[8:11], s55 offen offset:3072
    v_sub_f32 v26, v26, v11
    v_exp_f32 v26, v26
    v_sub_f32 v27, v27, v11
    v_exp_f32 v27, v27
    v_sub_f32 v28, v28, v11
    v_exp_f32 v28, v28
    v_sub_f32 v29, v29, v11
    v_exp_f32 v29, v29
    v_smfmac_f32_16x16x64_bf16 v[252:255], v[228:231], v[208:215], v54
    v_sub_f32 v30, v30, v11
    v_exp_f32 v30, v30
    v_sub_f32 v31, v31, v11
    v_exp_f32 v31, v31
    v_sub_f32 v32, v32, v12
    v_exp_f32 v32, v32
    v_sub_f32 v33, v33, v12
    v_exp_f32 v33, v33
    v_smfmac_f32_32x32x32_bf16 v[56:71], v[188:191], v[24:31], v55
    v_sub_f32 v34, v34, v12
    v_exp_f32 v34, v34
    v_sub_f32 v35, v35, v12
    v_exp_f32 v35, v35
    v_sub_f32 v36, v36, v12
    v_exp_f32 v36, v36
    v_sub_f32 v37, v37, v12
    v_exp_f32 v37, v37
    v_sub_f32 v38, v38, v12
    v_exp_f32 v38, v38
    v_sub_f32 v39, v39, v12
    v_exp_f32 v39, v39
    v_sub_f32 v40, v40, v12
    v_exp_f32 v40, v40
    v_sub_f32 v41, v41, v12
    v_exp_f32 v41, v41
    v_smfmac_f32_32x32x32_bf16 v[72:87], v[184:187], v[32:39], v55
    v_sub_f32 v42, v42, v12
    v_exp_f32 v42, v42
    v_add_u32 v7, 2048, v7
    v_sub_f32 v43, v43, v12
    v_exp_f32 v43, v43
    ds_write_b128 v2, v[56:59] offset:0
    v_sub_f32 v44, v44, v12
    v_exp_f32 v44, v44
    ds_write_b128 v2, v[60:63] offset:16
    v_sub_f32 v45, v45, v12
    v_exp_f32 v45, v45
    ds_write2_b32 v2, v7, v64 offset0:8 offset1:9
    v_sub_f32 v46, v46, v12
    v_exp_f32 v46, v46
    v_sub_f32 v47, v47, v12
    v_exp_f32 v47, v47
    s_nop 1
    v_smfmac_f32_32x32x32_bf16 v[72:87], v[188:191], v[40:47], v55
    v_and_b32 v16, 0x1cf, v0
    v_cmp_eq_u32 vcc, 0, v16
    v_lshrrev_b32 v18, 1, v0
    v_and_b32 v18, 0xf8, v18
    v_cndmask_b32 v16, 1.0, 0, vcc
    s_cmp_eq_u32 s17, 1
    s_nop 5
    ds_write_b128 v2, v[72:75] offset:3072
    ds_write_b128 v2, v[76:79] offset:3088
    ds_write2_b32 v53, v7, v80 offset0:8 offset1:9
    s_waitcnt lgkmcnt(0)
    s_barrier
    ds_read_b64 v[8:9], v4 offset:32
    ds_read2st64_b64 v[224:227], v3 offset0:0 offset1:12
    ds_read2st64_b64 v[228:231], v3 offset0:24 offset1:36
    ds_read2st64_b64 v[232:235], v3 offset0:48 offset1:60
    ds_read2st64_b64 v[236:239], v3 offset0:72 offset1:84
    s_waitcnt lgkmcnt(4)
    v_add_f32_dpp v9, v9, v9 quad_perm:[1,0,3,2] row_mask:0xf bank_mask:0xf
    s_waitcnt lgkmcnt(3)
    v_pk_add_f32 v[224:225], v[224:225], v[226:227]
    v_add_f32_dpp v9, v9, v9 quad_perm:[2,3,0,1] row_mask:0xf bank_mask:0xf
    s_waitcnt lgkmcnt(2)
    v_pk_add_f32 v[228:229], v[228:229], v[230:231]
    v_add_f32_dpp v9, v9, v9 row_ror:8 row_mask:0xf bank_mask:0xf
    s_waitcnt lgkmcnt(1)
    v_pk_add_f32 v[232:233], v[232:233], v[234:235]
    v_rcp_f32 v10, v9
    v_pk_add_f32 v[224:225], v[224:225], v[228:229]
    s_waitcnt lgkmcnt(0)
    v_pk_add_f32 v[236:237], v[236:237], v[238:239]
    v_pk_add_f32 v[224:225], v[224:225], v[232:233]
    v_pk_add_f32 v[224:225], v[224:225], v[236:237]
    v_pk_mul_f32 v[224:225], v[224:225], v[10:11] op_sel_hi:[1,0]
    v_cvt_pk_bf16_f32 v224, v224, v225
    ds_write2st64_b32 v5, v224, v7 offset0:192 offset1:200
    s_waitcnt lgkmcnt(0)
    s_barrier
    ds_read_b128 v[224:227], v1 offset:49152
    ds_read_b128 v[228:231], v1 offset:50176
    s_waitcnt vmcnt(0) lgkmcnt(1)
    v_smfmac_f32_16x16x64_bf16 v[240:243], v[224:227], v[96:103], v54
    v_smfmac_f32_16x16x64_bf16 v[244:247], v[224:227], v[104:111], v54
    v_smfmac_f32_16x16x64_bf16 v[248:251], v[224:227], v[112:119], v54
    v_smfmac_f32_16x16x64_bf16 v[252:255], v[224:227], v[120:127], v54
    s_waitcnt lgkmcnt(0)
    v_smfmac_f32_16x16x64_bf16 v[240:243], v[228:231], v[128:135], v54
    v_smfmac_f32_16x16x64_bf16 v[244:247], v[228:231], v[136:143], v54
    s_nop 0
    s_branch k4_epi
CODE_END:
.section .rodata,"a"
.p2align 6
KD_BASE:
.section .rodata,"a"
.p2align 6
.amdhsa_kernel k1_kernel
  .amdhsa_next_free_vgpr 180
  .amdhsa_next_free_sgpr 72
  .amdhsa_accum_offset 180
  .amdhsa_group_segment_fixed_size 0
  .amdhsa_kernarg_size 88
  .amdhsa_user_sgpr_count 2
  .amdhsa_user_sgpr_kernarg_segment_ptr 1
  .amdhsa_system_sgpr_workgroup_id_x 1
.end_amdhsa_kernel
.section .rodata,"a"
.p2align 6
.amdhsa_kernel km_kernel
  .amdhsa_next_free_vgpr 256
  .amdhsa_next_free_sgpr 64
  .amdhsa_accum_offset 256
  .amdhsa_group_segment_fixed_size 0
  .amdhsa_kernarg_size 88
  .amdhsa_user_sgpr_count 2
  .amdhsa_user_sgpr_kernarg_segment_ptr 1
  .amdhsa_system_sgpr_workgroup_id_x 1
.end_amdhsa_kernel
```
